```python
import torch

def _softmax(x, axis=-1):
    return torch.softmax(x, dim=axis)
def _gelu(x):
    return torch.nn.functional.gelu(x, approximate="tanh")
def _silu(x):
    return torch.nn.functional.silu(x)
def _sigmoid(x):
    return torch.sigmoid(x)
def _layernorm(x, axis=-1, eps=1e-5):
    m = x.mean(dim=axis, keepdim=True)
    v = x.var(dim=axis, keepdim=True, unbiased=False)
    return (x - m) / torch.sqrt(v + eps)
def _scatter_add(tgt, idx, src, axis=0):
    return tgt.clone().index_add_(axis, idx, src)
def _segment_sum(src, seg, n):
    out = torch.zeros((n,) + src.shape[1:], dtype=src.dtype)
    return out.index_add_(0, seg, src)
def _pad(x, pw):
    flat = tuple(v for pair in reversed(pw) for v in pair)
    return torch.nn.functional.pad(x, flat)

kernel_name = 'interleave_layers__linear_attn_block__dense_activation_silu__prompt'

def setup_inputs():

    _w = (lambda a: (lambda t: t.to(torch.bfloat16) if t.is_floating_point() else t)(torch.as_tensor(a)))
    def _A_setup():
        B, S, D = 1, 2048, 576
        return {
            "x": _w((lambda *s: torch.randn(*s, dtype=torch.bfloat16) * 0.05)(B, S, D)),
            "wqkv": _w((lambda *s: torch.randn(*s, dtype=torch.bfloat16) * 0.05)(D, 3 * D)),
            "wo": _w((lambda *s: torch.randn(*s, dtype=torch.bfloat16) * 0.05)(D, D)),
        }
    _A_in = _A_setup()

    def _B_setup():
        B, S, D, F = 1, 2048, 576, 4608
        return {
            "x": _w((lambda *s: torch.randn(*s, dtype=torch.bfloat16) * 0.05)(B, S, D)),
            "w1": _w((lambda *s: torch.randn(*s, dtype=torch.bfloat16) * 0.8)(D, F) * (D ** -0.5)),
            "w2": _w((lambda *s: torch.randn(*s, dtype=torch.bfloat16) * 0.8)(F, D) * (F ** -0.5)),
        }
    _B_in = _B_setup()

    return {
        "A_x": _A_in["x"],
        "A_wqkv": _A_in["wqkv"],
        "A_wo": _A_in["wo"],
        "B_x": _B_in["x"],
        "B_w1": _B_in["w1"],
        "B_w2": _B_in["w2"],
    }

def reference(A_x, A_wqkv, A_wo, B_x, B_w1, B_w2):
    def _A_ref(x, wqkv, wo):
        B, S, D = x.shape
        H = 32; Dh = D // H
        qkv = (lambda x, *d: x.permute(*d))((x @ wqkv).reshape(B, S, 3, H, Dh), 2, 0, 3, 1, 4)
        q, k, v = qkv[0], qkv[1], qkv[2]
        phi = lambda t: torch.where(t > 0, t + 1, torch.exp(t)) + 1e-6
        pq, pk = phi(q), phi(k)
        kv = torch.einsum("bhsd,bhse->bhde", pk, v)
        z = torch.einsum("bhsd->bhd", pk)
        num = torch.einsum("bhqd,bhde->bhqe", pq, kv)
        den = torch.einsum("bhqd,bhd->bhq", pq, z)[..., None] + 1e-6
        o = num / den
        return (lambda x, *d: x.permute(*d))(o, 0, 2, 1, 3).reshape(B, S, D) @ wo

    def _B_ref(x, w1, w2):
        h = torch.einsum("bsd,df->bsf", x, w1)
        h = _silu(h)
        out = torch.einsum("bsf,fd->bsd", h, w2)
        return out

    x = A_x
    x = x + _A_ref(_layernorm(x, axis=-1), A_wqkv, A_wo)
    x = x + _B_ref(_layernorm(x, axis=-1), B_w1, B_w2)
    x = x + _A_ref(_layernorm(x, axis=-1), A_wqkv, A_wo)
    x = x + _B_ref(_layernorm(x, axis=-1), B_w1, B_w2)
    return x
```

```asm
; @launch grid=(256,1,1) block=(256,1,1) lds=157184
.amdgcn_target "amdgcn-amd-amdhsa--gfx950"
.text
.globl interleave_layers__linear_attn_block__dense_activation_silu__prompt_kernel
.p2align 8
.type interleave_layers__linear_attn_block__dense_activation_silu__prompt_kernel,@function
interleave_layers__linear_attn_block__dense_activation_silu__prompt_kernel:
    s_cmp_ge_u32 s2, 256
    s_cbranch_scc1 L_interleave_layers__linear_attn_block__dense_activation_silu__prompt_kernel_end
    s_load_dwordx2 s[4:5], s[0:1], 64
    s_load_dwordx2 s[30:31], s[0:1], 56
    v_lshrrev_b32 v1, 6, v0
    s_nop 0
    v_readfirstlane_b32 s6, v1
    v_and_b32 v1, 63, v0
    v_lshlrev_b32 v2, 4, v1
    s_getpc_b64 s[20:21]
L_pc0:
    s_lshr_b32 s22, s2, 3
    s_lshl_b32 s22, s22, 2
    s_add_u32 s22, s22, s6
    s_lshl_b32 s22, s22, 7
    v_and_b32 v3, 3, v1
    v_lshlrev_b32 v3, 14, v3
    v_add_u32 v3, s22, v3
    v_min_u32 v3, L_interleave_layers__linear_attn_block__dense_activation_silu__prompt_kernel_end-L_pc0, v3
    global_load_dword v124, v3, s[20:21]
    s_and_b32 s7, s2, 7
    s_lshl_b32 s7, s7, 2
    s_lshr_b32 s3, s2, 3
    s_and_b32 s20, s3, 3
    s_add_u32 s7, s7, s20
    s_lshr_b32 s3, s3, 2
    s_load_dwordx4 s[24:27], s[0:1], 0
    s_load_dwordx2 s[28:29], s[0:1], 16
    s_load_dwordx4 s[32:35], s[0:1], 32
    s_cmp_ge_u32 s2, 177
    s_cbranch_scc1 L_k0_misc
    s_getpc_b64 s[20:21]
L_k0_pc:
    s_add_u32 s20, s20, L_k0_tab-L_k0_pc
    s_addc_u32 s21, s21, 0
    s_lshl_b32 s22, s2, 2
    s_add_u32 s22, s22, s6
    s_lshl_b32 s22, s22, 4
    s_load_dwordx4 s[16:19], s[20:21], s22
    v_lshrrev_b32 v3, 4, v1
    v_bfe_u32 v4, v1, 2, 2
    v_and_b32 v5, 3, v1
    s_cmp_lt_u32 s2, 24
    s_cbranch_scc1 L_k0_qkv
    v_lshrrev_b32 v6, 3, v1
    v_and_b32 v7, 7, v1
    v_and_b32 v8, 2, v6
    s_cmp_lt_u32 s2, 96
    s_cselect_b32 s22, 0, 1
    s_cselect_b32 s23, 64, 0
    v_lshlrev_b32 v8, s22, v8
    v_xor_b32 v7, v7, v8
    v_lshlrev_b32 v7, 4, v7
    s_mul_i32 s36, s6, 18432
    s_add_u32 s36, s36, 73728
    s_waitcnt lgkmcnt(0)
    s_add_u32 s8, s26, 0
    s_addc_u32 s9, s27, 0
    s_and_b32 s9, s9, 0xffff
    s_mov_b32 s10, 1990656
    s_mov_b32 s11, 0x20000
    s_mul_i32 s20, s7, 73728
    s_add_u32 s48, s24, s20
    s_addc_u32 s49, s25, 0
    s_and_b32 s49, s49, 0xffff
    s_mov_b32 s50, 73728
    s_mov_b32 s51, 0x20000
    s_cmp_ge_u32 s6, 2
    s_cbranch_scc1 L_ftx1
    s_lshl_b32 s20, s6, 6
    v_add_u32 v126, s20, v1
    v_min_u32 v126, 89, v126
    v_mul_u32_u24 v127, 205, v126
    v_lshrrev_b32 v127, 10, v127
    v_mul_u32_u24 v125, 5, v127
    v_sub_u32 v126, v126, v125
    v_lshlrev_b32 v126, 7, v126
    v_min_u32 v126, 428, v126
    v_mul_u32_u24 v127, 3456, v127
    v_add_u32 v126, v126, v127
    s_and_b32 s20, s2, 7
    s_mul_i32 s20, s20, 432
    s_lshr_b32 s21, s2, 3
    s_mul_i32 s21, s21, 62208
    s_add_u32 s20, s20, s21
    buffer_load_dword v125, v126, s[8:11], s20 offen
    s_branch L_ftd1
L_ftx1:
    v_min_u32 v126, 35, v1
    v_lshlrev_b32 v126, 7, v126
    s_lshl_b32 s20, s3, 1
    s_add_u32 s20, s20, s6
    s_sub_u32 s20, s20, 2
    s_mul_i32 s20, s20, 4608
    buffer_load_dword v125, v126, s[48:51], s20 offen
L_ftd1:
    s_waitcnt vmcnt(0)
    s_cmp_lt_u32 s2, 96
    s_cselect_b32 s20, s32, s34
    s_cselect_b32 s21, s33, s35
    s_cmp_lt_u32 s2, 168
    s_cselect_b32 s20, s20, s28
    s_cselect_b32 s21, s21, s29
    s_mov_b32 s37, 5308416
    s_cselect_b32 s10, s37, 663552
    s_mov_b32 s8, s20
    s_and_b32 s9, s21, 0xffff
    s_mov_b32 s11, 0x20000
    v_mul_lo_u32 v6, v6, s19
    v_add_u32 v6, v6, v7
    v_xor_b32 v7, s23, v6
    s_mul_i32 s37, s6, 144
    s_mul_i32 s37, s37, s19
    s_add_u32 s37, s37, s18
    s_lshl_b32 s38, s19, 3
    s_mov_b32 m0, s36
    s_add_u32 s36, s36, 1024
    buffer_load_dwordx4 v6, s[8:11], s37 offen nt lds
    s_add_u32 s37, s37, s38
    s_mov_b32 m0, s36
    s_add_u32 s36, s36, 1024
    buffer_load_dwordx4 v7, s[8:11], s37 offen nt lds
    s_add_u32 s37, s37, s38
    s_mov_b32 m0, s36
    s_add_u32 s36, s36, 1024
    buffer_load_dwordx4 v6, s[8:11], s37 offen nt lds
    s_add_u32 s37, s37, s38
    s_mov_b32 m0, s36
    s_add_u32 s36, s36, 1024
    buffer_load_dwordx4 v7, s[8:11], s37 offen nt lds
    s_add_u32 s37, s37, s38
    s_mov_b32 m0, s36
    s_add_u32 s36, s36, 1024
    buffer_load_dwordx4 v6, s[8:11], s37 offen nt lds
    s_add_u32 s37, s37, s38
    s_mov_b32 m0, s36
    s_add_u32 s36, s36, 1024
    buffer_load_dwordx4 v7, s[8:11], s37 offen nt lds
    s_add_u32 s37, s37, s38
    s_mov_b32 m0, s36
    s_add_u32 s36, s36, 1024
    buffer_load_dwordx4 v6, s[8:11], s37 offen nt lds
    s_add_u32 s37, s37, s38
    s_mov_b32 m0, s36
    s_add_u32 s36, s36, 1024
    buffer_load_dwordx4 v7, s[8:11], s37 offen nt lds
    s_add_u32 s37, s37, s38
    s_mov_b32 m0, s36
    s_add_u32 s36, s36, 1024
    buffer_load_dwordx4 v6, s[8:11], s37 offen nt lds
    s_add_u32 s37, s37, s38
    s_mov_b32 m0, s36
    s_add_u32 s36, s36, 1024
    buffer_load_dwordx4 v7, s[8:11], s37 offen nt lds
    s_add_u32 s37, s37, s38
    s_mov_b32 m0, s36
    s_add_u32 s36, s36, 1024
    buffer_load_dwordx4 v6, s[8:11], s37 offen nt lds
    s_add_u32 s37, s37, s38
    s_mov_b32 m0, s36
    s_add_u32 s36, s36, 1024
    buffer_load_dwordx4 v7, s[8:11], s37 offen nt lds
    s_add_u32 s37, s37, s38
    s_mov_b32 m0, s36
    s_add_u32 s36, s36, 1024
    buffer_load_dwordx4 v6, s[8:11], s37 offen nt lds
    s_add_u32 s37, s37, s38
    s_mov_b32 m0, s36
    s_add_u32 s36, s36, 1024
    buffer_load_dwordx4 v7, s[8:11], s37 offen nt lds
    s_add_u32 s37, s37, s38
    s_mov_b32 m0, s36
    s_add_u32 s36, s36, 1024
    buffer_load_dwordx4 v6, s[8:11], s37 offen nt lds
    s_add_u32 s37, s37, s38
    s_mov_b32 m0, s36
    s_add_u32 s36, s36, 1024
    buffer_load_dwordx4 v7, s[8:11], s37 offen nt lds
    s_add_u32 s37, s37, s38
    s_mov_b32 m0, s36
    s_add_u32 s36, s36, 1024
    buffer_load_dwordx4 v6, s[8:11], s37 offen nt lds
    s_add_u32 s37, s37, s38
    s_mov_b32 m0, s36
    s_add_u32 s36, s36, 1024
    buffer_load_dwordx4 v7, s[8:11], s37 offen nt lds
    s_add_u32 s37, s37, s38
    s_add_u32 s12, s4, s16
    s_addc_u32 s13, s5, 0
    s_and_b32 s13, s13, 0xffff
    s_mov_b32 s14, 73728
    s_mov_b32 s15, 0x20000
    s_add_u32 s52, s30, 0
    s_addc_u32 s53, s31, 0
    s_and_b32 s53, s53, 0xffff
    s_mov_b32 s54, 256
    s_mov_b32 s55, 0x20000
    s_add_u32 s56, s4, 13697024
    s_addc_u32 s57, s5, 0
    s_and_b32 s57, s57, 0xffff
    s_mov_b32 s58, 196608
    s_mov_b32 s59, 0x20000
    v_min_u32 v120, 5, v1
    v_lshlrev_b32 v120, 2, v120
    v_and_b32 v122, 15, v1
    v_lshrrev_b32 v123, 4, v1
    v_lshlrev_b32 v123, 2, v123
    v_sub_u32 v122, v122, v123
    v_mov_b32 v150, 0
    v_mov_b32 v151, 0
    v_mov_b32 v152, 0
    v_mov_b32 v153, 0
    v_mov_b32 v154, 0
    v_mov_b32 v155, 0
    v_cmp_eq_u32 vcc, 0, v122
    v_mov_b32 v123, 16256
    v_mov_b32 v156, 0x3f803f80
    v_cndmask_b32 v152, v152, v123, vcc
    v_cmp_eq_u32 vcc, 1, v122
    v_mov_b32 v123, 1065353216
    v_mov_b32 v157, 0x3f803f80
    v_cndmask_b32 v152, v152, v123, vcc
    v_cmp_eq_u32 vcc, 2, v122
    v_mov_b32 v123, 16256
    v_mov_b32 v158, 0x3f803f80
    v_cndmask_b32 v153, v153, v123, vcc
    v_cmp_eq_u32 vcc, 3, v122
    v_mov_b32 v123, 1065353216
    v_mov_b32 v159, 0x3f803f80
    v_cndmask_b32 v153, v153, v123, vcc
    s_cmp_ge_u32 s2, 96
    s_cbranch_scc1 L_k0_bc
    v_lshl_add_u32 v8, v3, 3, v4
    v_lshlrev_b32 v8, 7, v8
    v_lshrrev_b32 v9, 1, v5
    s_lshl_b32 s20, s6, 1
    v_add_u32 v9, s20, v9
    v_and_b32 v10, 2, v4
    v_xor_b32 v9, v9, v10
    v_and_b32 v10, 1, v3
    v_lshlrev_b32 v10, 2, v10
    v_xor_b32 v9, v9, v10
    v_lshl_add_u32 v8, v9, 4, v8
    v_and_b32 v10, 1, v5
    v_lshl_add_u32 v8, v10, 3, v8
    v_add_u32 v8, 73728, v8
    v_add_u32 v9, 36864, v8
    s_waitcnt vmcnt(0)
    s_barrier
    buffer_load_dword v121, v120, s[52:55], 0 offen sc1
    ds_read_b64_tr_b16 v[16:17], v8 offset:0
    ds_read_b64_tr_b16 v[18:19], v8 offset:512
    ds_read_b64_tr_b16 v[20:21], v8 offset:4096
    ds_read_b64_tr_b16 v[22:23], v8 offset:4608
    ds_read_b64_tr_b16 v[24:25], v8 offset:8192
    ds_read_b64_tr_b16 v[26:27], v8 offset:8704
    ds_read_b64_tr_b16 v[28:29], v8 offset:12288
    ds_read_b64_tr_b16 v[30:31], v8 offset:12800
    ds_read_b64_tr_b16 v[32:33], v8 offset:16384
    ds_read_b64_tr_b16 v[34:35], v8 offset:16896
    ds_read_b64_tr_b16 v[36:37], v8 offset:20480
    ds_read_b64_tr_b16 v[38:39], v8 offset:20992
    ds_read_b64_tr_b16 v[40:41], v8 offset:24576
    ds_read_b64_tr_b16 v[42:43], v8 offset:25088
    ds_read_b64_tr_b16 v[44:45], v8 offset:28672
    ds_read_b64_tr_b16 v[46:47], v8 offset:29184
    ds_read_b64_tr_b16 v[48:49], v8 offset:32768
    ds_read_b64_tr_b16 v[50:51], v8 offset:33280
    ds_read_b64_tr_b16 v[52:53], v9 offset:0
    ds_read_b64_tr_b16 v[54:55], v9 offset:512
    ds_read_b64_tr_b16 v[56:57], v9 offset:4096
    ds_read_b64_tr_b16 v[58:59], v9 offset:4608
    ds_read_b64_tr_b16 v[60:61], v9 offset:8192
    ds_read_b64_tr_b16 v[62:63], v9 offset:8704
    ds_read_b64_tr_b16 v[64:65], v9 offset:12288
    ds_read_b64_tr_b16 v[66:67], v9 offset:12800
    ds_read_b64_tr_b16 v[68:69], v9 offset:16384
    ds_read_b64_tr_b16 v[70:71], v9 offset:16896
    ds_read_b64_tr_b16 v[72:73], v9 offset:20480
    ds_read_b64_tr_b16 v[74:75], v9 offset:20992
    ds_read_b64_tr_b16 v[76:77], v9 offset:24576
    ds_read_b64_tr_b16 v[78:79], v9 offset:25088
    ds_read_b64_tr_b16 v[80:81], v9 offset:28672
    ds_read_b64_tr_b16 v[82:83], v9 offset:29184
    ds_read_b64_tr_b16 v[84:85], v9 offset:32768
    ds_read_b64_tr_b16 v[86:87], v9 offset:33280
    v_lshrrev_b32 v126, 3, v1
    v_and_b32 v127, 7, v1
    v_xor_b32 v127, v127, v126
    v_mul_u32_u24 v126, 1152, v126
    v_lshl_add_u32 v126, v127, 4, v126
    v_add_u32 v127, 9216, v126
    s_mul_i32 s20, s6, 18432
    s_mov_b32 s21, s20
    s_mov_b32 m0, s20
    s_add_u32 s20, s20, 1024
    buffer_load_dwordx4 v126, s[48:51], s21 offen lds
    s_mov_b32 m0, s20
    s_add_u32 s20, s20, 1024
    buffer_load_dwordx4 v127, s[48:51], s21 offen lds
    s_add_u32 s21, s21, 128
    s_mov_b32 m0, s20
    s_add_u32 s20, s20, 1024
    buffer_load_dwordx4 v126, s[48:51], s21 offen lds
    s_mov_b32 m0, s20
    s_add_u32 s20, s20, 1024
    buffer_load_dwordx4 v127, s[48:51], s21 offen lds
    s_add_u32 s21, s21, 128
    s_mov_b32 m0, s20
    s_add_u32 s20, s20, 1024
    buffer_load_dwordx4 v126, s[48:51], s21 offen lds
    s_mov_b32 m0, s20
    s_add_u32 s20, s20, 1024
    buffer_load_dwordx4 v127, s[48:51], s21 offen lds
    s_add_u32 s21, s21, 128
    s_mov_b32 m0, s20
    s_add_u32 s20, s20, 1024
    buffer_load_dwordx4 v126, s[48:51], s21 offen lds
    s_mov_b32 m0, s20
    s_add_u32 s20, s20, 1024
    buffer_load_dwordx4 v127, s[48:51], s21 offen lds
    s_add_u32 s21, s21, 128
    s_mov_b32 m0, s20
    s_add_u32 s20, s20, 1024
    buffer_load_dwordx4 v126, s[48:51], s21 offen lds
    s_mov_b32 m0, s20
    s_add_u32 s20, s20, 1024
    buffer_load_dwordx4 v127, s[48:51], s21 offen lds
    s_add_u32 s21, s21, 128
    s_mov_b32 m0, s20
    s_add_u32 s20, s20, 1024
    buffer_load_dwordx4 v126, s[48:51], s21 offen lds
    s_mov_b32 m0, s20
    s_add_u32 s20, s20, 1024
    buffer_load_dwordx4 v127, s[48:51], s21 offen lds
    s_add_u32 s21, s21, 128
    s_mov_b32 m0, s20
    s_add_u32 s20, s20, 1024
    buffer_load_dwordx4 v126, s[48:51], s21 offen lds
    s_mov_b32 m0, s20
    s_add_u32 s20, s20, 1024
    buffer_load_dwordx4 v127, s[48:51], s21 offen lds
    s_add_u32 s21, s21, 128
    s_mov_b32 m0, s20
    s_add_u32 s20, s20, 1024
    buffer_load_dwordx4 v126, s[48:51], s21 offen lds
    s_mov_b32 m0, s20
    s_add_u32 s20, s20, 1024
    buffer_load_dwordx4 v127, s[48:51], s21 offen lds
    s_add_u32 s21, s21, 128
    s_mov_b32 m0, s20
    s_add_u32 s20, s20, 1024
    buffer_load_dwordx4 v126, s[48:51], s21 offen lds
    s_mov_b32 m0, s20
    s_add_u32 s20, s20, 1024
    buffer_load_dwordx4 v127, s[48:51], s21 offen lds
    s_add_u32 s21, s21, 128
L_k0_ctail:
    s_waitcnt lgkmcnt(15)
    v_mfma_f32_16x16x32_bf16 v[88:91], v[156:159], v[16:19], 0
    v_mfma_f32_16x16x32_bf16 v[88:91], v[156:159], v[20:23], v[88:91]
    v_mfma_f32_16x16x32_bf16 v[88:91], v[156:159], v[24:27], v[88:91]
    v_mfma_f32_16x16x32_bf16 v[88:91], v[156:159], v[28:31], v[88:91]
    v_mfma_f32_16x16x32_bf16 v[88:91], v[156:159], v[32:35], v[88:91]
    v_mfma_f32_16x16x32_bf16 v[88:91], v[156:159], v[36:39], v[88:91]
    v_mfma_f32_16x16x32_bf16 v[88:91], v[156:159], v[40:43], v[88:91]
    v_mfma_f32_16x16x32_bf16 v[88:91], v[156:159], v[44:47], v[88:91]
    v_mfma_f32_16x16x32_bf16 v[88:91], v[156:159], v[48:51], v[88:91]
    v_mfma_f32_16x16x32_bf16 v[88:91], v[156:159], v[52:55], v[88:91]
    s_waitcnt lgkmcnt(14)
    v_mfma_f32_16x16x32_bf16 v[88:91], v[156:159], v[56:59], v[88:91]
    s_waitcnt lgkmcnt(12)
    v_mfma_f32_16x16x32_bf16 v[88:91], v[156:159], v[60:63], v[88:91]
    s_waitcnt lgkmcnt(10)
    v_mfma_f32_16x16x32_bf16 v[88:91], v[156:159], v[64:67], v[88:91]
    s_waitcnt lgkmcnt(8)
    v_mfma_f32_16x16x32_bf16 v[88:91], v[156:159], v[68:71], v[88:91]
    s_waitcnt lgkmcnt(6)
    v_mfma_f32_16x16x32_bf16 v[88:91], v[156:159], v[72:75], v[88:91]
    s_waitcnt lgkmcnt(4)
    v_mfma_f32_16x16x32_bf16 v[88:91], v[156:159], v[76:79], v[88:91]
    s_waitcnt lgkmcnt(2)
    v_mfma_f32_16x16x32_bf16 v[88:91], v[156:159], v[80:83], v[88:91]
    s_waitcnt lgkmcnt(0)
    v_mfma_f32_16x16x32_bf16 v[88:91], v[156:159], v[84:87], v[88:91]
    s_nop 7
    v_mul_f32 v88, 3135475257, v88
    v_mul_f32 v89, 3135475257, v89
    v_mul_f32 v90, 3135475257, v90
    v_mul_f32 v91, 3135475257, v91
    s_mov_b32 s20, 0
    s_nop 0
    v_mfma_f32_16x16x32_bf16 v[92:95], v[152:155], v[16:19], v[88:91]
    v_mfma_f32_16x16x32_bf16 v[96:99], v[150:153], v[16:19], v[88:91]
    v_mfma_f32_16x16x32_bf16 v[100:103], v[152:155], v[20:23], v[88:91]
    v_mfma_f32_16x16x32_bf16 v[104:107], v[150:153], v[20:23], v[88:91]
    v_mfma_f32_16x16x32_bf16 v[108:111], v[152:155], v[24:27], v[88:91]
    v_mfma_f32_16x16x32_bf16 v[112:115], v[150:153], v[24:27], v[88:91]
    s_nop 2
    v_cvt_pk_bf16_f32 v16, v92, v93
    v_cvt_pk_bf16_f32 v17, v94, v95
    v_cvt_pk_bf16_f32 v18, v96, v97
    v_cvt_pk_bf16_f32 v19, v98, v99
    buffer_store_dwordx4 v[16:19], v2, s[12:15], s20 offen sc1
    s_add_u32 s20, s20, s17
    v_mfma_f32_16x16x32_bf16 v[92:95], v[152:155], v[28:31], v[88:91]
    v_mfma_f32_16x16x32_bf16 v[96:99], v[150:153], v[28:31], v[88:91]
    v_cvt_pk_bf16_f32 v20, v100, v101
    v_cvt_pk_bf16_f32 v21, v102, v103
    v_cvt_pk_bf16_f32 v22, v104, v105
    v_cvt_pk_bf16_f32 v23, v106, v107
    buffer_store_dwordx4 v[20:23], v2, s[12:15], s20 offen sc1
    s_add_u32 s20, s20, s17
    v_mfma_f32_16x16x32_bf16 v[100:103], v[152:155], v[32:35], v[88:91]
    v_mfma_f32_16x16x32_bf16 v[104:107], v[150:153], v[32:35], v[88:91]
    v_cvt_pk_bf16_f32 v24, v108, v109
    v_cvt_pk_bf16_f32 v25, v110, v111
    v_cvt_pk_bf16_f32 v26, v112, v113
    v_cvt_pk_bf16_f32 v27, v114, v115
    buffer_store_dwordx4 v[24:27], v2, s[12:15], s20 offen sc1
    s_add_u32 s20, s20, s17
    v_mfma_f32_16x16x32_bf16 v[108:111], v[152:155], v[36:39], v[88:91]
    v_mfma_f32_16x16x32_bf16 v[112:115], v[150:153], v[36:39], v[88:91]
    v_cvt_pk_bf16_f32 v28, v92, v93
    v_cvt_pk_bf16_f32 v29, v94, v95
    v_cvt_pk_bf16_f32 v30, v96, v97
    v_cvt_pk_bf16_f32 v31, v98, v99
    buffer_store_dwordx4 v[28:31], v2, s[12:15], s20 offen sc1
    s_add_u32 s20, s20, s17
    v_mfma_f32_16x16x32_bf16 v[92:95], v[152:155], v[40:43], v[88:91]
    v_mfma_f32_16x16x32_bf16 v[96:99], v[150:153], v[40:43], v[88:91]
    v_cvt_pk_bf16_f32 v32, v100, v101
    v_cvt_pk_bf16_f32 v33, v102, v103
    v_cvt_pk_bf16_f32 v34, v104, v105
    v_cvt_pk_bf16_f32 v35, v106, v107
    buffer_store_dwordx4 v[32:35], v2, s[12:15], s20 offen sc1
    s_add_u32 s20, s20, s17
    v_mfma_f32_16x16x32_bf16 v[100:103], v[152:155], v[44:47], v[88:91]
    v_mfma_f32_16x16x32_bf16 v[104:107], v[150:153], v[44:47], v[88:91]
    v_cvt_pk_bf16_f32 v36, v108, v109
    v_cvt_pk_bf16_f32 v37, v110, v111
    v_cvt_pk_bf16_f32 v38, v112, v113
    v_cvt_pk_bf16_f32 v39, v114, v115
    buffer_store_dwordx4 v[36:39], v2, s[12:15], s20 offen sc1
    s_add_u32 s20, s20, s17
    v_mfma_f32_16x16x32_bf16 v[108:111], v[152:155], v[48:51], v[88:91]
    v_mfma_f32_16x16x32_bf16 v[112:115], v[150:153], v[48:51], v[88:91]
    v_cvt_pk_bf16_f32 v40, v92, v93
    v_cvt_pk_bf16_f32 v41, v94, v95
    v_cvt_pk_bf16_f32 v42, v96, v97
    v_cvt_pk_bf16_f32 v43, v98, v99
    buffer_store_dwordx4 v[40:43], v2, s[12:15], s20 offen sc1
    s_add_u32 s20, s20, s17
    v_mfma_f32_16x16x32_bf16 v[92:95], v[152:155], v[52:55], v[88:91]
    v_mfma_f32_16x16x32_bf16 v[96:99], v[150:153], v[52:55], v[88:91]
    v_cvt_pk_bf16_f32 v44, v100, v101
    v_cvt_pk_bf16_f32 v45, v102, v103
    v_cvt_pk_bf16_f32 v46, v104, v105
    v_cvt_pk_bf16_f32 v47, v106, v107
    buffer_store_dwordx4 v[44:47], v2, s[12:15], s20 offen sc1
    s_add_u32 s20, s20, s17
    v_mfma_f32_16x16x32_bf16 v[100:103], v[152:155], v[56:59], v[88:91]
    v_mfma_f32_16x16x32_bf16 v[104:107], v[150:153], v[56:59], v[88:91]
    v_cvt_pk_bf16_f32 v48, v108, v109
    v_cvt_pk_bf16_f32 v49, v110, v111
    v_cvt_pk_bf16_f32 v50, v112, v113
    v_cvt_pk_bf16_f32 v51, v114, v115
    buffer_store_dwordx4 v[48:51], v2, s[12:15], s20 offen sc1
    s_add_u32 s20, s20, s17
    v_mfma_f32_16x16x32_bf16 v[108:111], v[152:155], v[60:63], v[88:91]
    v_mfma_f32_16x16x32_bf16 v[112:115], v[150:153], v[60:63], v[88:91]
    v_cvt_pk_bf16_f32 v52, v92, v93
    v_cvt_pk_bf16_f32 v53, v94, v95
    v_cvt_pk_bf16_f32 v54, v96, v97
    v_cvt_pk_bf16_f32 v55, v98, v99
    buffer_store_dwordx4 v[52:55], v2, s[12:15], s20 offen sc1
    s_add_u32 s20, s20, s17
    v_mfma_f32_16x16x32_bf16 v[92:95], v[152:155], v[64:67], v[88:91]
    v_mfma_f32_16x16x32_bf16 v[96:99], v[150:153], v[64:67], v[88:91]
    v_cvt_pk_bf16_f32 v56, v100, v101
    v_cvt_pk_bf16_f32 v57, v102, v103
    v_cvt_pk_bf16_f32 v58, v104, v105
    v_cvt_pk_bf16_f32 v59, v106, v107
    buffer_store_dwordx4 v[56:59], v2, s[12:15], s20 offen sc1
    s_add_u32 s20, s20, s17
    v_mfma_f32_16x16x32_bf16 v[100:103], v[152:155], v[68:71], v[88:91]
    v_mfma_f32_16x16x32_bf16 v[104:107], v[150:153], v[68:71], v[88:91]
    v_cvt_pk_bf16_f32 v60, v108, v109
    v_cvt_pk_bf16_f32 v61, v110, v111
    v_cvt_pk_bf16_f32 v62, v112, v113
    v_cvt_pk_bf16_f32 v63, v114, v115
    buffer_store_dwordx4 v[60:63], v2, s[12:15], s20 offen sc1
    s_add_u32 s20, s20, s17
    v_mfma_f32_16x16x32_bf16 v[108:111], v[152:155], v[72:75], v[88:91]
    v_mfma_f32_16x16x32_bf16 v[112:115], v[150:153], v[72:75], v[88:91]
    v_cvt_pk_bf16_f32 v64, v92, v93
    v_cvt_pk_bf16_f32 v65, v94, v95
    v_cvt_pk_bf16_f32 v66, v96, v97
    v_cvt_pk_bf16_f32 v67, v98, v99
    buffer_store_dwordx4 v[64:67], v2, s[12:15], s20 offen sc1
    s_add_u32 s20, s20, s17
    v_mfma_f32_16x16x32_bf16 v[92:95], v[152:155], v[76:79], v[88:91]
    v_mfma_f32_16x16x32_bf16 v[96:99], v[150:153], v[76:79], v[88:91]
    v_cvt_pk_bf16_f32 v68, v100, v101
    v_cvt_pk_bf16_f32 v69, v102, v103
    v_cvt_pk_bf16_f32 v70, v104, v105
    v_cvt_pk_bf16_f32 v71, v106, v107
    buffer_store_dwordx4 v[68:71], v2, s[12:15], s20 offen sc1
    s_add_u32 s20, s20, s17
    v_mfma_f32_16x16x32_bf16 v[100:103], v[152:155], v[80:83], v[88:91]
    v_mfma_f32_16x16x32_bf16 v[104:107], v[150:153], v[80:83], v[88:91]
    v_cvt_pk_bf16_f32 v72, v108, v109
    v_cvt_pk_bf16_f32 v73, v110, v111
    v_cvt_pk_bf16_f32 v74, v112, v113
    v_cvt_pk_bf16_f32 v75, v114, v115
    buffer_store_dwordx4 v[72:75], v2, s[12:15], s20 offen sc1
    s_add_u32 s20, s20, s17
    v_mfma_f32_16x16x32_bf16 v[108:111], v[152:155], v[84:87], v[88:91]
    v_mfma_f32_16x16x32_bf16 v[112:115], v[150:153], v[84:87], v[88:91]
    v_cvt_pk_bf16_f32 v76, v92, v93
    v_cvt_pk_bf16_f32 v77, v94, v95
    v_cvt_pk_bf16_f32 v78, v96, v97
    v_cvt_pk_bf16_f32 v79, v98, v99
    buffer_store_dwordx4 v[76:79], v2, s[12:15], s20 offen sc1
    s_add_u32 s20, s20, s17
    v_cvt_pk_bf16_f32 v80, v100, v101
    v_cvt_pk_bf16_f32 v81, v102, v103
    v_cvt_pk_bf16_f32 v82, v104, v105
    v_cvt_pk_bf16_f32 v83, v106, v107
    buffer_store_dwordx4 v[80:83], v2, s[12:15], s20 offen sc1
    s_add_u32 s20, s20, s17
    v_cvt_pk_bf16_f32 v84, v108, v109
    v_cvt_pk_bf16_f32 v85, v110, v111
    v_cvt_pk_bf16_f32 v86, v112, v113
    v_cvt_pk_bf16_f32 v87, v114, v115
    buffer_store_dwordx4 v[84:87], v2, s[12:15], s20 offen sc1
    s_add_u32 s20, s20, s17
    s_cmp_ge_u32 s2, 24
    s_cbranch_scc1 L_k0_w18
    s_waitcnt vmcnt(0)
    s_mov_b32 s22, s2
    s_branch L_k0_sig
L_k0_bc:
    s_lshr_b32 s20, s6, 1
    s_lshl_b32 s20, s20, 2
    v_add_u32 v11, s20, v5
    s_and_b32 s21, s6, 1
    s_lshl_b32 s21, s21, 3
    s_add_u32 s21, s21, 73728
    v_lshl_add_u32 v8, v3, 2, v4
    v_lshlrev_b32 v8, 7, v8
    v_and_b32 v10, 2, v4
    v_lshlrev_b32 v10, 1, v10
    v_xor_b32 v9, v11, v10
    v_lshl_add_u32 v8, v9, 4, v8
    v_add_u32 v8, s21, v8
    v_add_u32 v9, 36864, v8
    s_cmp_ge_u32 s2, 168
    s_cbranch_scc1 L_k0_wo
    s_waitcnt vmcnt(0)
    s_barrier
    buffer_load_dword v121, v120, s[52:55], 0 offen sc1
    ds_read_b64_tr_b16 v[16:17], v8 offset:0
    ds_read_b64_tr_b16 v[18:19], v8 offset:2048
    ds_read_b64_tr_b16 v[20:21], v8 offset:18432
    ds_read_b64_tr_b16 v[22:23], v8 offset:20480
    ds_read_b64_tr_b16 v[24:25], v9 offset:0
    ds_read_b64_tr_b16 v[26:27], v9 offset:2048
    ds_read_b64_tr_b16 v[28:29], v9 offset:18432
    ds_read_b64_tr_b16 v[30:31], v9 offset:20480
    ds_read_b64_tr_b16 v[32:33], v8 offset:4096
    ds_read_b64_tr_b16 v[34:35], v8 offset:6144
    ds_read_b64_tr_b16 v[36:37], v8 offset:22528
    ds_read_b64_tr_b16 v[38:39], v8 offset:24576
    ds_read_b64_tr_b16 v[40:41], v9 offset:4096
    ds_read_b64_tr_b16 v[42:43], v9 offset:6144
    ds_read_b64_tr_b16 v[44:45], v9 offset:22528
    ds_read_b64_tr_b16 v[46:47], v9 offset:24576
    ds_read_b64_tr_b16 v[48:49], v8 offset:8192
    ds_read_b64_tr_b16 v[50:51], v8 offset:10240
    ds_read_b64_tr_b16 v[52:53], v8 offset:26624
    ds_read_b64_tr_b16 v[54:55], v8 offset:28672
    ds_read_b64_tr_b16 v[56:57], v9 offset:8192
    ds_read_b64_tr_b16 v[58:59], v9 offset:10240
    ds_read_b64_tr_b16 v[60:61], v9 offset:26624
    ds_read_b64_tr_b16 v[62:63], v9 offset:28672
    ds_read_b64_tr_b16 v[64:65], v8 offset:12288
    ds_read_b64_tr_b16 v[66:67], v8 offset:14336
    ds_read_b64_tr_b16 v[68:69], v8 offset:30720
    ds_read_b64_tr_b16 v[70:71], v8 offset:32768
    ds_read_b64_tr_b16 v[72:73], v9 offset:12288
    ds_read_b64_tr_b16 v[74:75], v9 offset:14336
    ds_read_b64_tr_b16 v[76:77], v9 offset:30720
    ds_read_b64_tr_b16 v[78:79], v9 offset:32768
    ds_read_b64_tr_b16 v[80:81], v8 offset:16384
    ds_read_b64_tr_b16 v[82:83], v8 offset:34816
    ds_read_b64_tr_b16 v[84:85], v9 offset:16384
    ds_read_b64_tr_b16 v[86:87], v9 offset:34816
L_k0_ptail:
    v_lshrrev_b32 v126, 3, v1
    v_and_b32 v127, 7, v1
    v_xor_b32 v127, v127, v126
    v_mul_u32_u24 v126, 1152, v126
    v_lshl_add_u32 v126, v127, 4, v126
    v_add_u32 v127, 9216, v126
    s_mul_i32 s20, s6, 18432
    s_mov_b32 s21, s20
    s_mov_b32 m0, s20
    s_add_u32 s20, s20, 1024
    buffer_load_dwordx4 v126, s[48:51], s21 offen lds
    s_mov_b32 m0, s20
    s_add_u32 s20, s20, 1024
    buffer_load_dwordx4 v127, s[48:51], s21 offen lds
    s_add_u32 s21, s21, 128
    s_mov_b32 m0, s20
    s_add_u32 s20, s20, 1024
    buffer_load_dwordx4 v126, s[48:51], s21 offen lds
    s_mov_b32 m0, s20
    s_add_u32 s20, s20, 1024
    buffer_load_dwordx4 v127, s[48:51], s21 offen lds
    s_add_u32 s21, s21, 128
    s_mov_b32 m0, s20
    s_add_u32 s20, s20, 1024
    buffer_load_dwordx4 v126, s[48:51], s21 offen lds
    s_mov_b32 m0, s20
    s_add_u32 s20, s20, 1024
    buffer_load_dwordx4 v127, s[48:51], s21 offen lds
    s_add_u32 s21, s21, 128
    s_mov_b32 m0, s20
    s_add_u32 s20, s20, 1024
    buffer_load_dwordx4 v126, s[48:51], s21 offen lds
    s_mov_b32 m0, s20
    s_add_u32 s20, s20, 1024
    buffer_load_dwordx4 v127, s[48:51], s21 offen lds
    s_add_u32 s21, s21, 128
    s_mov_b32 m0, s20
    s_add_u32 s20, s20, 1024
    buffer_load_dwordx4 v126, s[48:51], s21 offen lds
    s_mov_b32 m0, s20
    s_add_u32 s20, s20, 1024
    buffer_load_dwordx4 v127, s[48:51], s21 offen lds
    s_add_u32 s21, s21, 128
    s_mov_b32 m0, s20
    s_add_u32 s20, s20, 1024
    buffer_load_dwordx4 v126, s[48:51], s21 offen lds
    s_mov_b32 m0, s20
    s_add_u32 s20, s20, 1024
    buffer_load_dwordx4 v127, s[48:51], s21 offen lds
    s_add_u32 s21, s21, 128
    s_mov_b32 m0, s20
    s_add_u32 s20, s20, 1024
    buffer_load_dwordx4 v126, s[48:51], s21 offen lds
    s_mov_b32 m0, s20
    s_add_u32 s20, s20, 1024
    buffer_load_dwordx4 v127, s[48:51], s21 offen lds
    s_add_u32 s21, s21, 128
    s_mov_b32 m0, s20
    s_add_u32 s20, s20, 1024
    buffer_load_dwordx4 v126, s[48:51], s21 offen lds
    s_mov_b32 m0, s20
    s_add_u32 s20, s20, 1024
    buffer_load_dwordx4 v127, s[48:51], s21 offen lds
    s_add_u32 s21, s21, 128
    s_mov_b32 m0, s20
    s_add_u32 s20, s20, 1024
    buffer_load_dwordx4 v126, s[48:51], s21 offen lds
    s_mov_b32 m0, s20
    s_add_u32 s20, s20, 1024
    buffer_load_dwordx4 v127, s[48:51], s21 offen lds
    s_add_u32 s21, s21, 128
    s_mov_b32 s20, 0
    s_waitcnt lgkmcnt(15)
    buffer_store_dwordx4 v[16:19], v2, s[12:15], s20 offen sc1
    s_add_u32 s20, s20, s17
    buffer_store_dwordx4 v[20:23], v2, s[12:15], s20 offen sc1
    s_add_u32 s20, s20, s17
    buffer_store_dwordx4 v[24:27], v2, s[12:15], s20 offen sc1
    s_add_u32 s20, s20, s17
    buffer_store_dwordx4 v[28:31], v2, s[12:15], s20 offen sc1
    s_add_u32 s20, s20, s17
    buffer_store_dwordx4 v[32:35], v2, s[12:15], s20 offen sc1
    s_add_u32 s20, s20, s17
    buffer_store_dwordx4 v[36:39], v2, s[12:15], s20 offen sc1
    s_add_u32 s20, s20, s17
    buffer_store_dwordx4 v[40:43], v2, s[12:15], s20 offen sc1
    s_add_u32 s20, s20, s17
    buffer_store_dwordx4 v[44:47], v2, s[12:15], s20 offen sc1
    s_add_u32 s20, s20, s17
    buffer_store_dwordx4 v[48:51], v2, s[12:15], s20 offen sc1
    s_add_u32 s20, s20, s17
    buffer_store_dwordx4 v[52:55], v2, s[12:15], s20 offen sc1
    s_add_u32 s20, s20, s17
    s_waitcnt lgkmcnt(14)
    buffer_store_dwordx4 v[56:59], v2, s[12:15], s20 offen sc1
    s_add_u32 s20, s20, s17
    s_waitcnt lgkmcnt(12)
    buffer_store_dwordx4 v[60:63], v2, s[12:15], s20 offen sc1
    s_add_u32 s20, s20, s17
    s_waitcnt lgkmcnt(10)
    buffer_store_dwordx4 v[64:67], v2, s[12:15], s20 offen sc1
    s_add_u32 s20, s20, s17
    s_waitcnt lgkmcnt(8)
    buffer_store_dwordx4 v[68:71], v2, s[12:15], s20 offen sc1
    s_add_u32 s20, s20, s17
    s_waitcnt lgkmcnt(6)
    buffer_store_dwordx4 v[72:75], v2, s[12:15], s20 offen sc1
    s_add_u32 s20, s20, s17
    s_waitcnt lgkmcnt(4)
    buffer_store_dwordx4 v[76:79], v2, s[12:15], s20 offen sc1
    s_add_u32 s20, s20, s17
    s_waitcnt lgkmcnt(2)
    buffer_store_dwordx4 v[80:83], v2, s[12:15], s20 offen sc1
    s_add_u32 s20, s20, s17
    s_waitcnt lgkmcnt(0)
    buffer_store_dwordx4 v[84:87], v2, s[12:15], s20 offen sc1
    s_add_u32 s20, s20, s17
    s_cmp_lt_u32 s2, 168
    s_cbranch_scc1 L_k0_w18
    s_waitcnt vmcnt(0)
    s_sub_u32 s22, s2, 144
    s_branch L_k0_sig
L_k0_wo:
    v_lshl_add_u32 v8, v4, 2, v3
    v_lshlrev_b32 v8, 7, v8
    v_and_b32 v10, 2, v3
    v_lshlrev_b32 v10, 1, v10
    v_xor_b32 v9, v11, v10
    v_lshl_add_u32 v8, v9, 4, v8
    v_add_u32 v8, s21, v8
    v_add_u32 v9, 36864, v8
    v_lshrrev_b32 v10, 1, v4
    v_mul_u32_u24 v10, 72, v10
    v_mul_u32_u24 v12, 18, v3
    v_add_u32 v10, v10, v12
    v_and_b32 v12, 1, v3
    v_xor_b32 v12, 1, v12
    v_lshl_add_u32 v10, v12, 4, v10
    v_and_b32 v12, 1, v4
    v_add_u32 v10, v10, v12
    v_and_b32 v12, 2, v10
    v_lshlrev_b32 v12, 1, v12
    v_xor_b32 v12, v11, v12
    v_lshlrev_b32 v10, 7, v10
    v_lshl_add_u32 v10, v12, 4, v10
    v_add_u32 v10, s21, v10
    s_waitcnt vmcnt(0)
    s_barrier
    buffer_load_dword v121, v120, s[52:55], 0 offen sc1
    ds_read_b64_tr_b16 v[16:17], v8 offset:0
    ds_read_b64_tr_b16 v[18:19], v8 offset:2560
    ds_read_b64_tr_b16 v[20:21], v8 offset:4608
    ds_read_b64_tr_b16 v[22:23], v8 offset:7168
    ds_read_b64_tr_b16 v[24:25], v8 offset:9216
    ds_read_b64_tr_b16 v[26:27], v8 offset:11776
    ds_read_b64_tr_b16 v[28:29], v8 offset:13824
    ds_read_b64_tr_b16 v[30:31], v8 offset:16384
    ds_read_b64_tr_b16 v[32:33], v8 offset:18432
    ds_read_b64_tr_b16 v[34:35], v8 offset:20992
    ds_read_b64_tr_b16 v[36:37], v8 offset:23040
    ds_read_b64_tr_b16 v[38:39], v8 offset:25600
    ds_read_b64_tr_b16 v[40:41], v8 offset:27648
    ds_read_b64_tr_b16 v[42:43], v8 offset:30208
    ds_read_b64_tr_b16 v[44:45], v8 offset:32256
    ds_read_b64_tr_b16 v[46:47], v8 offset:34816
    ds_read_b64_tr_b16 v[48:49], v9 offset:0
    ds_read_b64_tr_b16 v[50:51], v9 offset:2560
    ds_read_b64_tr_b16 v[52:53], v9 offset:4608
    ds_read_b64_tr_b16 v[54:55], v9 offset:7168
    ds_read_b64_tr_b16 v[56:57], v9 offset:9216
    ds_read_b64_tr_b16 v[58:59], v9 offset:11776
    ds_read_b64_tr_b16 v[60:61], v9 offset:13824
    ds_read_b64_tr_b16 v[62:63], v9 offset:16384
    ds_read_b64_tr_b16 v[64:65], v9 offset:18432
    ds_read_b64_tr_b16 v[66:67], v9 offset:20992
    ds_read_b64_tr_b16 v[68:69], v9 offset:23040
    ds_read_b64_tr_b16 v[70:71], v9 offset:25600
    ds_read_b64_tr_b16 v[72:73], v9 offset:27648
    ds_read_b64_tr_b16 v[74:75], v9 offset:30208
    ds_read_b64_tr_b16 v[76:77], v9 offset:32256
    ds_read_b64_tr_b16 v[78:79], v9 offset:34816
    ds_read_b64_tr_b16 v[80:81], v10 offset:0
    ds_read_b64_tr_b16 v[82:83], v10 offset:18432
    ds_read_b64_tr_b16 v[84:85], v10 offset:36864
    ds_read_b64_tr_b16 v[86:87], v10 offset:55296
    s_branch L_k0_ptail
L_k0_qkv:
    s_mov_b32 s22, 7282
    s_add_u32 s20, s6, 0
    s_lshl_b32 s20, s20, 6
    v_add_u32 v9, s20, v1
    v_mul_lo_u32 v10, v9, s22
    v_lshrrev_b32 v10, 16, v10
    v_mul_u32_u24 v11, 9, v10
    v_sub_u32 v9, v9, v11
    v_mul_u32_u24 v10, 3456, v10
    v_lshl_add_u32 v6, v9, 4, v10
    s_add_u32 s20, s6, 4
    s_lshl_b32 s20, s20, 6
    v_add_u32 v9, s20, v1
    v_mul_lo_u32 v10, v9, s22
    v_lshrrev_b32 v10, 16, v10
    v_mul_u32_u24 v11, 9, v10
    v_sub_u32 v9, v9, v11
    v_mul_u32_u24 v10, 3456, v10
    v_lshl_add_u32 v7, v9, 4, v10
    v_add_u32 v9, 512, v1
    v_mul_lo_u32 v10, v9, s22
    v_lshrrev_b32 v10, 16, v10
    v_mul_u32_u24 v11, 9, v10
    v_sub_u32 v9, v9, v11
    v_mul_u32_u24 v10, 3456, v10
    v_lshl_add_u32 v8, v9, 4, v10
    s_waitcnt lgkmcnt(0)
    s_add_u32 s8, s26, 0
    s_addc_u32 s9, s27, 0
    s_and_b32 s9, s9, 0xffff
    s_mov_b32 s10, 1990656
    s_mov_b32 s11, 0x20000
    s_mul_i32 s20, s7, 73728
    s_add_u32 s48, s24, s20
    s_addc_u32 s49, s25, 0
    s_and_b32 s49, s49, 0xffff
    s_mov_b32 s50, 73728
    s_mov_b32 s51, 0x20000
    s_cmp_ge_u32 s6, 2
    s_cbranch_scc1 L_ftx2
    s_lshl_b32 s20, s6, 6
    v_add_u32 v126, s20, v1
    v_min_u32 v126, 89, v126
    v_mul_u32_u24 v127, 205, v126
    v_lshrrev_b32 v127, 10, v127
    v_mul_u32_u24 v125, 5, v127
    v_sub_u32 v126, v126, v125
    v_lshlrev_b32 v126, 7, v126
    v_min_u32 v126, 428, v126
    v_mul_u32_u24 v127, 3456, v127
    v_add_u32 v126, v126, v127
    s_and_b32 s20, s2, 7
    s_mul_i32 s20, s20, 432
    s_lshr_b32 s21, s2, 3
    s_mul_i32 s21, s21, 62208
    s_add_u32 s20, s20, s21
    buffer_load_dword v125, v126, s[8:11], s20 offen
    s_branch L_ftd2
L_ftx2:
    v_min_u32 v126, 35, v1
    v_lshlrev_b32 v126, 7, v126
    s_lshl_b32 s20, s3, 1
    s_add_u32 s20, s20, s6
    s_sub_u32 s20, s20, 2
    s_mul_i32 s20, s20, 4608
    buffer_load_dword v125, v126, s[48:51], s20 offen
L_ftd2:
    s_lshl_b32 s36, s6, 10
    s_add_u32 s36, s36, 73728
    s_mov_b32 s37, s18
    s_add_u32 m0, s36, 0
    s_nop 0
    buffer_load_dwordx4 v6, s[8:11], s37 offen lds
    s_add_u32 m0, s36, 4096
    s_nop 0
    buffer_load_dwordx4 v7, s[8:11], s37 offen lds
    s_add_u32 s37, s37, 221184
    s_add_u32 m0, s36, 9216
    s_nop 0
    buffer_load_dwordx4 v6, s[8:11], s37 offen lds
    s_add_u32 m0, s36, 13312
    s_nop 0
    buffer_load_dwordx4 v7, s[8:11], s37 offen lds
    s_add_u32 s37, s37, 221184
    s_add_u32 m0, s36, 18432
    s_nop 0
    buffer_load_dwordx4 v6, s[8:11], s37 offen lds
    s_add_u32 m0, s36, 22528
    s_nop 0
    buffer_load_dwordx4 v7, s[8:11], s37 offen lds
    s_add_u32 s37, s37, 221184
    s_add_u32 m0, s36, 27648
    s_nop 0
    buffer_load_dwordx4 v6, s[8:11], s37 offen lds
    s_add_u32 m0, s36, 31744
    s_nop 0
    buffer_load_dwordx4 v7, s[8:11], s37 offen lds
    s_add_u32 s37, s37, 221184
    s_add_u32 m0, s36, 36864
    s_nop 0
    buffer_load_dwordx4 v6, s[8:11], s37 offen lds
    s_add_u32 m0, s36, 40960
    s_nop 0
    buffer_load_dwordx4 v7, s[8:11], s37 offen lds
    s_add_u32 s37, s37, 221184
    s_add_u32 m0, s36, 46080
    s_nop 0
    buffer_load_dwordx4 v6, s[8:11], s37 offen lds
    s_add_u32 m0, s36, 50176
    s_nop 0
    buffer_load_dwordx4 v7, s[8:11], s37 offen lds
    s_add_u32 s37, s37, 221184
    s_add_u32 m0, s36, 55296
    s_nop 0
    buffer_load_dwordx4 v6, s[8:11], s37 offen lds
    s_add_u32 m0, s36, 59392
    s_nop 0
    buffer_load_dwordx4 v7, s[8:11], s37 offen lds
    s_add_u32 s37, s37, 221184
    s_add_u32 m0, s36, 64512
    s_nop 0
    buffer_load_dwordx4 v6, s[8:11], s37 offen lds
    s_add_u32 m0, s36, 68608
    s_nop 0
    buffer_load_dwordx4 v7, s[8:11], s37 offen lds
    s_add_u32 s37, s37, 221184
    s_add_u32 m0, s36, 73728
    s_nop 0
    buffer_load_dwordx4 v6, s[8:11], s37 offen lds
    s_add_u32 m0, s36, 77824
    s_nop 0
    buffer_load_dwordx4 v7, s[8:11], s37 offen lds
    s_add_u32 s37, s37, 221184
    s_mul_i32 s36, s6, 9216
    s_add_u32 s36, s36, 73728
    s_mul_i32 s37, s6, 221184
    s_add_u32 s37, s37, s18
    s_add_u32 m0, s36, 8192
    s_nop 0
    buffer_load_dwordx4 v8, s[8:11], s37 offen lds
    s_add_u32 s37, s37, 884736
    s_add_u32 m0, s36, 45056
    s_nop 0
    buffer_load_dwordx4 v8, s[8:11], s37 offen lds
    s_add_u32 s37, s37, 884736
    s_cmp_lg_u32 s6, 0
    s_cbranch_scc1 L_k0_q1
    s_add_u32 m0, s36, 81920
    s_nop 0
    buffer_load_dwordx4 v8, s[8:11], s37 offen lds
    s_add_u32 s37, s37, 884736
L_k0_q1:
    s_add_u32 s52, s30, 0
    s_addc_u32 s53, s31, 0
    s_and_b32 s53, s53, 0xffff
    s_mov_b32 s54, 256
    s_mov_b32 s55, 0x20000
    s_add_u32 s56, s4, 13697024
    s_addc_u32 s57, s5, 0
    s_and_b32 s57, s57, 0xffff
    s_mov_b32 s58, 196608
    s_mov_b32 s59, 0x20000
    v_min_u32 v120, 5, v1
    v_lshlrev_b32 v120, 2, v120
    v_and_b32 v122, 15, v1
    v_lshrrev_b32 v123, 4, v1
    v_lshlrev_b32 v123, 2, v123
    v_sub_u32 v122, v122, v123
    v_mov_b32 v150, 0
    v_mov_b32 v151, 0
    v_mov_b32 v152, 0
    v_mov_b32 v153, 0
    v_mov_b32 v154, 0
    v_mov_b32 v155, 0
    v_cmp_eq_u32 vcc, 0, v122
    v_mov_b32 v123, 16256
    v_mov_b32 v156, 0x3f803f80
    v_cndmask_b32 v152, v152, v123, vcc
    v_cmp_eq_u32 vcc, 1, v122
    v_mov_b32 v123, 1065353216
    v_mov_b32 v157, 0x3f803f80
    v_cndmask_b32 v152, v152, v123, vcc
    v_cmp_eq_u32 vcc, 2, v122
    v_mov_b32 v123, 16256
    v_mov_b32 v158, 0x3f803f80
    v_cndmask_b32 v153, v153, v123, vcc
    v_cmp_eq_u32 vcc, 3, v122
    v_mov_b32 v123, 1065353216
    v_mov_b32 v159, 0x3f803f80
    v_cndmask_b32 v153, v153, v123, vcc
    s_add_u32 s12, s4, s16
    s_addc_u32 s13, s5, 0
    s_and_b32 s13, s13, 0xffff
    s_mov_b32 s14, 73728
    s_mov_b32 s15, 0x20000
    s_add_u32 s40, s4, s19
    s_addc_u32 s41, s5, 0
    s_and_b32 s41, s41, 0xffff
    s_mov_b32 s42, 2304
    s_mov_b32 s43, 0x20000
    v_lshl_add_u32 v10, v3, 3, v4
    v_mul_u32_u24 v10, 144, v10
    s_mul_i32 s20, s6, 36
    s_and_b32 s21, s6, 1
    s_lshl_b32 s22, s21, 2
    s_add_u32 s20, s20, s22
    s_add_u32 s20, s20, 73728
    v_lshl_add_u32 v8, v5, 3, v10
    v_add_u32 v8, s20, v8
    v_add_u32 v9, 41472, v8
    s_lshr_b32 s20, s6, 1
    s_mul_i32 s20, s20, 72
    s_add_u32 s20, s20, 73760
    v_mul_u32_u24 v11, 4608, v5
    v_add3_u32 v10, v10, v11, s20
    v_and_b32 v11, 1, v5
    v_mul_u32_u24 v11, 4608, v11
    v_lshl_add_u32 v7, v3, 3, v4
    v_mul_u32_u24 v7, 144, v7
    v_add3_u32 v11, v7, v11, s20
    v_add_u32 v11, 73728, v11
    v_and_b32 v6, 1, v5
    v_lshl_add_u32 v6, v3, 1, v6
    v_lshlrev_b32 v6, 4, v6
    v_lshl_add_u32 v6, v4, 7, v6
    s_lshl_b32 s21, s21, 1
    s_mov_b32 s44, 0x33333333
    s_lshl_b32 s44, s44, s21
    s_mov_b32 s45, s44
    s_mov_b32 s46, 0x00ff00ff
    s_mov_b32 s47, 0x00ff00ff
    s_waitcnt vmcnt(0)
    s_barrier
    buffer_load_dword v121, v120, s[52:55], 0 offen sc1
    ds_read_b64_tr_b16 v[128:129], v10 offset:0
    ds_read_b64_tr_b16 v[130:131], v10 offset:576
    ds_read_b64_tr_b16 v[132:133], v10 offset:18432
    ds_read_b64_tr_b16 v[134:135], v10 offset:19008
    ds_read_b64_tr_b16 v[136:137], v10 offset:36864
    ds_read_b64_tr_b16 v[138:139], v10 offset:37440
    ds_read_b64_tr_b16 v[140:141], v10 offset:55296
    ds_read_b64_tr_b16 v[142:143], v10 offset:55872
    ds_read_b64_tr_b16 v[144:145], v11 offset:0
    ds_read_b64_tr_b16 v[146:147], v11 offset:576
    s_waitcnt lgkmcnt(0)
    v_cndmask_b32 v144, 0, v144, s[46:47]
    v_cndmask_b32 v145, 0, v145, s[46:47]
    v_cndmask_b32 v146, 0, v146, s[46:47]
    v_cndmask_b32 v147, 0, v147, s[46:47]
    v_mfma_f32_16x16x32_bf16 v[88:91], v[156:159], v[128:131], 0
    v_mfma_f32_16x16x32_bf16 v[88:91], v[156:159], v[132:135], v[88:91]
    v_mfma_f32_16x16x32_bf16 v[88:91], v[156:159], v[136:139], v[88:91]
    v_mfma_f32_16x16x32_bf16 v[88:91], v[156:159], v[140:143], v[88:91]
    v_mfma_f32_16x16x32_bf16 v[88:91], v[156:159], v[144:147], v[88:91]
    ds_read_b64_tr_b16 v[16:17], v8 offset:0
    ds_read_b64_tr_b16 v[18:19], v8 offset:576
    ds_read_b64_tr_b16 v[20:21], v8 offset:4608
    ds_read_b64_tr_b16 v[22:23], v8 offset:5184
    ds_read_b64_tr_b16 v[24:25], v8 offset:9216
    ds_read_b64_tr_b16 v[26:27], v8 offset:9792
    ds_read_b64_tr_b16 v[28:29], v8 offset:13824
    ds_read_b64_tr_b16 v[30:31], v8 offset:14400
    ds_read_b64_tr_b16 v[32:33], v8 offset:18432
    ds_read_b64_tr_b16 v[34:35], v8 offset:19008
    ds_read_b64_tr_b16 v[36:37], v8 offset:23040
    ds_read_b64_tr_b16 v[38:39], v8 offset:23616
    ds_read_b64_tr_b16 v[40:41], v8 offset:27648
    ds_read_b64_tr_b16 v[42:43], v8 offset:28224
    ds_read_b64_tr_b16 v[44:45], v8 offset:32256
    ds_read_b64_tr_b16 v[46:47], v8 offset:32832
    ds_read_b64_tr_b16 v[48:49], v8 offset:36864
    ds_read_b64_tr_b16 v[50:51], v8 offset:37440
    ds_read_b64_tr_b16 v[52:53], v9 offset:0
    ds_read_b64_tr_b16 v[54:55], v9 offset:576
    ds_read_b64_tr_b16 v[56:57], v9 offset:4608
    ds_read_b64_tr_b16 v[58:59], v9 offset:5184
    ds_read_b64_tr_b16 v[60:61], v9 offset:9216
    ds_read_b64_tr_b16 v[62:63], v9 offset:9792
    ds_read_b64_tr_b16 v[64:65], v9 offset:13824
    ds_read_b64_tr_b16 v[66:67], v9 offset:14400
    ds_read_b64_tr_b16 v[68:69], v9 offset:18432
    ds_read_b64_tr_b16 v[70:71], v9 offset:19008
    ds_read_b64_tr_b16 v[72:73], v9 offset:23040
    ds_read_b64_tr_b16 v[74:75], v9 offset:23616
    ds_read_b64_tr_b16 v[76:77], v9 offset:27648
    ds_read_b64_tr_b16 v[78:79], v9 offset:28224
    ds_read_b64_tr_b16 v[80:81], v9 offset:32256
    ds_read_b64_tr_b16 v[82:83], v9 offset:32832
    ds_read_b64_tr_b16 v[84:85], v9 offset:36864
    ds_read_b64_tr_b16 v[86:87], v9 offset:37440
    v_add_f32_dpp v88, v88, v88 row_ror:4 row_mask:0xf bank_mask:0xf
    s_nop 1
    v_add_f32_dpp v88, v88, v88 row_ror:8 row_mask:0xf bank_mask:0xf
    v_mul_f32 v91, 3135475257, v88
    v_mul_f32 v90, 3135475257, v88
    v_mul_f32 v89, 3135475257, v88
    v_mul_f32 v88, 3135475257, v88
    s_nop 1
    v_mfma_f32_16x16x32_bf16 v[160:163], v[152:155], v[128:131], v[88:91]
    v_mfma_f32_16x16x32_bf16 v[164:167], v[150:153], v[128:131], v[88:91]
    v_mfma_f32_16x16x32_bf16 v[168:171], v[152:155], v[132:135], v[88:91]
    v_mfma_f32_16x16x32_bf16 v[172:175], v[150:153], v[132:135], v[88:91]
    v_mfma_f32_16x16x32_bf16 v[176:179], v[152:155], v[136:139], v[88:91]
    v_mfma_f32_16x16x32_bf16 v[180:183], v[150:153], v[136:139], v[88:91]
    v_mfma_f32_16x16x32_bf16 v[184:187], v[152:155], v[140:143], v[88:91]
    v_mfma_f32_16x16x32_bf16 v[188:191], v[150:153], v[140:143], v[88:91]
    v_mfma_f32_16x16x32_bf16 v[192:195], v[152:155], v[144:147], v[88:91]
    v_mfma_f32_16x16x32_bf16 v[196:199], v[150:153], v[144:147], v[88:91]
    v_cvt_pk_bf16_f32 v128, v160, v161
    v_cvt_pk_bf16_f32 v129, v162, v163
    v_cvt_pk_bf16_f32 v130, v164, v165
    v_cvt_pk_bf16_f32 v131, v166, v167
    v_cvt_pk_bf16_f32 v132, v168, v169
    v_cvt_pk_bf16_f32 v133, v170, v171
    v_cvt_pk_bf16_f32 v134, v172, v173
    v_cvt_pk_bf16_f32 v135, v174, v175
    v_cvt_pk_bf16_f32 v136, v176, v177
    v_cvt_pk_bf16_f32 v137, v178, v179
    v_cvt_pk_bf16_f32 v138, v180, v181
    v_cvt_pk_bf16_f32 v139, v182, v183
    v_cvt_pk_bf16_f32 v140, v184, v185
    v_cvt_pk_bf16_f32 v141, v186, v187
    v_cvt_pk_bf16_f32 v142, v188, v189
    v_cvt_pk_bf16_f32 v143, v190, v191
    v_cvt_pk_bf16_f32 v144, v192, v193
    v_cvt_pk_bf16_f32 v145, v194, v195
    v_cvt_pk_bf16_f32 v146, v196, v197
    v_cvt_pk_bf16_f32 v147, v198, v199
    s_mov_b64 exec, s[44:45]
    buffer_store_dwordx4 v[128:131], v6, s[40:43], 0 offen offset:0 sc1
    buffer_store_dwordx4 v[132:135], v6, s[40:43], 0 offen offset:512 sc1
    buffer_store_dwordx4 v[136:139], v6, s[40:43], 0 offen offset:1024 sc1
    buffer_store_dwordx4 v[140:143], v6, s[40:43], 0 offen offset:1536 sc1
    buffer_store_dwordx4 v[144:147], v6, s[40:43], 0 offen offset:2048 sc1
    s_mov_b64 exec, -1
    s_branch L_k0_ctail
L_k0_misc:
    s_waitcnt lgkmcnt(0)
    s_cmp_ge_u32 s2, 183
    s_cbranch_scc1 L_k0_m2
    s_sub_u32 s20, s2, 177
    s_lshl_b32 s20, s20, 15
    s_add_u32 s20, s20, 13697024
    s_add_u32 s12, s4, s20
    s_addc_u32 s13, s5, 0
    s_and_b32 s13, s13, 0xffff
    s_mov_b32 s14, 32768
    s_mov_b32 s15, 0x20000
    v_lshlrev_b32 v5, 4, v0
    v_mov_b32 v8, 0
    v_mov_b32 v9, 0
    v_mov_b32 v10, 0
    v_mov_b32 v11, 0
    s_mov_b32 s20, 0
    buffer_store_dwordx4 v[8:11], v5, s[12:15], s20 offen sc1
    s_mov_b32 s20, 4096
    buffer_store_dwordx4 v[8:11], v5, s[12:15], s20 offen sc1
    s_mov_b32 s20, 8192
    buffer_store_dwordx4 v[8:11], v5, s[12:15], s20 offen sc1
    s_mov_b32 s20, 12288
    buffer_store_dwordx4 v[8:11], v5, s[12:15], s20 offen sc1
    s_mov_b32 s20, 16384
    buffer_store_dwordx4 v[8:11], v5, s[12:15], s20 offen sc1
    s_mov_b32 s20, 20480
    buffer_store_dwordx4 v[8:11], v5, s[12:15], s20 offen sc1
    s_mov_b32 s20, 24576
    buffer_store_dwordx4 v[8:11], v5, s[12:15], s20 offen sc1
    s_mov_b32 s20, 28672
    buffer_store_dwordx4 v[8:11], v5, s[12:15], s20 offen sc1
    s_add_u32 s12, s30, 0
    s_addc_u32 s13, s31, 0
    s_and_b32 s13, s13, 0xffff
    s_mov_b32 s14, 256
    s_mov_b32 s15, 0x20000
    s_waitcnt vmcnt(0)
    s_barrier
    s_cmp_lg_u32 s6, 0
    s_cbranch_scc1 L_k0_m2
    s_sub_u32 s20, s2, 177
    s_lshl_b32 s20, s20, 2
    v_mov_b32 v3, 1
    s_mov_b64 exec, 1
    buffer_store_dword v3, off, s[12:15], s20 sc1
    s_mov_b64 exec, -1
L_k0_m2:
    s_add_u32 s8, s26, 0
    s_addc_u32 s9, s27, 0
    s_and_b32 s9, s9, 0xffff
    s_mov_b32 s10, 1990656
    s_mov_b32 s11, 0x20000
    s_mul_i32 s20, s7, 73728
    s_add_u32 s48, s24, s20
    s_addc_u32 s49, s25, 0
    s_and_b32 s49, s49, 0xffff
    s_mov_b32 s50, 73728
    s_mov_b32 s51, 0x20000
    s_cmp_ge_u32 s6, 2
    s_cbranch_scc1 L_ftx3
    s_lshl_b32 s20, s6, 6
    v_add_u32 v126, s20, v1
    v_min_u32 v126, 89, v126
    v_mul_u32_u24 v127, 205, v126
    v_lshrrev_b32 v127, 10, v127
    v_mul_u32_u24 v125, 5, v127
    v_sub_u32 v126, v126, v125
    v_lshlrev_b32 v126, 7, v126
    v_min_u32 v126, 428, v126
    v_mul_u32_u24 v127, 3456, v127
    v_add_u32 v126, v126, v127
    s_and_b32 s20, s2, 7
    s_mul_i32 s20, s20, 432
    s_lshr_b32 s21, s2, 3
    s_mul_i32 s21, s21, 62208
    s_add_u32 s20, s20, s21
    buffer_load_dword v125, v126, s[8:11], s20 offen
    s_branch L_ftd3
L_ftx3:
    v_min_u32 v126, 35, v1
    v_lshlrev_b32 v126, 7, v126
    s_lshl_b32 s20, s3, 1
    s_add_u32 s20, s20, s6
    s_sub_u32 s20, s20, 2
    s_mul_i32 s20, s20, 4608
    buffer_load_dword v125, v126, s[48:51], s20 offen
L_ftd3:
    s_cmp_lt_u32 s2, 184
    s_cbranch_scc1 L_k0_m3
    s_add_u32 s12, s32, 0
    s_addc_u32 s13, s33, 0
    s_and_b32 s13, s13, 0xffff
    s_mov_b32 s14, 5308416
    s_mov_b32 s15, 0x20000
    s_sub_u32 s20, s2, 184
    s_lshr_b32 s20, s20, 3
    s_and_b32 s21, s2, 7
    s_mul_i32 s21, s21, 9
    s_add_u32 s20, s20, s21
    s_lshl_b32 s20, s20, 7
    s_mul_i32 s21, s6, 1327104
    s_add_u32 s20, s20, s21
    s_add_u32 s20, s20, 737280
    v_mul_u32_u24 v3, 9216, v1
    buffer_load_dword v4, v3, s[12:15], s20 offen nt
L_k0_m3:
    v_lshrrev_b32 v126, 3, v1
    v_and_b32 v127, 7, v1
    v_xor_b32 v127, v127, v126
    v_mul_u32_u24 v126, 1152, v126
    v_lshl_add_u32 v126, v127, 4, v126
    v_add_u32 v127, 9216, v126
    s_mul_i32 s20, s6, 18432
    s_mov_b32 s21, s20
    s_mov_b32 m0, s20
    s_add_u32 s20, s20, 1024
    buffer_load_dwordx4 v126, s[48:51], s21 offen lds
    s_mov_b32 m0, s20
    s_add_u32 s20, s20, 1024
    buffer_load_dwordx4 v127, s[48:51], s21 offen lds
    s_add_u32 s21, s21, 128
    s_mov_b32 m0, s20
    s_add_u32 s20, s20, 1024
    buffer_load_dwordx4 v126, s[48:51], s21 offen lds
    s_mov_b32 m0, s20
    s_add_u32 s20, s20, 1024
    buffer_load_dwordx4 v127, s[48:51], s21 offen lds
    s_add_u32 s21, s21, 128
    s_mov_b32 m0, s20
    s_add_u32 s20, s20, 1024
    buffer_load_dwordx4 v126, s[48:51], s21 offen lds
    s_mov_b32 m0, s20
    s_add_u32 s20, s20, 1024
    buffer_load_dwordx4 v127, s[48:51], s21 offen lds
    s_add_u32 s21, s21, 128
    s_mov_b32 m0, s20
    s_add_u32 s20, s20, 1024
    buffer_load_dwordx4 v126, s[48:51], s21 offen lds
    s_mov_b32 m0, s20
    s_add_u32 s20, s20, 1024
    buffer_load_dwordx4 v127, s[48:51], s21 offen lds
    s_add_u32 s21, s21, 128
    s_mov_b32 m0, s20
    s_add_u32 s20, s20, 1024
    buffer_load_dwordx4 v126, s[48:51], s21 offen lds
    s_mov_b32 m0, s20
    s_add_u32 s20, s20, 1024
    buffer_load_dwordx4 v127, s[48:51], s21 offen lds
    s_add_u32 s21, s21, 128
    s_mov_b32 m0, s20
    s_add_u32 s20, s20, 1024
    buffer_load_dwordx4 v126, s[48:51], s21 offen lds
    s_mov_b32 m0, s20
    s_add_u32 s20, s20, 1024
    buffer_load_dwordx4 v127, s[48:51], s21 offen lds
    s_add_u32 s21, s21, 128
    s_mov_b32 m0, s20
    s_add_u32 s20, s20, 1024
    buffer_load_dwordx4 v126, s[48:51], s21 offen lds
    s_mov_b32 m0, s20
    s_add_u32 s20, s20, 1024
    buffer_load_dwordx4 v127, s[48:51], s21 offen lds
    s_add_u32 s21, s21, 128
    s_mov_b32 m0, s20
    s_add_u32 s20, s20, 1024
    buffer_load_dwordx4 v126, s[48:51], s21 offen lds
    s_mov_b32 m0, s20
    s_add_u32 s20, s20, 1024
    buffer_load_dwordx4 v127, s[48:51], s21 offen lds
    s_add_u32 s21, s21, 128
    s_mov_b32 m0, s20
    s_add_u32 s20, s20, 1024
    buffer_load_dwordx4 v126, s[48:51], s21 offen lds
    s_mov_b32 m0, s20
    s_add_u32 s20, s20, 1024
    buffer_load_dwordx4 v127, s[48:51], s21 offen lds
    s_add_u32 s21, s21, 128
    s_add_u32 s52, s30, 0
    s_addc_u32 s53, s31, 0
    s_and_b32 s53, s53, 0xffff
    s_mov_b32 s54, 256
    s_mov_b32 s55, 0x20000
    s_add_u32 s56, s4, 13697024
    s_addc_u32 s57, s5, 0
    s_and_b32 s57, s57, 0xffff
    s_mov_b32 s58, 196608
    s_mov_b32 s59, 0x20000
    v_min_u32 v120, 5, v1
    v_lshlrev_b32 v120, 2, v120
    v_and_b32 v122, 15, v1
    v_lshrrev_b32 v123, 4, v1
    v_lshlrev_b32 v123, 2, v123
    v_sub_u32 v122, v122, v123
    v_mov_b32 v150, 0
    v_mov_b32 v151, 0
    v_mov_b32 v152, 0
    v_mov_b32 v153, 0
    v_mov_b32 v154, 0
    v_mov_b32 v155, 0
    v_cmp_eq_u32 vcc, 0, v122
    v_mov_b32 v123, 16256
    v_mov_b32 v156, 0x3f803f80
    v_cndmask_b32 v152, v152, v123, vcc
    v_cmp_eq_u32 vcc, 1, v122
    v_mov_b32 v123, 1065353216
    v_mov_b32 v157, 0x3f803f80
    v_cndmask_b32 v152, v152, v123, vcc
    v_cmp_eq_u32 vcc, 2, v122
    v_mov_b32 v123, 16256
    v_mov_b32 v158, 0x3f803f80
    v_cndmask_b32 v153, v153, v123, vcc
    v_cmp_eq_u32 vcc, 3, v122
    v_mov_b32 v123, 1065353216
    v_mov_b32 v159, 0x3f803f80
    v_cndmask_b32 v153, v153, v123, vcc
    s_waitcnt vmcnt(0)
    buffer_load_dword v121, v120, s[52:55], 0 offen sc1
    s_waitcnt vmcnt(0)
    s_branch L_k0_done
L_k0_sig:
    s_mov_b32 s21, 131072
L_zc4:
    v_cmp_ne_u32 vcc, 0, v121
    s_sub_u32 s21, s21, 1
    s_nop 0
    s_cmp_eq_u64 vcc, exec
    s_cbranch_scc1 L_zcd4
    s_sleep 8
    buffer_load_dword v121, v120, s[52:55], 0 offen sc1
    s_waitcnt vmcnt(0)
    s_cmp_lg_u32 s21, 0
    s_cbranch_scc1 L_zc4
L_zcd4:
    s_barrier
    s_cmp_lg_u32 s6, 0
    s_cbranch_scc1 L_k0_sig2
    s_lshl_b32 s20, s22, 7
    s_add_u32 s20, s20, 100352
    v_mov_b32 v3, 1
    s_mov_b64 exec, 1
    buffer_store_dword v3, off, s[56:59], s20 sc1
    s_mov_b64 exec, -1
L_k0_sig2:
    s_cmp_ge_u32 s2, 24
    s_cbranch_scc1 L_k0_done2
    v_lshrrev_b32 v126, 3, v1
    v_and_b32 v127, 7, v1
    v_xor_b32 v127, v127, v126
    v_mul_u32_u24 v126, 1152, v126
    v_lshl_add_u32 v126, v127, 4, v126
    v_add_u32 v127, 9216, v126
    s_mul_i32 s20, s6, 18432
    s_mov_b32 s21, s20
    s_mov_b32 m0, s20
    s_add_u32 s20, s20, 1024
    buffer_load_dwordx4 v126, s[48:51], s21 offen lds
    s_mov_b32 m0, s20
    s_add_u32 s20, s20, 1024
    buffer_load_dwordx4 v127, s[48:51], s21 offen lds
    s_add_u32 s21, s21, 128
    s_mov_b32 m0, s20
    s_add_u32 s20, s20, 1024
    buffer_load_dwordx4 v126, s[48:51], s21 offen lds
    s_mov_b32 m0, s20
    s_add_u32 s20, s20, 1024
    buffer_load_dwordx4 v127, s[48:51], s21 offen lds
    s_add_u32 s21, s21, 128
    s_mov_b32 m0, s20
    s_add_u32 s20, s20, 1024
    buffer_load_dwordx4 v126, s[48:51], s21 offen lds
    s_mov_b32 m0, s20
    s_add_u32 s20, s20, 1024
    buffer_load_dwordx4 v127, s[48:51], s21 offen lds
    s_add_u32 s21, s21, 128
    s_mov_b32 m0, s20
    s_add_u32 s20, s20, 1024
    buffer_load_dwordx4 v126, s[48:51], s21 offen lds
    s_mov_b32 m0, s20
    s_add_u32 s20, s20, 1024
    buffer_load_dwordx4 v127, s[48:51], s21 offen lds
    s_add_u32 s21, s21, 128
    s_mov_b32 m0, s20
    s_add_u32 s20, s20, 1024
    buffer_load_dwordx4 v126, s[48:51], s21 offen lds
    s_mov_b32 m0, s20
    s_add_u32 s20, s20, 1024
    buffer_load_dwordx4 v127, s[48:51], s21 offen lds
    s_add_u32 s21, s21, 128
    s_mov_b32 m0, s20
    s_add_u32 s20, s20, 1024
    buffer_load_dwordx4 v126, s[48:51], s21 offen lds
    s_mov_b32 m0, s20
    s_add_u32 s20, s20, 1024
    buffer_load_dwordx4 v127, s[48:51], s21 offen lds
    s_add_u32 s21, s21, 128
    s_mov_b32 m0, s20
    s_add_u32 s20, s20, 1024
    buffer_load_dwordx4 v126, s[48:51], s21 offen lds
    s_mov_b32 m0, s20
    s_add_u32 s20, s20, 1024
    buffer_load_dwordx4 v127, s[48:51], s21 offen lds
    s_add_u32 s21, s21, 128
    s_mov_b32 m0, s20
    s_add_u32 s20, s20, 1024
    buffer_load_dwordx4 v126, s[48:51], s21 offen lds
    s_mov_b32 m0, s20
    s_add_u32 s20, s20, 1024
    buffer_load_dwordx4 v127, s[48:51], s21 offen lds
    s_add_u32 s21, s21, 128
    s_mov_b32 m0, s20
    s_add_u32 s20, s20, 1024
    buffer_load_dwordx4 v126, s[48:51], s21 offen lds
    s_mov_b32 m0, s20
    s_add_u32 s20, s20, 1024
    buffer_load_dwordx4 v127, s[48:51], s21 offen lds
    s_add_u32 s21, s21, 128
    s_branch L_k0_done2
L_k0_w18:
    s_waitcnt vmcnt(18)
L_k0_done:
    s_mov_b32 s21, 131072
L_zc5:
    v_cmp_ne_u32 vcc, 0, v121
    s_sub_u32 s21, s21, 1
    s_nop 0
    s_cmp_eq_u64 vcc, exec
    s_cbranch_scc1 L_zcd5
    s_sleep 8
    buffer_load_dword v121, v120, s[52:55], 0 offen sc1
    s_waitcnt vmcnt(0)
    s_cmp_lg_u32 s21, 0
    s_cbranch_scc1 L_zc5
L_zcd5:
L_k0_done2:
    s_cmp_lg_u32 s6, 1
    s_cbranch_scc1 L_k0_nocen
    s_getreg_b32 s21, hwreg(HW_REG_XCC_ID, 0, 3)
    s_lshl_b32 s21, s21, 2
    s_and_b32 s20, s2, 7
    s_lshl_b32 s20, s20, 7
    s_add_u32 s20, s20, s21
    s_add_u32 s20, s20, 98304
    v_mov_b32 v3, 1
    s_mov_b64 exec, 1
    buffer_atomic_add v3, off, s[56:59], s20
    s_mov_b64 exec, -1
L_k0_nocen:
    v_and_b32 v3, 15, v1
    v_lshrrev_b32 v4, 4, v1
    v_and_b32 v5, 7, v1
    v_xor_b32 v4, v4, v5
    v_lshlrev_b32 v4, 4, v4
    v_lshl_add_u32 v249, v3, 7, v4
    v_xor_b32 v250, 64, v249
    v_and_b32 v3, 15, v1
    v_mov_b32 v11, 0x100000
    v_cmp_eq_u32 vcc, 0, v3
    v_mov_b32 v10, 57600
    s_nop 0
    v_cndmask_b32 v11, v11, v10, vcc
    v_cmp_eq_u32 vcc, 1, v3
    v_mov_b32 v10, 57616
    s_nop 0
    v_cndmask_b32 v11, v11, v10, vcc
    v_cmp_eq_u32 vcc, 4, v3
    v_mov_b32 v10, 55296
    s_nop 0
    v_cndmask_b32 v11, v11, v10, vcc
    v_cmp_eq_u32 vcc, 5, v3
    v_mov_b32 v10, 55312
    s_nop 0
    v_cndmask_b32 v11, v11, v10, vcc
    v_cmp_eq_u32 vcc, 3, v3
    v_mov_b32 v10, 59904
    s_nop 0
    v_cndmask_b32 v11, v11, v10, vcc
    v_cmp_eq_u32 vcc, 7, v3
    v_mov_b32 v10, 59920
    s_nop 0
    v_cndmask_b32 v11, v11, v10, vcc
    v_lshrrev_b32 v3, 4, v1
    v_lshl_add_u32 v11, v3, 5, v11
    s_cmp_lg_u32 s6, 3
    s_cbranch_scc1 L_k0_god
    v_min_u32 v3, 2, v1
    v_lshl_add_u32 v3, v3, 3, s3
    v_mul_u32_u24 v4, 43, v3
    v_lshrrev_b32 v4, 7, v4
    v_mul_u32_u24 v5, 3, v4
    v_sub_u32 v3, v3, v5
    v_lshl_add_u32 v3, v3, 3, v4
    v_lshlrev_b32 v3, 7, v3
    s_mov_b32 s20, 100352
    s_mov_b32 s21, 131072
L_k0_go:
    buffer_load_dword v4, v3, s[56:59], s20 offen sc1
    s_waitcnt vmcnt(0)
    v_cmp_ne_u32 vcc, 0, v4
    s_sub_u32 s21, s21, 1
    s_nop 0
    s_cmp_eq_u64 vcc, exec
    s_cbranch_scc1 L_k0_god
    s_sleep 4
    s_cmp_lg_u32 s21, 0
    s_cbranch_scc1 L_k0_go
L_k0_god:
    s_cmp_ge_u32 s2, 24
    s_cbranch_scc1 L_k0_xok
    s_waitcnt vmcnt(0)
L_k0_xok:
    s_barrier
    s_lshl_b32 s21, s3, 2
    s_add_u32 s21, s21, s6
    s_mul_i32 s21, s21, 73728
    s_add_u32 s21, s21, 10616832
    s_add_u32 s8, s4, s21
    s_addc_u32 s9, s5, 0
    s_and_b32 s9, s9, 0xffff
    s_mov_b32 s10, 73728
    s_mov_b32 s11, 0x20000
    s_mov_b32 s26, 0
    buffer_load_dwordx4 v[156:159], v2, s[8:11], s26 offen offset:0 sc1
    buffer_load_dwordx4 v[160:163], v2, s[8:11], s26 offen offset:1024 sc1
    buffer_load_dwordx4 v[164:167], v2, s[8:11], s26 offen offset:2048 sc1
    buffer_load_dwordx4 v[168:171], v2, s[8:11], s26 offen offset:3072 sc1
    s_add_u32 s26, s26, 4096
    buffer_load_dwordx4 v[172:175], v2, s[8:11], s26 offen offset:0 sc1
    buffer_load_dwordx4 v[176:179], v2, s[8:11], s26 offen offset:1024 sc1
    buffer_load_dwordx4 v[180:183], v2, s[8:11], s26 offen offset:2048 sc1
    buffer_load_dwordx4 v[184:187], v2, s[8:11], s26 offen offset:3072 sc1
    s_add_u32 s26, s26, 4096
    buffer_load_dwordx4 v[188:191], v2, s[8:11], s26 offen offset:0 sc1
    buffer_load_dwordx4 v[192:195], v2, s[8:11], s26 offen offset:1024 sc1
    buffer_load_dwordx4 v[196:199], v2, s[8:11], s26 offen offset:2048 sc1
    buffer_load_dwordx4 v[200:203], v2, s[8:11], s26 offen offset:3072 sc1
    s_add_u32 s26, s26, 4096
    buffer_load_dwordx4 v[204:207], v2, s[8:11], s26 offen offset:0 sc1
    buffer_load_dwordx4 v[208:211], v2, s[8:11], s26 offen offset:1024 sc1
    buffer_load_dwordx4 v[212:215], v2, s[8:11], s26 offen offset:2048 sc1
    buffer_load_dwordx4 v[216:219], v2, s[8:11], s26 offen offset:3072 sc1
    s_add_u32 s26, s26, 4096
    buffer_load_dwordx4 v[220:223], v2, s[8:11], s26 offen offset:0 sc1
    buffer_load_dwordx4 v[224:227], v2, s[8:11], s26 offen offset:1024 sc1
    s_load_dwordx2 s[46:47], s[0:1], 48
    s_lshl_b32 s53, s7, 1
    s_and_b32 s20, s3, 1
    s_add_u32 s53, s53, s20
    s_lshr_b32 s54, s3, 1
    s_lshl_b32 s51, s7, 7
    s_add_u32 s51, s51, 163840
    s_lshl_b32 s52, s3, 2
    s_add_u32 s52, s52, s6
    s_lshl_b32 s52, s52, 2
    s_add_u32 s52, s52, s51
    s_mov_b32 s44, 0
    s_waitcnt lgkmcnt(0)
L_layer:
    v_add_u32 v251, 36864, v249
    v_add_u32 v252, 36864, v250
    s_mul_i32 s20, s6, 18432
    v_add_u32 v253, s20, v249
    v_add_u32 v254, s20, v250
    v_mov_b32 v132, 0x3f803f80
    v_mov_b32 v133, 0x3f803f80
    v_mov_b32 v134, 0x3f803f80
    v_mov_b32 v135, 0x3f803f80
    s_mov_b32 s36, 0x22222222
    s_mov_b32 s37, 0x22222222
    s_mov_b32 s38, 0x44444444
    s_mov_b32 s39, 0x44444444
    s_mov_b32 s40, 0x88888888
    s_mov_b32 s41, 0x88888888
    s_mov_b32 s42, 0x00f0000f
    s_mov_b32 s43, 0xf0000f00
    v_and_b32 v5, 15, v1
    v_lshrrev_b32 v6, 4, v1
    s_lshl_b32 s20, s6, 6
    s_add_u32 s20, s20, 156672
    v_lshl_add_u32 v7, v5, 2, s20
    v_lshlrev_b32 v8, 2, v5
    v_add_u32 v8, 156672, v8
    v_lshlrev_b32 v9, 4, v6
    v_add_u32 v9, 156672, v9
    s_lshl_b32 s22, s7, 16
    s_add_u32 s22, s22, 35651584
    s_add_u32 s16, s4, s22
    s_addc_u32 s17, s5, 0
    s_and_b32 s17, s17, 0xffff
    s_mov_b32 s18, 65536
    s_mov_b32 s19, 0x20000
    s_lshl_b32 s22, s7, 3
    s_add_u32 s22, s22, s3
    s_lshl_b32 s22, s22, 10
    s_add_u32 s22, s22, 37748736
    s_add_u32 s12, s4, s22
    s_addc_u32 s13, s5, 0
    s_and_b32 s13, s13, 0xffff
    s_mov_b32 s14, 1024
    s_mov_b32 s15, 0x20000
    s_mul_i32 s22, s3, 6144
    s_mul_i32 s23, s44, 49152
    s_add_u32 s22, s22, s23
    s_add_u32 s22, s22, 13697024
    s_add_u32 s32, s4, s22
    s_addc_u32 s33, s5, 0
    s_and_b32 s33, s33, 0xffff
    s_mov_b32 s34, 6144
    s_mov_b32 s35, 0x20000
    s_mul_i32 s24, s54, 165888
    s_add_u32 s24, s24, 12976128
    s_add_u32 s28, s4, s24
    s_addc_u32 s29, s5, 0
    s_and_b32 s29, s29, 0xffff
    s_mov_b32 s30, 165888
    s_mov_b32 s31, 0x20000
    s_mov_b32 s22, 1060205080
    s_add_u32 s23, s6, 1
    s_and_b32 s23, s23, 3
    s_lshl_b32 s24, s23, 8
    s_add_u32 s24, s24, 5120
    s_lshl_b32 s25, s6, 6
    s_cmp_eq_u32 s44, 0
    s_cbranch_scc1 L_q_x0
    s_sub_u32 s20, s51, 8192
    v_and_b32 v3, 31, v1
    v_lshlrev_b32 v3, 2, v3
    s_mov_b32 s21, 131072
L_cw6:
    buffer_load_dword v4, v3, s[56:59], s20 offen sc1
    s_waitcnt vmcnt(0)
    v_cmp_ne_u32 vcc, 0, v4
    s_sub_u32 s21, s21, 1
    s_nop 0
    s_cmp_eq_u32 vcc_lo, -1
    s_cbranch_scc1 L_cwd6
    s_cmp_lg_u32 s21, 0
    s_cbranch_scc1 L_cw6
L_cwd6:
    s_cmp_eq_u32 s45, 1
    s_cbranch_scc1 L_cwf6
    buffer_inv sc1
    s_waitcnt vmcnt(0)
L_cwf6:
    s_mov_b32 m0, s90
    s_nop 0
    buffer_load_dwordx4 v2, s[96:99], s90 offen offset:0 sc1 lds
    buffer_load_dwordx4 v2, s[96:99], s90 offen offset:1024 sc1 lds
    buffer_load_dwordx4 v2, s[96:99], s90 offen offset:2048 sc1 lds
    buffer_load_dwordx4 v2, s[96:99], s90 offen offset:3072 sc1 lds
    s_add_u32 s90, s90, 4096
    s_mov_b32 m0, s90
    s_nop 0
    buffer_load_dwordx4 v2, s[96:99], s90 offen offset:0 sc1 lds
    buffer_load_dwordx4 v2, s[96:99], s90 offen offset:1024 sc1 lds
    buffer_load_dwordx4 v2, s[96:99], s90 offen offset:2048 sc1 lds
    buffer_load_dwordx4 v2, s[96:99], s90 offen offset:3072 sc1 lds
    s_add_u32 s90, s90, 4096
    s_mov_b32 m0, s90
    s_nop 0
    buffer_load_dwordx4 v2, s[96:99], s90 offen offset:0 sc1 lds
    buffer_load_dwordx4 v2, s[96:99], s90 offen offset:1024 sc1 lds
    buffer_load_dwordx4 v2, s[96:99], s90 offen offset:2048 sc1 lds
    buffer_load_dwordx4 v2, s[96:99], s90 offen offset:3072 sc1 lds
    s_add_u32 s90, s90, 4096
    s_mov_b32 m0, s90
    s_nop 0
    buffer_load_dwordx4 v2, s[96:99], s90 offen offset:0 sc1 lds
    buffer_load_dwordx4 v2, s[96:99], s90 offen offset:1024 sc1 lds
    buffer_load_dwordx4 v2, s[96:99], s90 offen offset:2048 sc1 lds
    buffer_load_dwordx4 v2, s[96:99], s90 offen offset:3072 sc1 lds
    s_add_u32 s90, s90, 4096
    s_mov_b32 m0, s90
    s_nop 0
    buffer_load_dwordx4 v2, s[96:99], s90 offen offset:0 sc1 lds
    buffer_load_dwordx4 v2, s[96:99], s90 offen offset:1024 sc1 lds
    s_waitcnt vmcnt(12)
    s_barrier
    s_branch L_q_xok
L_q_x0:
    s_mul_i32 s20, s7, 73728
    s_add_u32 s20, s20, 13893632
    s_add_u32 s96, s4, s20
    s_addc_u32 s97, s5, 0
    s_and_b32 s97, s97, 0xffff
    s_mov_b32 s98, 73728
    s_mov_b32 s99, 0x20000
    s_mul_i32 s20, s3, 9
    s_add_u32 s20, s20, s6
    s_and_b32 s21, s20, 1
    s_cmp_eq_u32 s21, 0
    s_cselect_b64 vcc, -1, 0
    s_sub_u32 s21, s20, s21
    s_lshl_b32 s21, s21, 10
    s_lshl_b32 s20, s20, 10
    v_cndmask_b32 v3, v250, v249, vcc
    v_add_u32 v3, s21, v3
    ds_read_b128 v[228:231], v3
    ds_read_b128 v[232:235], v3 offset:4096
    ds_read_b128 v[236:239], v3 offset:8192
    s_add_u32 s21, s20, 4096
    s_add_u32 s27, s20, 8192
    s_cmp_eq_u32 s6, 0
    s_cselect_b32 s27, s27, 0x40000000
    s_waitcnt lgkmcnt(0)
    buffer_store_dwordx4 v[228:231], v2, s[96:99], s20 offen sc1
    buffer_store_dwordx4 v[232:235], v2, s[96:99], s21 offen sc1
    buffer_store_dwordx4 v[236:239], v2, s[96:99], s27 offen sc1
L_q_xok:
    ds_read_b128 a[0:3], v249 offset:0
    ds_read_b128 a[4:7], v249 offset:18432
    ds_read_b128 a[8:11], v251 offset:0
    ds_read_b128 a[12:15], v251 offset:18432
    ds_read_b128 a[16:19], v250 offset:0
    ds_read_b128 a[20:23], v250 offset:18432
    ds_read_b128 a[24:27], v252 offset:0
    ds_read_b128 a[28:31], v252 offset:18432
    s_waitcnt vmcnt(16) lgkmcnt(4)
    v_mfma_f32_16x16x32_bf16 v[44:47], a[0:3], v[156:159], 0
    ds_read_b128 a[32:35], v249 offset:2048
    v_mfma_f32_16x16x32_bf16 v[48:51], a[4:7], v[156:159], 0
    ds_read_b128 a[36:39], v249 offset:20480
    v_mfma_f32_16x16x32_bf16 v[52:55], a[8:11], v[156:159], 0
    ds_read_b128 a[40:43], v251 offset:2048
    v_mfma_f32_16x16x32_bf16 v[56:59], a[12:15], v[156:159], 0
    ds_read_b128 a[44:47], v251 offset:20480
    buffer_load_dwordx4 v[156:159], v2, s[8:11], s26 offen offset:2048 sc1
    v_mfma_f32_16x16x32_bf16 v[60:63], a[0:3], v[160:163], 0
    v_mfma_f32_16x16x32_bf16 v[64:67], a[4:7], v[160:163], 0
    v_mfma_f32_16x16x32_bf16 v[68:71], a[8:11], v[160:163], 0
    v_mfma_f32_16x16x32_bf16 v[72:75], a[12:15], v[160:163], 0
    buffer_load_dwordx4 v[160:163], v2, s[8:11], s26 offen offset:3072 sc1
    s_waitcnt vmcnt(16) lgkmcnt(4)
    v_mfma_f32_16x16x32_bf16 v[44:47], a[16:19], v[164:167], v[44:47]
    ds_read_b128 a[48:51], v250 offset:2048
    v_mfma_f32_16x16x32_bf16 v[48:51], a[20:23], v[164:167], v[48:51]
    ds_read_b128 a[52:55], v250 offset:20480
    v_mfma_f32_16x16x32_bf16 v[52:55], a[24:27], v[164:167], v[52:55]
    ds_read_b128 a[56:59], v252 offset:2048
    v_mfma_f32_16x16x32_bf16 v[56:59], a[28:31], v[164:167], v[56:59]
    ds_read_b128 a[60:63], v252 offset:20480
    s_add_u32 s26, s26, 4096
    buffer_load_dwordx4 v[164:167], v2, s[8:11], s26 offen offset:0 sc1
    v_mfma_f32_16x16x32_bf16 v[60:63], a[16:19], v[168:171], v[60:63]
    v_mfma_f32_16x16x32_bf16 v[64:67], a[20:23], v[168:171], v[64:67]
    v_mfma_f32_16x16x32_bf16 v[68:71], a[24:27], v[168:171], v[68:71]
    v_mfma_f32_16x16x32_bf16 v[72:75], a[28:31], v[168:171], v[72:75]
    buffer_load_dwordx4 v[168:171], v2, s[8:11], s26 offen offset:1024 sc1
    s_waitcnt vmcnt(16) lgkmcnt(4)
    v_mfma_f32_16x16x32_bf16 v[44:47], a[32:35], v[172:175], v[44:47]
    ds_read_b128 a[64:67], v249 offset:4096
    v_mfma_f32_16x16x32_bf16 v[48:51], a[36:39], v[172:175], v[48:51]
    ds_read_b128 a[68:71], v249 offset:22528
    v_mfma_f32_16x16x32_bf16 v[52:55], a[40:43], v[172:175], v[52:55]
    ds_read_b128 a[72:75], v251 offset:4096
    v_mfma_f32_16x16x32_bf16 v[56:59], a[44:47], v[172:175], v[56:59]
    ds_read_b128 a[76:79], v251 offset:22528
    buffer_load_dwordx4 v[172:175], v2, s[8:11], s26 offen offset:2048 sc1
    v_mfma_f32_16x16x32_bf16 v[60:63], a[32:35], v[176:179], v[60:63]
    v_mfma_f32_16x16x32_bf16 v[64:67], a[36:39], v[176:179], v[64:67]
    v_mfma_f32_16x16x32_bf16 v[68:71], a[40:43], v[176:179], v[68:71]
    v_mfma_f32_16x16x32_bf16 v[72:75], a[44:47], v[176:179], v[72:75]
    buffer_load_dwordx4 v[176:179], v2, s[8:11], s26 offen offset:3072 sc1
    s_waitcnt vmcnt(16) lgkmcnt(4)
    s_cmp_eq_u32 s44, 0
    s_cbranch_scc1 L_q_rest
    s_waitcnt vmcnt(6)
    s_barrier
L_q_rest:
    v_mfma_f32_16x16x32_bf16 v[44:47], a[48:51], v[180:183], v[44:47]
    ds_read_b128 v[108:111], v253 offset:0
    v_mfma_f32_16x16x32_bf16 v[48:51], a[52:55], v[180:183], v[48:51]
    ds_read_b128 v[112:115], v254 offset:0
    v_mfma_f32_16x16x32_bf16 v[52:55], a[56:59], v[180:183], v[52:55]
    ds_read_b128 a[80:83], v250 offset:4096
    v_mfma_f32_16x16x32_bf16 v[56:59], a[60:63], v[180:183], v[56:59]
    ds_read_b128 a[84:87], v250 offset:22528
    s_add_u32 s26, s26, 4096
    buffer_load_dwordx4 v[180:183], v2, s[8:11], s26 offen offset:0 sc1
    v_mfma_f32_16x16x32_bf16 v[60:63], a[48:51], v[184:187], v[60:63]
    ds_read_b128 a[88:91], v252 offset:4096
    v_mfma_f32_16x16x32_bf16 v[64:67], a[52:55], v[184:187], v[64:67]
    ds_read_b128 a[92:95], v252 offset:22528
    v_mfma_f32_16x16x32_bf16 v[68:71], a[56:59], v[184:187], v[68:71]
    v_mfma_f32_16x16x32_bf16 v[72:75], a[60:63], v[184:187], v[72:75]
    buffer_load_dwordx4 v[184:187], v2, s[8:11], s26 offen offset:1024 sc1
    s_waitcnt vmcnt(16) lgkmcnt(4)
    v_mfma_f32_16x16x32_bf16 v[44:47], a[64:67], v[188:191], v[44:47]
    ds_read_b128 v[116:119], v253 offset:2048
    v_mfma_f32_16x16x32_bf16 v[48:51], a[68:71], v[188:191], v[48:51]
    ds_read_b128 v[120:123], v254 offset:2048
    v_mfma_f32_16x16x32_bf16 v[52:55], a[72:75], v[188:191], v[52:55]
    ds_read_b128 a[96:99], v249 offset:6144
    v_mfma_f32_16x16x32_bf16 v[56:59], a[76:79], v[188:191], v[56:59]
    ds_read_b128 a[100:103], v249 offset:24576
    v_mfma_f32_16x16x32_bf16 v[124:127], v[108:111], v[108:111], 0
    v_mfma_f32_16x16x32_bf16 v[128:131], v[132:135], v[108:111], 0
    buffer_load_dwordx4 v[188:191], v2, s[8:11], s26 offen offset:2048 sc1
    v_mfma_f32_16x16x32_bf16 v[60:63], a[64:67], v[192:195], v[60:63]
    ds_read_b128 a[104:107], v251 offset:6144
    v_mfma_f32_16x16x32_bf16 v[64:67], a[68:71], v[192:195], v[64:67]
    ds_read_b128 a[108:111], v251 offset:24576
    v_mfma_f32_16x16x32_bf16 v[68:71], a[72:75], v[192:195], v[68:71]
    v_mfma_f32_16x16x32_bf16 v[72:75], a[76:79], v[192:195], v[72:75]
    v_mfma_f32_16x16x32_bf16 v[124:127], v[112:115], v[112:115], v[124:127]
    v_mfma_f32_16x16x32_bf16 v[128:131], v[132:135], v[112:115], v[128:131]
    buffer_load_dwordx4 v[192:195], v2, s[8:11], s26 offen offset:3072 sc1
    s_waitcnt vmcnt(16) lgkmcnt(4)
    v_and_b32 v3, 15, v1
    v_lshlrev_b32 v3, 7, v3
    v_and_b32 v4, 1, v1
    v_lshlrev_b32 v4, 7, v4
    s_lshl_b32 s20, s6, 14
    s_lshl_b32 s21, s3, 11
    s_add_u32 s20, s20, s21
    s_lshl_b32 s21, s6, 8
    buffer_load_dword v10, v3, s[16:19], s20 offen sc1
    buffer_load_dword v10, v4, s[12:15], s21 offen sc1
    v_mfma_f32_16x16x32_bf16 v[44:47], a[80:83], v[196:199], v[44:47]
    ds_read_b128 v[108:111], v253 offset:4096
    v_mfma_f32_16x16x32_bf16 v[48:51], a[84:87], v[196:199], v[48:51]
    ds_read_b128 v[112:115], v254 offset:4096
    v_mfma_f32_16x16x32_bf16 v[52:55], a[88:91], v[196:199], v[52:55]
    ds_read_b128 a[112:115], v250 offset:6144
    v_mfma_f32_16x16x32_bf16 v[56:59], a[92:95], v[196:199], v[56:59]
    ds_read_b128 a[116:119], v250 offset:24576
    v_mfma_f32_16x16x32_bf16 v[124:127], v[116:119], v[116:119], v[124:127]
    v_mfma_f32_16x16x32_bf16 v[128:131], v[132:135], v[116:119], v[128:131]
    s_add_u32 s26, s26, 4096
    buffer_load_dwordx4 v[196:199], v2, s[8:11], s26 offen offset:0 sc1
    v_mfma_f32_16x16x32_bf16 v[60:63], a[80:83], v[200:203], v[60:63]
    ds_read_b128 a[120:123], v252 offset:6144
    v_mfma_f32_16x16x32_bf16 v[64:67], a[84:87], v[200:203], v[64:67]
    ds_read_b128 a[124:127], v252 offset:24576
    v_mfma_f32_16x16x32_bf16 v[68:71], a[88:91], v[200:203], v[68:71]
    v_mfma_f32_16x16x32_bf16 v[72:75], a[92:95], v[200:203], v[72:75]
    v_mfma_f32_16x16x32_bf16 v[124:127], v[120:123], v[120:123], v[124:127]
    v_mfma_f32_16x16x32_bf16 v[128:131], v[132:135], v[120:123], v[128:131]
    buffer_load_dwordx4 v[200:203], v2, s[8:11], s26 offen offset:1024 sc1
    s_waitcnt vmcnt(18) lgkmcnt(4)
    v_mfma_f32_16x16x32_bf16 v[44:47], a[96:99], v[204:207], v[44:47]
    ds_read_b128 v[116:119], v253 offset:6144
    v_mfma_f32_16x16x32_bf16 v[48:51], a[100:103], v[204:207], v[48:51]
    ds_read_b128 v[120:123], v254 offset:6144
    v_mfma_f32_16x16x32_bf16 v[52:55], a[104:107], v[204:207], v[52:55]
    ds_read_b128 a[128:131], v249 offset:8192
    v_mfma_f32_16x16x32_bf16 v[56:59], a[108:111], v[204:207], v[56:59]
    ds_read_b128 a[132:135], v249 offset:26624
    v_mfma_f32_16x16x32_bf16 v[124:127], v[108:111], v[108:111], v[124:127]
    v_mfma_f32_16x16x32_bf16 v[128:131], v[132:135], v[108:111], v[128:131]
    buffer_load_dwordx4 v[204:207], v2, s[8:11], s26 offen offset:2048 sc1
    v_mfma_f32_16x16x32_bf16 v[60:63], a[96:99], v[208:211], v[60:63]
    ds_read_b128 a[136:139], v251 offset:8192
    v_mfma_f32_16x16x32_bf16 v[64:67], a[100:103], v[208:211], v[64:67]
    ds_read_b128 a[140:143], v251 offset:26624
    v_mfma_f32_16x16x32_bf16 v[68:71], a[104:107], v[208:211], v[68:71]
    v_mfma_f32_16x16x32_bf16 v[72:75], a[108:111], v[208:211], v[72:75]
    v_mfma_f32_16x16x32_bf16 v[124:127], v[112:115], v[112:115], v[124:127]
    v_mfma_f32_16x16x32_bf16 v[128:131], v[132:135], v[112:115], v[128:131]
    buffer_load_dwordx4 v[208:211], v2, s[8:11], s26 offen offset:3072 sc1
    s_waitcnt vmcnt(18) lgkmcnt(4)
    v_mfma_f32_16x16x32_bf16 v[44:47], a[112:115], v[212:215], v[44:47]
    ds_read_b128 v[108:111], v253 offset:8192
    v_mfma_f32_16x16x32_bf16 v[48:51], a[116:119], v[212:215], v[48:51]
    ds_read_b128 v[112:115], v254 offset:8192
    v_mfma_f32_16x16x32_bf16 v[52:55], a[120:123], v[212:215], v[52:55]
    ds_read_b128 a[144:147], v250 offset:8192
    v_mfma_f32_16x16x32_bf16 v[56:59], a[124:127], v[212:215], v[56:59]
    ds_read_b128 a[148:151], v250 offset:26624
    v_mfma_f32_16x16x32_bf16 v[124:127], v[116:119], v[116:119], v[124:127]
    v_mfma_f32_16x16x32_bf16 v[128:131], v[132:135], v[116:119], v[128:131]
    s_add_u32 s26, s26, 4096
    buffer_load_dwordx4 v[212:215], v2, s[8:11], s26 offen offset:0 sc1
    v_mfma_f32_16x16x32_bf16 v[60:63], a[112:115], v[216:219], v[60:63]
    ds_read_b128 a[152:155], v252 offset:8192
    v_mfma_f32_16x16x32_bf16 v[64:67], a[116:119], v[216:219], v[64:67]
    ds_read_b128 a[156:159], v252 offset:26624
    v_mfma_f32_16x16x32_bf16 v[68:71], a[120:123], v[216:219], v[68:71]
    v_mfma_f32_16x16x32_bf16 v[72:75], a[124:127], v[216:219], v[72:75]
    v_mfma_f32_16x16x32_bf16 v[124:127], v[120:123], v[120:123], v[124:127]
    v_mfma_f32_16x16x32_bf16 v[128:131], v[132:135], v[120:123], v[128:131]
    buffer_load_dwordx4 v[216:219], v2, s[8:11], s26 offen offset:1024 sc1
    s_waitcnt vmcnt(18) lgkmcnt(4)
    v_mfma_f32_16x16x32_bf16 v[44:47], a[128:131], v[220:223], v[44:47]
    ds_read_b128 v[116:119], v253 offset:10240
    v_mfma_f32_16x16x32_bf16 v[48:51], a[132:135], v[220:223], v[48:51]
    ds_read_b128 v[120:123], v254 offset:10240
    v_mfma_f32_16x16x32_bf16 v[52:55], a[136:139], v[220:223], v[52:55]
    ds_read_b128 a[160:163], v249 offset:10240
    v_mfma_f32_16x16x32_bf16 v[56:59], a[140:143], v[220:223], v[56:59]
    ds_read_b128 a[164:167], v249 offset:28672
    v_mfma_f32_16x16x32_bf16 v[124:127], v[108:111], v[108:111], v[124:127]
    v_mfma_f32_16x16x32_bf16 v[128:131], v[132:135], v[108:111], v[128:131]
    buffer_load_dwordx4 v[220:223], v2, s[8:11], s26 offen offset:2048 sc1
    v_mfma_f32_16x16x32_bf16 v[60:63], a[128:131], v[224:227], v[60:63]
    ds_read_b128 a[168:171], v251 offset:10240
    v_mfma_f32_16x16x32_bf16 v[64:67], a[132:135], v[224:227], v[64:67]
    ds_read_b128 a[172:175], v251 offset:28672
    v_mfma_f32_16x16x32_bf16 v[68:71], a[136:139], v[224:227], v[68:71]
    v_mfma_f32_16x16x32_bf16 v[72:75], a[140:143], v[224:227], v[72:75]
    v_mfma_f32_16x16x32_bf16 v[124:127], v[112:115], v[112:115], v[124:127]
    v_mfma_f32_16x16x32_bf16 v[128:131], v[132:135], v[112:115], v[128:131]
    buffer_load_dwordx4 v[224:227], v2, s[8:11], s26 offen offset:3072 sc1
    s_waitcnt vmcnt(18) lgkmcnt(4)
    v_mfma_f32_16x16x32_bf16 v[44:47], a[144:147], v[156:159], v[44:47]
    ds_read_b128 v[108:111], v253 offset:12288
    v_mfma_f32_16x16x32_bf16 v[48:51], a[148:151], v[156:159], v[48:51]
    ds_read_b128 v[112:115], v254 offset:12288
    v_mfma_f32_16x16x32_bf16 v[52:55], a[152:155], v[156:159], v[52:55]
    ds_read_b128 a[176:179], v250 offset:10240
    v_mfma_f32_16x16x32_bf16 v[56:59], a[156:159], v[156:159], v[56:59]
    ds_read_b128 a[180:183], v250 offset:28672
    v_mfma_f32_16x16x32_bf16 v[124:127], v[116:119], v[116:119], v[124:127]
    v_mfma_f32_16x16x32_bf16 v[128:131], v[132:135], v[116:119], v[128:131]
    buffer_load_dwordx4 v[156:159], v11, s[8:11], 0 offen offset:0 sc1
    v_mfma_f32_16x16x32_bf16 v[60:63], a[144:147], v[160:163], v[60:63]
    ds_read_b128 a[184:187], v252 offset:10240
    v_mfma_f32_16x16x32_bf16 v[64:67], a[148:151], v[160:163], v[64:67]
    ds_read_b128 a[188:191], v252 offset:28672
    v_mfma_f32_16x16x32_bf16 v[68:71], a[152:155], v[160:163], v[68:71]
    v_mfma_f32_16x16x32_bf16 v[72:75], a[156:159], v[160:163], v[72:75]
    v_mfma_f32_16x16x32_bf16 v[124:127], v[120:123], v[120:123], v[124:127]
    v_mfma_f32_16x16x32_bf16 v[128:131], v[132:135], v[120:123], v[128:131]
    buffer_load_dwordx4 v[160:163], v11, s[8:11], 0 offen offset:128 sc1
    s_waitcnt vmcnt(18) lgkmcnt(4)
    v_mfma_f32_16x16x32_bf16 v[44:47], a[160:163], v[164:167], v[44:47]
    ds_read_b128 v[116:119], v253 offset:14336
    v_mfma_f32_16x16x32_bf16 v[48:51], a[164:167], v[164:167], v[48:51]
    ds_read_b128 v[120:123], v254 offset:14336
    v_mfma_f32_16x16x32_bf16 v[52:55], a[168:171], v[164:167], v[52:55]
    ds_read_b128 a[192:195], v249 offset:12288
    v_mfma_f32_16x16x32_bf16 v[56:59], a[172:175], v[164:167], v[56:59]
    ds_read_b128 a[196:199], v249 offset:30720
    v_mfma_f32_16x16x32_bf16 v[124:127], v[108:111], v[108:111], v[124:127]
    v_mfma_f32_16x16x32_bf16 v[128:131], v[132:135], v[108:111], v[128:131]
    buffer_load_dwordx4 v[164:167], v11, s[8:11], 0 offen offset:256 sc1
    v_mfma_f32_16x16x32_bf16 v[60:63], a[160:163], v[168:171], v[60:63]
    ds_read_b128 a[200:203], v251 offset:12288
    v_mfma_f32_16x16x32_bf16 v[64:67], a[164:167], v[168:171], v[64:67]
    ds_read_b128 a[204:207], v251 offset:30720
    v_mfma_f32_16x16x32_bf16 v[68:71], a[168:171], v[168:171], v[68:71]
    v_mfma_f32_16x16x32_bf16 v[72:75], a[172:175], v[168:171], v[72:75]
    v_mfma_f32_16x16x32_bf16 v[124:127], v[112:115], v[112:115], v[124:127]
    v_mfma_f32_16x16x32_bf16 v[128:131], v[132:135], v[112:115], v[128:131]
    buffer_load_dwordx4 v[168:171], v11, s[8:11], 0 offen offset:384 sc1
    s_waitcnt vmcnt(18) lgkmcnt(4)
    v_mfma_f32_16x16x32_bf16 v[44:47], a[176:179], v[172:175], v[44:47]
    ds_read_b128 v[108:111], v253 offset:16384
    v_mfma_f32_16x16x32_bf16 v[48:51], a[180:183], v[172:175], v[48:51]
    ds_read_b128 v[112:115], v254 offset:16384
    v_mfma_f32_16x16x32_bf16 v[52:55], a[184:187], v[172:175], v[52:55]
    ds_read_b128 a[208:211], v250 offset:12288
    v_mfma_f32_16x16x32_bf16 v[56:59], a[188:191], v[172:175], v[56:59]
    ds_read_b128 a[212:215], v250 offset:30720
    v_mfma_f32_16x16x32_bf16 v[124:127], v[116:119], v[116:119], v[124:127]
    v_mfma_f32_16x16x32_bf16 v[128:131], v[132:135], v[116:119], v[128:131]
    buffer_load_dwordx4 v[172:175], v11, s[8:11], 0 offen offset:512 sc1
    v_mfma_f32_16x16x32_bf16 v[60:63], a[176:179], v[176:179], v[60:63]
    ds_read_b128 a[216:219], v252 offset:12288
    v_mfma_f32_16x16x32_bf16 v[64:67], a[180:183], v[176:179], v[64:67]
    ds_read_b128 a[220:223], v252 offset:30720
    v_mfma_f32_16x16x32_bf16 v[68:71], a[184:187], v[176:179], v[68:71]
    v_mfma_f32_16x16x32_bf16 v[72:75], a[188:191], v[176:179], v[72:75]
    v_mfma_f32_16x16x32_bf16 v[124:127], v[120:123], v[120:123], v[124:127]
    v_mfma_f32_16x16x32_bf16 v[128:131], v[132:135], v[120:123], v[128:131]
    buffer_load_dwordx4 v[176:179], v11, s[8:11], 0 offen offset:640 sc1
    s_waitcnt vmcnt(18) lgkmcnt(4)
    v_mfma_f32_16x16x32_bf16 v[44:47], a[192:195], v[180:183], v[44:47]
    ds_read_b128 a[224:227], v249 offset:14336
    v_mfma_f32_16x16x32_bf16 v[48:51], a[196:199], v[180:183], v[48:51]
    ds_read_b128 a[228:231], v249 offset:32768
    v_mfma_f32_16x16x32_bf16 v[52:55], a[200:203], v[180:183], v[52:55]
    ds_read_b128 a[232:235], v251 offset:14336
    v_mfma_f32_16x16x32_bf16 v[56:59], a[204:207], v[180:183], v[56:59]
    ds_read_b128 a[236:239], v251 offset:32768
    v_mfma_f32_16x16x32_bf16 v[124:127], v[108:111], v[108:111], v[124:127]
    v_mfma_f32_16x16x32_bf16 v[128:131], v[132:135], v[108:111], v[128:131]
    buffer_load_dwordx4 v[180:183], v11, s[8:11], 0 offen offset:768 sc1
    v_mfma_f32_16x16x32_bf16 v[60:63], a[192:195], v[184:187], v[60:63]
    v_mfma_f32_16x16x32_bf16 v[64:67], a[196:199], v[184:187], v[64:67]
    v_mfma_f32_16x16x32_bf16 v[68:71], a[200:203], v[184:187], v[68:71]
    v_mfma_f32_16x16x32_bf16 v[72:75], a[204:207], v[184:187], v[72:75]
    v_mfma_f32_16x16x32_bf16 v[124:127], v[112:115], v[112:115], v[124:127]
    v_mfma_f32_16x16x32_bf16 v[128:131], v[132:135], v[112:115], v[128:131]
    buffer_load_dwordx4 v[184:187], v11, s[8:11], 0 offen offset:896 sc1
    s_waitcnt vmcnt(18) lgkmcnt(4)
    v_mfma_f32_16x16x32_bf16 v[44:47], a[208:211], v[188:191], v[44:47]
    ds_read_b128 a[240:243], v250 offset:14336
    v_mfma_f32_16x16x32_bf16 v[48:51], a[212:215], v[188:191], v[48:51]
    ds_read_b128 a[244:247], v250 offset:32768
    v_mfma_f32_16x16x32_bf16 v[52:55], a[216:219], v[188:191], v[52:55]
    ds_read_b128 a[248:251], v252 offset:14336
    v_mfma_f32_16x16x32_bf16 v[56:59], a[220:223], v[188:191], v[56:59]
    ds_read_b128 a[252:255], v252 offset:32768
    buffer_load_dwordx4 v[188:191], v11, s[8:11], 0 offen offset:1024 sc1
    v_mfma_f32_16x16x32_bf16 v[60:63], a[208:211], v[192:195], v[60:63]
    v_mfma_f32_16x16x32_bf16 v[64:67], a[212:215], v[192:195], v[64:67]
    v_mfma_f32_16x16x32_bf16 v[68:71], a[216:219], v[192:195], v[68:71]
    v_mfma_f32_16x16x32_bf16 v[72:75], a[220:223], v[192:195], v[72:75]
    buffer_load_dwordx4 v[192:195], v11, s[8:11], 0 offen offset:1152 sc1
    s_waitcnt vmcnt(16) lgkmcnt(4)
    v_mfma_f32_16x16x32_bf16 v[44:47], a[224:227], v[196:199], v[44:47]
    ds_read_b128 v[12:15], v249 offset:16384
    v_cndmask_b32 v124, v124, v125, s[36:37]
    v_mul_f32 v128, 987991609, v128
    v_mfma_f32_16x16x32_bf16 v[48:51], a[228:231], v[196:199], v[48:51]
    ds_read_b128 v[16:19], v249 offset:34816
    v_cndmask_b32 v124, v124, v126, s[38:39]
    v_mul_f32 v128, v128, v128
    v_mfma_f32_16x16x32_bf16 v[52:55], a[232:235], v[196:199], v[52:55]
    ds_read_b128 v[20:23], v251 offset:16384
    v_cndmask_b32 v124, v124, v127, s[40:41]
    v_mfma_f32_16x16x32_bf16 v[56:59], a[236:239], v[196:199], v[56:59]
    ds_read_b128 v[24:27], v251 offset:34816
    v_mul_f32 v124, 987991609, v124
    buffer_load_dwordx4 v[196:199], v11, s[8:11], 0 offen offset:1280 sc1
    v_mfma_f32_16x16x32_bf16 v[60:63], a[224:227], v[200:203], v[60:63]
    v_sub_f32 v124, v124, v128
    v_mfma_f32_16x16x32_bf16 v[64:67], a[228:231], v[200:203], v[64:67]
    v_max_f32 v124, 0, v124
    v_mfma_f32_16x16x32_bf16 v[68:71], a[232:235], v[200:203], v[68:71]
    v_add_f32 v124, 925353388, v124
    v_mfma_f32_16x16x32_bf16 v[72:75], a[236:239], v[200:203], v[72:75]
    v_rsq_f32 v128, v124
    buffer_load_dwordx4 v[200:203], v11, s[8:11], 0 offen offset:1408 sc1
    s_waitcnt vmcnt(16) lgkmcnt(4)
    v_mul_f32 v136, 1069066811, v128
    s_mov_b64 exec, s[42:43]
    ds_write_b32 v7, v128
    ds_write_b32 v7, v136 offset:256
    s_mov_b64 exec, -1
    v_mfma_f32_16x16x32_bf16 v[44:47], a[240:243], v[204:207], v[44:47]
    ds_read_b128 v[28:31], v250 offset:16384
    v_mfma_f32_16x16x32_bf16 v[48:51], a[244:247], v[204:207], v[48:51]
    ds_read_b128 v[32:35], v250 offset:34816
    v_mfma_f32_16x16x32_bf16 v[52:55], a[248:251], v[204:207], v[52:55]
    ds_read_b128 v[36:39], v252 offset:16384
    v_mfma_f32_16x16x32_bf16 v[56:59], a[252:255], v[204:207], v[56:59]
    ds_read_b128 v[40:43], v252 offset:34816
    buffer_load_dwordx4 v[204:207], v11, s[8:11], 0 offen offset:1536 sc1
    v_mfma_f32_16x16x32_bf16 v[60:63], a[240:243], v[208:211], v[60:63]
    v_mfma_f32_16x16x32_bf16 v[64:67], a[244:247], v[208:211], v[64:67]
    v_mfma_f32_16x16x32_bf16 v[68:71], a[248:251], v[208:211], v[68:71]
    v_mfma_f32_16x16x32_bf16 v[72:75], a[252:255], v[208:211], v[72:75]
    buffer_load_dwordx4 v[208:211], v11, s[8:11], 0 offen offset:1664 sc1
    s_waitcnt vmcnt(16) lgkmcnt(6)
    s_waitcnt lgkmcnt(0)
    s_barrier
    ds_read_b128 v[140:143], v9 offset:256
    ds_read_b128 v[144:147], v9 offset:320
    ds_read_b128 v[148:151], v9 offset:384
    ds_read_b128 v[152:155], v9 offset:448
    ds_read_b128 v[228:231], v9 offset:0
    ds_read_b128 v[232:235], v9 offset:64
    ds_read_b128 v[236:239], v9 offset:128
    ds_read_b128 v[240:243], v9 offset:192
    ds_read_b32 v244, v8 offset:256
    ds_read_b32 v245, v8 offset:320
    ds_read_b32 v246, v8 offset:384
    ds_read_b32 v247, v8 offset:448
    v_mfma_f32_16x16x32_bf16 v[44:47], v[12:15], v[212:215], v[44:47]
    s_mov_b32 s36, 0xff77ff77
    s_mov_b32 s37, 0xff77ff77
    v_mfma_f32_16x16x32_bf16 v[48:51], v[16:19], v[212:215], v[48:51]
    v_lshlrev_b32 v10, 2, v6
    v_sub_u32 v10, v5, v10
    v_mfma_f32_16x16x32_bf16 v[52:55], v[20:23], v[212:215], v[52:55]
    v_mov_b32 v124, 0
    v_mov_b32 v125, 0
    v_mfma_f32_16x16x32_bf16 v[56:59], v[24:27], v[212:215], v[56:59]
    v_mov_b32 v126, 0
    v_mov_b32 v127, 0
    buffer_load_dwordx4 v[212:215], v11, s[8:11], 0 offen offset:1792 sc1
    v_mfma_f32_16x16x32_bf16 v[60:63], v[12:15], v[216:219], v[60:63]
    v_mov_b32 v128, 0
    v_mov_b32 v129, 0
    v_mfma_f32_16x16x32_bf16 v[64:67], v[16:19], v[216:219], v[64:67]
    v_mov_b32 v138, 0x3f80
    v_mov_b32 v139, 0x3f800000
    v_mfma_f32_16x16x32_bf16 v[68:71], v[20:23], v[216:219], v[68:71]
    v_cndmask_b32 v136, 0, 1.0, s[36:37]
    v_cmp_eq_u32 vcc, 0, v10
    v_mfma_f32_16x16x32_bf16 v[72:75], v[24:27], v[216:219], v[72:75]
    v_lshrrev_b32 v3, 2, v5
    buffer_load_dwordx4 v[216:219], v11, s[8:11], 0 offen offset:1920 sc1
    s_waitcnt vmcnt(16)
    v_mfma_f32_16x16x32_bf16 v[44:47], v[28:31], v[220:223], v[44:47]
    v_and_b32 v4, 3, v5
    v_cndmask_b32 v126, v126, v138, vcc
    v_mfma_f32_16x16x32_bf16 v[48:51], v[32:35], v[220:223], v[48:51]
    v_cmp_eq_u32 vcc, 1, v10
    v_lshlrev_b32 v130, 8, v3
    v_mfma_f32_16x16x32_bf16 v[52:55], v[36:39], v[220:223], v[52:55]
    v_lshl_add_u32 v130, v6, 4, v130
    v_cndmask_b32 v126, v126, v139, vcc
    v_mfma_f32_16x16x32_bf16 v[56:59], v[40:43], v[220:223], v[56:59]
    v_cmp_eq_u32 vcc, 2, v10
    v_lshl_add_u32 v130, v4, 2, v130
    buffer_load_dwordx4 v[220:223], v11, s[8:11], 0 offen offset:2048 sc1
    v_mfma_f32_16x16x32_bf16 v[60:63], v[28:31], v[224:227], v[60:63]
    s_mov_b32 s38, 0x00030003
    v_cndmask_b32 v127, v127, v138, vcc
    v_mfma_f32_16x16x32_bf16 v[64:67], v[32:35], v[224:227], v[64:67]
    v_cmp_eq_u32 vcc, 3, v10
    s_mov_b32 s39, 0x00030003
    v_mfma_f32_16x16x32_bf16 v[68:71], v[36:39], v[224:227], v[68:71]
    s_lshl_b32 s40, s6, 10
    v_mfma_f32_16x16x32_bf16 v[72:75], v[40:43], v[224:227], v[72:75]
    v_cndmask_b32 v127, v127, v139, vcc
    buffer_load_dwordx4 v[224:227], v11, s[8:11], 0 offen offset:2176 sc1
    s_waitcnt lgkmcnt(0)
    s_waitcnt vmcnt(15)
    v_mfma_f32_16x16x32_bf16 v[92:95], a[0:3], v[156:159], 0
    v_mfma_f32_16x16x32_bf16 v[96:99], a[4:7], v[156:159], 0
    v_mul_f32 v108, v44, v140
    v_mul_f32 v109, v45, v141
    v_mul_f32 v110, v46, v142
    v_mul_f32 v111, v47, v143
    v_mfma_f32_16x16x32_bf16 v[100:103], a[8:11], v[156:159], 0
    v_exp_f32_e64 v112, v108 clamp
    v_fma_f32 v108, v108, s22, 1.0
    v_mfma_f32_16x16x32_bf16 v[104:107], a[12:15], v[156:159], 0
    v_exp_f32_e64 v113, v109 clamp
    v_fma_f32 v109, v109, s22, 1.0
    s_add_u32 s26, s26, 4096
    buffer_load_dwordx4 v[156:159], v2, s[8:11], s26 offen offset:0 sc1
    v_mfma_f32_16x16x32_bf16 v[92:95], a[16:19], v[160:163], v[92:95]
    v_exp_f32_e64 v114, v110 clamp
    v_mfma_f32_16x16x32_bf16 v[96:99], a[20:23], v[160:163], v[96:99]
    v_fma_f32 v110, v110, s22, 1.0
    v_exp_f32_e64 v115, v111 clamp
    v_mfma_f32_16x16x32_bf16 v[100:103], a[24:27], v[160:163], v[100:103]
    v_fma_f32 v111, v111, s22, 1.0
    v_max_f32 v108, v108, v112
    v_mfma_f32_16x16x32_bf16 v[104:107], a[28:31], v[160:163], v[104:107]
    v_max_f32 v109, v109, v113
    v_max_f32 v110, v110, v114
    buffer_load_dwordx4 v[160:163], v2, s[8:11], s26 offen offset:1024 sc1
    v_mfma_f32_16x16x32_bf16 v[92:95], a[32:35], v[164:167], v[92:95]
    v_max_f32 v111, v111, v115
    v_add_f32 v108, 897988541, v108
    v_add_f32 v109, 897988541, v109
    v_mfma_f32_16x16x32_bf16 v[96:99], a[36:39], v[164:167], v[96:99]
    v_add_f32 v110, 897988541, v110
    v_add_f32 v111, 897988541, v111
    v_mfma_f32_16x16x32_bf16 v[100:103], a[40:43], v[164:167], v[100:103]
    v_cvt_pk_bf16_f32 v44, v108, v109
    v_cvt_pk_bf16_f32 v45, v110, v111
    v_mul_f32 v116, v48, v144
    v_mfma_f32_16x16x32_bf16 v[104:107], a[44:47], v[164:167], v[104:107]
    v_mul_f32 v117, v49, v145
    v_mul_f32 v118, v50, v146
    buffer_load_dwordx4 v[164:167], v2, s[8:11], s26 offen offset:2048 sc1
    s_waitcnt vmcnt(15)
    v_mfma_f32_16x16x32_bf16 v[92:95], a[48:51], v[168:171], v[92:95]
    v_mul_f32 v119, v51, v147
    v_exp_f32_e64 v120, v116 clamp
    v_mfma_f32_16x16x32_bf16 v[96:99], a[52:55], v[168:171], v[96:99]
    v_fma_f32 v116, v116, s22, 1.0
    v_mfma_f32_16x16x32_bf16 v[100:103], a[56:59], v[168:171], v[100:103]
    v_exp_f32_e64 v121, v117 clamp
    v_fma_f32 v117, v117, s22, 1.0
    v_mfma_f32_16x16x32_bf16 v[104:107], a[60:63], v[168:171], v[104:107]
    v_exp_f32_e64 v122, v118 clamp
    v_fma_f32 v118, v118, s22, 1.0
    buffer_load_dwordx4 v[168:171], v2, s[8:11], s26 offen offset:3072 sc1
    v_mfma_f32_16x16x32_bf16 v[92:95], a[64:67], v[172:175], v[92:95]
    v_exp_f32_e64 v123, v119 clamp
    v_mfma_f32_16x16x32_bf16 v[96:99], a[68:71], v[172:175], v[96:99]
    v_fma_f32 v119, v119, s22, 1.0
    v_max_f32 v116, v116, v120
    v_mfma_f32_16x16x32_bf16 v[100:103], a[72:75], v[172:175], v[100:103]
    v_max_f32 v117, v117, v121
    v_max_f32 v118, v118, v122
    v_max_f32 v119, v119, v123
    v_mfma_f32_16x16x32_bf16 v[104:107], a[76:79], v[172:175], v[104:107]
    v_add_f32 v116, 897988541, v116
    v_add_f32 v117, 897988541, v117
    s_add_u32 s26, s26, 4096
    buffer_load_dwordx4 v[172:175], v2, s[8:11], s26 offen offset:0 sc1
    v_mfma_f32_16x16x32_bf16 v[92:95], a[80:83], v[176:179], v[92:95]
    v_add_f32 v118, 897988541, v118
    v_add_f32 v119, 897988541, v119
    v_cvt_pk_bf16_f32 v46, v116, v117
    v_mfma_f32_16x16x32_bf16 v[96:99], a[84:87], v[176:179], v[96:99]
    v_cvt_pk_bf16_f32 v47, v118, v119
    v_mul_f32 v108, v52, v148
    v_mfma_f32_16x16x32_bf16 v[100:103], a[88:91], v[176:179], v[100:103]
    v_mul_f32 v109, v53, v149
    v_mul_f32 v110, v54, v150
    v_mul_f32 v111, v55, v151
    v_mfma_f32_16x16x32_bf16 v[104:107], a[92:95], v[176:179], v[104:107]
    v_exp_f32_e64 v112, v108 clamp
    buffer_load_dwordx4 v[176:179], v2, s[8:11], s26 offen offset:1024 sc1
    s_waitcnt vmcnt(15)
    v_mfma_f32_16x16x32_bf16 v[92:95], a[96:99], v[180:183], v[92:95]
    v_fma_f32 v108, v108, s22, 1.0
    v_exp_f32_e64 v113, v109 clamp
    v_mfma_f32_16x16x32_bf16 v[96:99], a[100:103], v[180:183], v[96:99]
    v_fma_f32 v109, v109, s22, 1.0
    v_mfma_f32_16x16x32_bf16 v[100:103], a[104:107], v[180:183], v[100:103]
    v_exp_f32_e64 v114, v110 clamp
    v_fma_f32 v110, v110, s22, 1.0
    v_mfma_f32_16x16x32_bf16 v[104:107], a[108:111], v[180:183], v[104:107]
    v_exp_f32_e64 v115, v111 clamp
    v_fma_f32 v111, v111, s22, 1.0
    buffer_load_dwordx4 v[180:183], v2, s[8:11], s26 offen offset:2048 sc1
    v_mfma_f32_16x16x32_bf16 v[92:95], a[112:115], v[184:187], v[92:95]
    v_max_f32 v108, v108, v112
    v_max_f32 v109, v109, v113
    v_mfma_f32_16x16x32_bf16 v[96:99], a[116:119], v[184:187], v[96:99]
    v_max_f32 v110, v110, v114
    v_max_f32 v111, v111, v115
    v_mfma_f32_16x16x32_bf16 v[100:103], a[120:123], v[184:187], v[100:103]
    v_add_f32 v108, 897988541, v108
    v_add_f32 v109, 897988541, v109
    v_add_f32 v110, 897988541, v110
    v_mfma_f32_16x16x32_bf16 v[104:107], a[124:127], v[184:187], v[104:107]
    v_add_f32 v111, 897988541, v111
    v_cvt_pk_bf16_f32 v48, v108, v109
    buffer_load_dwordx4 v[184:187], v2, s[8:11], s26 offen offset:3072 sc1
    v_mfma_f32_16x16x32_bf16 v[92:95], a[128:131], v[188:191], v[92:95]
    v_cvt_pk_bf16_f32 v49, v110, v111
    v_mul_f32 v116, v56, v152
    v_mul_f32 v117, v57, v153
    v_mfma_f32_16x16x32_bf16 v[96:99], a[132:135], v[188:191], v[96:99]
    v_mul_f32 v118, v58, v154
    v_mul_f32 v119, v59, v155
    v_mfma_f32_16x16x32_bf16 v[100:103], a[136:139], v[188:191], v[100:103]
    v_exp_f32_e64 v120, v116 clamp
    v_fma_f32 v116, v116, s22, 1.0
    v_mfma_f32_16x16x32_bf16 v[104:107], a[140:143], v[188:191], v[104:107]
    v_exp_f32_e64 v121, v117 clamp
    s_add_u32 s26, s26, 4096
    buffer_load_dwordx4 v[188:191], v2, s[8:11], s26 offen offset:0 sc1
    s_waitcnt vmcnt(15)
    v_mfma_f32_16x16x32_bf16 v[92:95], a[144:147], v[192:195], v[92:95]
    v_fma_f32 v117, v117, s22, 1.0
    v_exp_f32_e64 v122, v118 clamp
    v_mfma_f32_16x16x32_bf16 v[96:99], a[148:151], v[192:195], v[96:99]
    v_fma_f32 v118, v118, s22, 1.0
    v_mfma_f32_16x16x32_bf16 v[100:103], a[152:155], v[192:195], v[100:103]
    v_exp_f32_e64 v123, v119 clamp
    v_fma_f32 v119, v119, s22, 1.0
    v_mfma_f32_16x16x32_bf16 v[104:107], a[156:159], v[192:195], v[104:107]
    v_max_f32 v116, v116, v120
    v_max_f32 v117, v117, v121
    v_max_f32 v118, v118, v122
    buffer_load_dwordx4 v[192:195], v2, s[8:11], s26 offen offset:1024 sc1
    v_mfma_f32_16x16x32_bf16 v[92:95], a[160:163], v[196:199], v[92:95]
    v_max_f32 v119, v119, v123
    v_add_f32 v116, 897988541, v116
    v_mfma_f32_16x16x32_bf16 v[96:99], a[164:167], v[196:199], v[96:99]
    v_add_f32 v117, 897988541, v117
    v_add_f32 v118, 897988541, v118
    v_mfma_f32_16x16x32_bf16 v[100:103], a[168:171], v[196:199], v[100:103]
    v_add_f32 v119, 897988541, v119
    v_cvt_pk_bf16_f32 v50, v116, v117
    v_cvt_pk_bf16_f32 v51, v118, v119
    v_mfma_f32_16x16x32_bf16 v[104:107], a[172:175], v[196:199], v[104:107]
    v_mul_f32 v60, v60, v228
    v_mul_f32 v61, v61, v229
    buffer_load_dwordx4 v[196:199], v2, s[8:11], s26 offen offset:2048 sc1
    v_mfma_f32_16x16x32_bf16 v[92:95], a[176:179], v[200:203], v[92:95]
    v_cvt_pk_bf16_f32 v60, v60, v61
    v_mul_f32 v62, v62, v230
    v_mul_f32 v63, v63, v231
    v_mfma_f32_16x16x32_bf16 v[96:99], a[180:183], v[200:203], v[96:99]
    v_cvt_pk_bf16_f32 v61, v62, v63
    v_mul_f32 v64, v64, v232
    v_mfma_f32_16x16x32_bf16 v[100:103], a[184:187], v[200:203], v[100:103]
    v_mul_f32 v65, v65, v233
    v_cvt_pk_bf16_f32 v62, v64, v65
    v_mul_f32 v66, v66, v234
    v_mfma_f32_16x16x32_bf16 v[104:107], a[188:191], v[200:203], v[104:107]
    v_mul_f32 v67, v67, v235
    v_cvt_pk_bf16_f32 v63, v66, v67
    buffer_load_dwordx4 v[200:203], v2, s[8:11], s26 offen offset:3072 sc1
    s_waitcnt vmcnt(15)
    v_mfma_f32_16x16x32_bf16 v[92:95], a[192:195], v[204:207], v[92:95]
    v_mul_f32 v68, v68, v236
    v_mul_f32 v69, v69, v237
    v_mfma_f32_16x16x32_bf16 v[96:99], a[196:199], v[204:207], v[96:99]
    v_cvt_pk_bf16_f32 v64, v68, v69
    v_mul_f32 v70, v70, v238
    v_mul_f32 v71, v71, v239
    v_mfma_f32_16x16x32_bf16 v[100:103], a[200:203], v[204:207], v[100:103]
    v_cvt_pk_bf16_f32 v65, v70, v71
    v_mul_f32 v72, v72, v240
    v_mfma_f32_16x16x32_bf16 v[104:107], a[204:207], v[204:207], v[104:107]
    v_mul_f32 v73, v73, v241
    v_cvt_pk_bf16_f32 v66, v72, v73
    v_mul_f32 v74, v74, v242
    s_add_u32 s26, s26, 4096
    buffer_load_dwordx4 v[204:207], v2, s[8:11], s26 offen offset:0 sc1
    v_mfma_f32_16x16x32_bf16 v[92:95], a[208:211], v[208:211], v[92:95]
    v_mul_f32 v75, v75, v243
    v_cvt_pk_bf16_f32 v67, v74, v75
    v_mfma_f32_16x16x32_bf16 v[96:99], a[212:215], v[208:211], v[96:99]
    s_mov_b32 s41, 897988541
    s_mov_b32 s42, 897988541
    s_mov_b32 s43, 897988541
    v_mfma_f32_16x16x32_bf16 v[100:103], a[216:219], v[208:211], v[100:103]
    v_mfma_f32_16x16x32_bf16 v[52:55], v[60:63], v[44:47], 0
    v_mfma_f32_16x16x32_bf16 v[104:107], a[220:223], v[208:211], v[104:107]
    v_mfma_f32_16x16x32_bf16 v[52:55], v[64:67], v[48:51], v[52:55]
    buffer_load_dwordx4 v[208:211], v2, s[8:11], s26 offen offset:1024 sc1
    v_mfma_f32_16x16x32_bf16 v[92:95], a[224:227], v[212:215], v[92:95]
    s_add_u32 s20, s25, 4096
    s_add_u32 s21, s24, s25
    s_mov_b32 s27, s23
    v_mfma_f32_16x16x32_bf16 v[96:99], a[228:231], v[212:215], v[96:99]
    s_mov_b32 s23, s22
    s_nop 0
    v_mfma_f32_16x16x32_bf16 v[100:103], a[232:235], v[212:215], v[100:103]
    s_nop 0
    buffer_atomic_add_f32 v52, v130, s[32:35], s40 offen offset:0
    buffer_atomic_add_f32 v53, v130, s[32:35], s40 offen offset:64
    v_mfma_f32_16x16x32_bf16 v[104:107], a[236:239], v[212:215], v[104:107]
    buffer_atomic_add_f32 v54, v130, s[32:35], s40 offen offset:128
    buffer_atomic_add_f32 v55, v130, s[32:35], s40 offen offset:192
    buffer_load_dwordx4 v[212:215], v2, s[8:11], s26 offen offset:2048 sc1
    s_waitcnt vmcnt(19)
    v_mfma_f32_16x16x32_bf16 v[92:95], a[240:243], v[216:219], v[92:95]
    v_mfma_f32_16x16x32_bf16 v[96:99], a[244:247], v[216:219], v[96:99]
    v_mfma_f32_16x16x32_bf16 v[100:103], a[248:251], v[216:219], v[100:103]
    v_mfma_f32_16x16x32_bf16 v[104:107], a[252:255], v[216:219], v[104:107]
    buffer_load_dwordx4 v[216:219], v2, s[8:11], s26 offen offset:3072 sc1
    v_mfma_f32_16x16x32_bf16 v[92:95], v[12:15], v[220:223], v[92:95]
    v_mfma_f32_16x16x32_bf16 v[96:99], v[16:19], v[220:223], v[96:99]
    v_mfma_f32_16x16x32_bf16 v[100:103], v[20:23], v[220:223], v[100:103]
    v_mfma_f32_16x16x32_bf16 v[104:107], v[24:27], v[220:223], v[104:107]
    s_add_u32 s26, s26, 4096
    buffer_load_dwordx4 v[220:223], v2, s[8:11], s26 offen offset:0 sc1
    v_mfma_f32_16x16x32_bf16 v[92:95], v[28:31], v[224:227], v[92:95]
    v_mfma_f32_16x16x32_bf16 v[96:99], v[32:35], v[224:227], v[96:99]
    v_mfma_f32_16x16x32_bf16 v[100:103], v[36:39], v[224:227], v[100:103]
    v_mfma_f32_16x16x32_bf16 v[104:107], v[40:43], v[224:227], v[104:107]
    buffer_load_dwordx4 v[224:227], v2, s[8:11], s26 offen offset:1024 sc1
    s_nop 3
    v_pk_mul_f32 v[108:109], v[92:93], v[140:141]
    v_pk_mul_f32 v[110:111], v[94:95], v[142:143]
    v_pk_mul_f32 v[112:113], v[96:97], v[144:145]
    v_pk_mul_f32 v[114:115], v[98:99], v[146:147]
    v_exp_f32_e64 v116, v108 clamp
    v_exp_f32_e64 v117, v109 clamp
    v_exp_f32_e64 v118, v110 clamp
    v_exp_f32_e64 v119, v111 clamp
    v_exp_f32_e64 v120, v112 clamp
    v_exp_f32_e64 v121, v113 clamp
    v_exp_f32_e64 v122, v114 clamp
    v_exp_f32_e64 v123, v115 clamp
    v_pk_fma_f32 v[108:109], v[108:109], s[22:23], v[136:137] op_sel_hi:[1,1,0]
    v_pk_fma_f32 v[110:111], v[110:111], s[22:23], v[136:137] op_sel_hi:[1,1,0]
    v_pk_fma_f32 v[112:113], v[112:113], s[22:23], v[136:137] op_sel_hi:[1,1,0]
    v_pk_fma_f32 v[114:115], v[114:115], s[22:23], v[136:137] op_sel_hi:[1,1,0]
    s_mov_b64 exec, s[36:37]
    v_max_f32 v108, v108, v116
    v_max_f32 v109, v109, v117
    v_max_f32 v110, v110, v118
    v_max_f32 v111, v111, v119
    v_max_f32 v112, v112, v120
    v_max_f32 v113, v113, v121
    v_max_f32 v114, v114, v122
    v_max_f32 v115, v115, v123
    v_pk_add_f32 v[108:109], v[108:109], s[42:43]
    v_pk_add_f32 v[110:111], v[110:111], s[42:43]
    v_pk_add_f32 v[112:113], v[112:113], s[42:43]
    v_pk_add_f32 v[114:115], v[114:115], s[42:43]
    s_mov_b64 exec, -1
    v_cvt_pk_bf16_f32 v92, v108, v109
    v_cvt_pk_bf16_f32 v93, v110, v111
    v_cvt_pk_bf16_f32 v94, v112, v113
    v_cvt_pk_bf16_f32 v95, v114, v115
    v_pk_mul_f32 v[108:109], v[100:101], v[148:149]
    v_pk_mul_f32 v[110:111], v[102:103], v[150:151]
    v_pk_mul_f32 v[112:113], v[104:105], v[152:153]
    v_pk_mul_f32 v[114:115], v[106:107], v[154:155]
    v_exp_f32_e64 v116, v108 clamp
    v_exp_f32_e64 v117, v109 clamp
    v_exp_f32_e64 v118, v110 clamp
    v_exp_f32_e64 v119, v111 clamp
    v_exp_f32_e64 v120, v112 clamp
    v_exp_f32_e64 v121, v113 clamp
    v_exp_f32_e64 v122, v114 clamp
    v_exp_f32_e64 v123, v115 clamp
    v_pk_fma_f32 v[108:109], v[108:109], s[22:23], v[136:137] op_sel_hi:[1,1,0]
    v_pk_fma_f32 v[110:111], v[110:111], s[22:23], v[136:137] op_sel_hi:[1,1,0]
    v_pk_fma_f32 v[112:113], v[112:113], s[22:23], v[136:137] op_sel_hi:[1,1,0]
    v_pk_fma_f32 v[114:115], v[114:115], s[22:23], v[136:137] op_sel_hi:[1,1,0]
    s_mov_b64 exec, s[36:37]
    v_max_f32 v108, v108, v116
    v_max_f32 v109, v109, v117
    v_max_f32 v110, v110, v118
    v_max_f32 v111, v111, v119
    v_max_f32 v112, v112, v120
    v_max_f32 v113, v113, v121
    v_max_f32 v114, v114, v122
    v_max_f32 v115, v115, v123
    v_pk_add_f32 v[108:109], v[108:109], s[42:43]
    v_pk_add_f32 v[110:111], v[110:111], s[42:43]
    v_pk_add_f32 v[112:113], v[112:113], s[42:43]
    v_pk_add_f32 v[114:115], v[114:115], s[42:43]
    s_mov_b64 exec, -1
    v_cvt_pk_bf16_f32 v96, v108, v109
    v_cvt_pk_bf16_f32 v97, v110, v111
    v_cvt_pk_bf16_f32 v98, v112, v113
    v_cvt_pk_bf16_f32 v99, v114, v115
    v_mfma_f32_16x16x32_bf16 v[56:59], v[92:95], v[44:47], 0
    v_mfma_f32_16x16x32_bf16 v[68:71], v[60:63], v[92:95], 0
    v_mfma_f32_16x16x32_bf16 v[72:75], v[92:95], v[92:95], 0
    v_mfma_f32_16x16x32_bf16 v[56:59], v[96:99], v[48:51], v[56:59]
    v_mfma_f32_16x16x32_bf16 v[68:71], v[64:67], v[96:99], v[68:71]
    v_mfma_f32_16x16x32_bf16 v[72:75], v[96:99], v[96:99], v[72:75]
    v_mfma_f32_16x16x32_bf16 v[140:143], v[92:95], v[126:129], 0
    v_mfma_f32_16x16x32_bf16 v[144:147], v[92:95], v[124:127], 0
    v_mfma_f32_16x16x32_bf16 v[148:151], v[96:99], v[126:129], 0
    v_mfma_f32_16x16x32_bf16 v[152:155], v[96:99], v[124:127], 0
    s_nop 1
    buffer_atomic_add_f32 v59, v130, s[32:35], s20 offen
    s_mov_b64 exec, s[38:39]
    buffer_atomic_add_f32 v68, v130, s[32:35], s24 offen offset:0
    buffer_atomic_add_f32 v69, v130, s[32:35], s24 offen offset:64
    buffer_atomic_add_f32 v70, v130, s[32:35], s24 offen offset:128
    buffer_atomic_add_f32 v71, v130, s[32:35], s24 offen offset:192
    buffer_atomic_add_f32 v75, v130, s[32:35], s21 offen offset:8
    s_mov_b64 exec, -1
    v_min_u32 v7, 8, v1
    v_lshlrev_b32 v7, 7, v7
    v_add_u32 v7, 103424, v7
    buffer_load_dword v8, v7, s[56:59], 0 offen sc1
    s_getreg_b32 s21, hwreg(HW_REG_XCC_ID, 0, 3)
    s_lshl_b32 s21, s21, 2
    s_and_b32 s20, s2, 7
    s_lshl_b32 s20, s20, 7
    s_add_u32 s20, s20, s21
    s_add_u32 s20, s20, 98304
    buffer_load_dword v4, off, s[56:59], s20 sc1
    s_lshl_b32 s20, s27, 6
    v_lshl_add_u32 v134, v5, 2, s20
    s_waitcnt vmcnt(27)
    v_mfma_f32_16x16x32_bf16 v[76:79], v[156:159], a[0:3], 0
    v_mfma_f32_16x16x32_bf16 v[80:83], v[156:159], a[4:7], 0
    v_mfma_f32_16x16x32_bf16 v[84:87], v[156:159], a[8:11], 0
    v_mfma_f32_16x16x32_bf16 v[88:91], v[156:159], a[12:15], 0
    v_mfma_f32_16x16x32_bf16 v[76:79], v[160:163], a[16:19], v[76:79]
    v_mfma_f32_16x16x32_bf16 v[80:83], v[160:163], a[20:23], v[80:83]
    s_lshl_b32 s20, s3, 1
    s_lshr_b32 s21, s6, 1
    s_add_u32 s20, s20, s21
    s_lshl_b32 s20, s20, 10
    v_mfma_f32_16x16x32_bf16 v[84:87], v[160:163], a[24:27], v[84:87]
    v_mfma_f32_16x16x32_bf16 v[88:91], v[160:163], a[28:31], v[88:91]
    v_mfma_f32_16x16x32_bf16 v[76:79], v[164:167], a[32:35], v[76:79]
    v_mfma_f32_16x16x32_bf16 v[80:83], v[164:167], a[36:39], v[80:83]
    v_mfma_f32_16x16x32_bf16 v[84:87], v[164:167], a[40:43], v[84:87]
    v_mfma_f32_16x16x32_bf16 v[88:91], v[164:167], a[44:47], v[88:91]
    s_waitcnt vmcnt(24)
    v_mfma_f32_16x16x32_bf16 v[76:79], v[168:171], a[48:51], v[76:79]
    v_mfma_f32_16x16x32_bf16 v[80:83], v[168:171], a[52:55], v[80:83]
    s_and_b32 s21, s6, 1
    s_lshl_b32 s21, s21, 3
    s_add_u32 s20, s20, s21
    v_mfma_f32_16x16x32_bf16 v[84:87], v[168:171], a[56:59], v[84:87]
    v_mfma_f32_16x16x32_bf16 v[88:91], v[168:171], a[60:63], v[88:91]
    v_mfma_f32_16x16x32_bf16 v[76:79], v[172:175], a[64:67], v[76:79]
    v_mfma_f32_16x16x32_bf16 v[80:83], v[172:175], a[68:71], v[80:83]
    v_mfma_f32_16x16x32_bf16 v[84:87], v[172:175], a[72:75], v[84:87]
    v_add_u32 v133, s20, v2
    v_mfma_f32_16x16x32_bf16 v[88:91], v[172:175], a[76:79], v[88:91]
    v_mfma_f32_16x16x32_bf16 v[76:79], v[176:179], a[80:83], v[76:79]
    v_mfma_f32_16x16x32_bf16 v[80:83], v[176:179], a[84:87], v[80:83]
    v_cvt_pk_bf16_f32 v140, v140, v141
    v_mfma_f32_16x16x32_bf16 v[84:87], v[176:179], a[88:91], v[84:87]
    v_mfma_f32_16x16x32_bf16 v[88:91], v[176:179], a[92:95], v[88:91]
    v_cvt_pk_bf16_f32 v144, v144, v145
    s_waitcnt vmcnt(21)
    v_mfma_f32_16x16x32_bf16 v[76:79], v[180:183], a[96:99], v[76:79]
    v_mfma_f32_16x16x32_bf16 v[80:83], v[180:183], a[100:103], v[80:83]
    v_mfma_f32_16x16x32_bf16 v[84:87], v[180:183], a[104:107], v[84:87]
    v_cvt_pk_bf16_f32 v148, v148, v149
    v_mfma_f32_16x16x32_bf16 v[88:91], v[180:183], a[108:111], v[88:91]
    v_mfma_f32_16x16x32_bf16 v[76:79], v[184:187], a[112:115], v[76:79]
    v_cvt_pk_bf16_f32 v152, v152, v153
    v_mfma_f32_16x16x32_bf16 v[80:83], v[184:187], a[116:119], v[80:83]
    v_mfma_f32_16x16x32_bf16 v[84:87], v[184:187], a[120:123], v[84:87]
    v_mfma_f32_16x16x32_bf16 v[88:91], v[184:187], a[124:127], v[88:91]
    v_mfma_f32_16x16x32_bf16 v[76:79], v[188:191], a[128:131], v[76:79]
    v_mfma_f32_16x16x32_bf16 v[80:83], v[188:191], a[132:135], v[80:83]
    v_mfma_f32_16x16x32_bf16 v[84:87], v[188:191], a[136:139], v[84:87]
    v_mfma_f32_16x16x32_bf16 v[88:91], v[188:191], a[140:143], v[88:91]
    s_lshl_b32 s20, s44, 7
    s_add_u32 s20, s20, 131072
    s_lshr_b32 s21, s2, 3
    s_and_b32 s21, s21, 15
    s_waitcnt vmcnt(18)
    v_mfma_f32_16x16x32_bf16 v[76:79], v[192:195], a[144:147], v[76:79]
    v_mfma_f32_16x16x32_bf16 v[80:83], v[192:195], a[148:151], v[80:83]
    v_mfma_f32_16x16x32_bf16 v[84:87], v[192:195], a[152:155], v[84:87]
    v_mfma_f32_16x16x32_bf16 v[88:91], v[192:195], a[156:159], v[88:91]
    v_mfma_f32_16x16x32_bf16 v[76:79], v[196:199], a[160:163], v[76:79]
    v_mfma_f32_16x16x32_bf16 v[80:83], v[196:199], a[164:167], v[80:83]
    v_mfma_f32_16x16x32_bf16 v[84:87], v[196:199], a[168:171], v[84:87]
    s_lshl_b32 s21, s21, 8
    s_add_u32 s21, s21, s20
    v_mfma_f32_16x16x32_bf16 v[88:91], v[196:199], a[172:175], v[88:91]
    v_mfma_f32_16x16x32_bf16 v[76:79], v[200:203], a[176:179], v[76:79]
    v_mfma_f32_16x16x32_bf16 v[80:83], v[200:203], a[180:183], v[80:83]
    v_mfma_f32_16x16x32_bf16 v[84:87], v[200:203], a[184:187], v[84:87]
    v_mov_b32 v3, 1
    v_mfma_f32_16x16x32_bf16 v[88:91], v[200:203], a[188:191], v[88:91]
    s_waitcnt vmcnt(11)
    v_mfma_f32_16x16x32_bf16 v[76:79], v[204:207], a[192:195], v[76:79]
    v_lshlrev_b32 v9, 12, v1
    v_mfma_f32_16x16x32_bf16 v[80:83], v[204:207], a[196:199], v[80:83]
    v_mfma_f32_16x16x32_bf16 v[84:87], v[204:207], a[200:203], v[84:87]
    v_mfma_f32_16x16x32_bf16 v[88:91], v[204:207], a[204:207], v[88:91]
    v_mfma_f32_16x16x32_bf16 v[76:79], v[208:211], a[208:211], v[76:79]
    v_mfma_f32_16x16x32_bf16 v[80:83], v[208:211], a[212:215], v[80:83]
    s_mul_i32 s100, s6, 36864
    s_lshr_b32 s99, s6, 1
    s_mul_i32 s99, s99, 18432
    v_mfma_f32_16x16x32_bf16 v[84:87], v[208:211], a[216:219], v[84:87]
    v_mfma_f32_16x16x32_bf16 v[88:91], v[208:211], a[220:223], v[88:91]
    v_mfma_f32_16x16x32_bf16 v[76:79], v[212:215], a[224:227], v[76:79]
    v_mfma_f32_16x16x32_bf16 v[80:83], v[212:215], a[228:231], v[80:83]
    v_mfma_f32_16x16x32_bf16 v[84:87], v[212:215], a[232:235], v[84:87]
    v_mfma_f32_16x16x32_bf16 v[88:91], v[212:215], a[236:239], v[88:91]
    s_waitcnt vmcnt(8)
    v_mfma_f32_16x16x32_bf16 v[76:79], v[216:219], a[240:243], v[76:79]
    s_add_u32 s101, s100, 18432
    s_sub_u32 s101, s101, s99
    v_mfma_f32_16x16x32_bf16 v[80:83], v[216:219], a[244:247], v[80:83]
    v_mfma_f32_16x16x32_bf16 v[84:87], v[216:219], a[248:251], v[84:87]
    v_mfma_f32_16x16x32_bf16 v[88:91], v[216:219], a[252:255], v[88:91]
    v_mfma_f32_16x16x32_bf16 v[76:79], v[220:223], v[12:15], v[76:79]
    v_mfma_f32_16x16x32_bf16 v[80:83], v[220:223], v[16:19], v[80:83]
    v_mfma_f32_16x16x32_bf16 v[84:87], v[220:223], v[20:23], v[84:87]
    s_add_u32 s100, s100, s99
    s_lshr_b32 s99, s99, 1
    s_add_u32 s99, s99, 147456
    v_mfma_f32_16x16x32_bf16 v[88:91], v[220:223], v[24:27], v[88:91]
    v_mfma_f32_16x16x32_bf16 v[76:79], v[224:227], v[28:31], v[76:79]
    v_mfma_f32_16x16x32_bf16 v[80:83], v[224:227], v[32:35], v[80:83]
    v_mfma_f32_16x16x32_bf16 v[84:87], v[224:227], v[36:39], v[84:87]
    v_mfma_f32_16x16x32_bf16 v[88:91], v[224:227], v[40:43], v[88:91]
    s_waitcnt vmcnt(2)
    s_barrier
    s_cmp_lg_u32 s6, 2
    s_cbranch_scc1 L_q_noarr
    s_mov_b64 exec, 0xff
    buffer_atomic_add v3, v9, s[56:59], s21 offen
    s_mov_b64 exec, -1
L_q_noarr:
    v_accvgpr_write_b32 a232, v124
    v_accvgpr_write_b32 a233, v125
    v_accvgpr_write_b32 a234, v126
    v_accvgpr_write_b32 a235, v127
    v_accvgpr_write_b32 a236, v128
    v_accvgpr_write_b32 a237, v129
    v_pk_mul_f32 v[108:109], v[76:77], v[244:245] op_sel_hi:[1,0]
    v_pk_mul_f32 v[110:111], v[78:79], v[244:245] op_sel_hi:[1,0]
    v_pk_mul_f32 v[112:113], v[80:81], v[244:245] op_sel:[0,1]
    v_pk_mul_f32 v[114:115], v[82:83], v[244:245] op_sel:[0,1]
    v_exp_f32_e64 v116, v108 clamp
    v_exp_f32_e64 v117, v109 clamp
    v_exp_f32_e64 v118, v110 clamp
    v_exp_f32_e64 v119, v111 clamp
    v_exp_f32_e64 v120, v112 clamp
    v_exp_f32_e64 v121, v113 clamp
    v_exp_f32_e64 v122, v114 clamp
    v_exp_f32_e64 v123, v115 clamp
    v_pk_fma_f32 v[108:109], v[108:109], s[22:23], 1.0 op_sel_hi:[1,1,0]
    v_pk_fma_f32 v[110:111], v[110:111], s[22:23], 1.0 op_sel_hi:[1,1,0]
    v_pk_fma_f32 v[112:113], v[112:113], s[22:23], 1.0 op_sel_hi:[1,1,0]
    v_pk_fma_f32 v[114:115], v[114:115], s[22:23], 1.0 op_sel_hi:[1,1,0]
    v_max_f32 v108, v108, v116
    v_max_f32 v109, v109, v117
    v_max_f32 v110, v110, v118
    v_max_f32 v111, v111, v119
    v_max_f32 v112, v112, v120
    v_max_f32 v113, v113, v121
    v_max_f32 v114, v114, v122
    v_max_f32 v115, v115, v123
    v_pk_add_f32 v[108:109], v[108:109], s[42:43]
    v_pk_add_f32 v[110:111], v[110:111], s[42:43]
    v_pk_add_f32 v[112:113], v[112:113], s[42:43]
    v_pk_add_f32 v[114:115], v[114:115], s[42:43]
    v_cvt_pk_bf16_f32 v76, v108, v109
    v_cvt_pk_bf16_f32 v77, v110, v111
    v_cvt_pk_bf16_f32 v78, v112, v113
    v_cvt_pk_bf16_f32 v79, v114, v115
    s_mov_b32 exec_lo, 0xffff0000
    s_mov_b32 exec_hi, 0
    buffer_store_dword v140, v134, s[12:15], 0 offen offset:0
    buffer_store_dword v144, v134, s[12:15], 0 offen offset:256
    buffer_store_dword v148, v134, s[12:15], 0 offen offset:512
    buffer_store_dword v152, v134, s[12:15], 0 offen offset:768
    s_mov_b64 exec, -1
    s_mov_b32 s20, 0
    buffer_store_dwordx2 v[76:77], v133, s[16:19], s20 offen
    s_mov_b32 s20, 16384
    buffer_store_dwordx2 v[78:79], v133, s[16:19], s20 offen
    v_pk_mul_f32 v[108:109], v[84:85], v[246:247] op_sel_hi:[1,0]
    v_pk_mul_f32 v[110:111], v[86:87], v[246:247] op_sel_hi:[1,0]
    v_pk_mul_f32 v[112:113], v[88:89], v[246:247] op_sel:[0,1]
    v_pk_mul_f32 v[114:115], v[90:91], v[246:247] op_sel:[0,1]
    v_exp_f32_e64 v116, v108 clamp
    v_exp_f32_e64 v117, v109 clamp
    v_exp_f32_e64 v118, v110 clamp
    v_exp_f32_e64 v119, v111 clamp
    v_exp_f32_e64 v120, v112 clamp
    v_exp_f32_e64 v121, v113 clamp
    v_exp_f32_e64 v122, v114 clamp
    v_exp_f32_e64 v123, v115 clamp
    v_pk_fma_f32 v[108:109], v[108:109], s[22:23], 1.0 op_sel_hi:[1,1,0]
    v_pk_fma_f32 v[110:111], v[110:111], s[22:23], 1.0 op_sel_hi:[1,1,0]
    v_pk_fma_f32 v[112:113], v[112:113], s[22:23], 1.0 op_sel_hi:[1,1,0]
    v_pk_fma_f32 v[114:115], v[114:115], s[22:23], 1.0 op_sel_hi:[1,1,0]
    v_max_f32 v108, v108, v116
    v_max_f32 v109, v109, v117
    v_max_f32 v110, v110, v118
    v_max_f32 v111, v111, v119
    v_max_f32 v112, v112, v120
    v_max_f32 v113, v113, v121
    v_max_f32 v114, v114, v122
    v_max_f32 v115, v115, v123
    v_pk_add_f32 v[108:109], v[108:109], s[42:43]
    v_pk_add_f32 v[110:111], v[110:111], s[42:43]
    v_pk_add_f32 v[112:113], v[112:113], s[42:43]
    v_pk_add_f32 v[114:115], v[114:115], s[42:43]
    v_cvt_pk_bf16_f32 v80, v108, v109
    v_cvt_pk_bf16_f32 v81, v110, v111
    v_cvt_pk_bf16_f32 v82, v112, v113
    v_cvt_pk_bf16_f32 v83, v114, v115
    s_mov_b32 s20, 32768
    buffer_store_dwordx2 v[80:81], v133, s[16:19], s20 offen
    s_mov_b32 s20, 49152
    buffer_store_dwordx2 v[82:83], v133, s[16:19], s20 offen
    s_waitcnt vmcnt(8)
    v_readfirstlane_b32 s45, v4
    s_nop 0
    s_cmp_eq_u32 s45, 32
    s_cselect_b32 s45, 1, 0
    s_add_u32 s20, s52, 12288
    v_mov_b32 v3, 1
    s_waitcnt vmcnt(0)
    s_mov_b64 exec, 1
    s_cmp_eq_u32 s45, 1
    s_cbranch_scc1 L_sigf7
    buffer_wbl2 sc1
    s_waitcnt vmcnt(0)
    buffer_store_dword v3, off, s[56:59], s20 sc1
    s_branch L_sigd7
L_sigf7:
    buffer_store_dword v3, off, s[56:59], s20
L_sigd7:
    s_mov_b64 exec, -1
    s_mov_b32 s21, 131072
L_wo_chk:
    v_cmp_ne_u32 vcc, 0, v8
    s_sub_u32 s21, s21, 1
    s_nop 0
    s_cmp_eq_u64 vcc, exec
    s_cbranch_scc1 L_wo_ok
    buffer_load_dword v8, v7, s[56:59], 0 offen sc1
    s_waitcnt vmcnt(0)
    s_cmp_lg_u32 s21, 0
    s_cbranch_scc1 L_wo_chk
L_wo_ok:
    buffer_load_dwordx4 a[0:3], v2, s[28:31], s100 offen offset:0 sc1
    buffer_load_dwordx4 a[4:7], v2, s[28:31], s100 offen offset:1024 sc1
    buffer_load_dwordx4 a[144:147], v2, s[28:31], s99 offen offset:0 sc1
    buffer_load_dwordx4 a[8:11], v2, s[28:31], s100 offen offset:2048 sc1
    buffer_load_dwordx4 a[12:15], v2, s[28:31], s100 offen offset:3072 sc1
    buffer_load_dwordx4 a[148:151], v2, s[28:31], s99 offen offset:1024 sc1
    s_add_u32 s100, s100, 4096
    buffer_load_dwordx4 a[16:19], v2, s[28:31], s100 offen offset:0 sc1
    buffer_load_dwordx4 a[20:23], v2, s[28:31], s100 offen offset:1024 sc1
    s_mul_i32 s21, s6, 12288
    s_mul_i32 s22, s44, 49152
    s_add_u32 s21, s21, s22
    s_add_u32 s21, s21, 13697024
    s_add_u32 s8, s4, s21
    s_addc_u32 s9, s5, 0
    s_and_b32 s9, s9, 0xffff
    s_mov_b32 s10, 12288
    s_mov_b32 s11, 0x20000
    s_lshl_b32 s22, s53, 15
    s_add_u32 s22, s22, 35651584
    s_add_u32 s12, s4, s22
    s_addc_u32 s13, s5, 0
    s_and_b32 s13, s13, 0xffff
    s_mov_b32 s14, 32768
    s_mov_b32 s15, 0x20000
    s_lshl_b32 s23, s7, 13
    s_add_u32 s23, s23, 37748736
    s_add_u32 s16, s4, s23
    s_addc_u32 s17, s5, 0
    s_and_b32 s17, s17, 0xffff
    s_mov_b32 s18, 8192
    s_mov_b32 s19, 0x20000
    s_mul_i32 s21, s53, 36864
    s_add_u32 s22, s21, 13893632
    s_add_u32 s32, s4, s22
    s_addc_u32 s33, s5, 0
    s_and_b32 s33, s33, 0xffff
    s_mov_b32 s34, 36864
    s_mov_b32 s35, 0x20000
    s_and_b32 s25, s6, 1
    s_mul_i32 s24, s25, 18432
    s_mul_i32 s40, s54, 9
    s_add_u32 s40, s40, 1
    s_lshr_b32 s40, s40, 1
    s_add_u32 s40, s40, s6
    s_lshl_b32 s40, s40, 10
    s_add_u32 s41, s40, 18432
    s_sub_u32 s41, s41, s24
    s_add_u32 s40, s40, s24
    s_lshr_b32 s42, s54, 1
    s_mul_i32 s42, s42, 9
    s_add_u32 s42, s42, 4
    s_lshl_b32 s42, s42, 10
    s_add_u32 s42, s42, s24
    s_and_b32 s43, s54, 1
    s_lshl_b32 s43, s43, 3
    s_add_u32 s43, s43, s42
    v_lshlrev_b32 v252, 2, v1
    v_mov_b32 v109, 0
    v_mov_b32 v113, 0
    v_mov_b32 v119, 0
    v_mov_b32 v123, 0
    v_mov_b32 v125, 0
    v_mov_b32 v129, 0
    v_mov_b32 v135, 0
    v_mov_b32 v139, 0
    v_mov_b32 v140, 0
    v_mov_b32 v144, 0
    v_mov_b32 v150, 0
    v_mov_b32 v154, 0
    v_mov_b32 v156, 0
    v_mov_b32 v160, 0
    v_mov_b32 v166, 0
    v_mov_b32 v170, 0
    s_lshl_b32 s20, s6, 13
    s_add_u32 s20, s20, 73728
    v_add_u32 v6, s20, v2
    s_lshr_b32 s20, s6, 1
    s_lshl_b32 s20, s20, 11
    s_lshl_b32 s21, s25, 3
    s_add_u32 s20, s20, s21
    s_add_u32 s20, s20, 106496
    v_add_u32 v7, s20, v2
    s_lshl_b32 s20, s25, 10
    s_lshr_b32 s22, s6, 1
    s_mul_i32 s22, s22, 18432
    s_add_u32 s22, s22, 73728
    s_add_u32 s21, s20, s22
    v_add_u32 v4, s21, v2
    s_sub_u32 s21, s22, s20
    s_add_u32 s21, s21, 1024
    v_add_u32 v5, s21, v2
    s_sub_u32 s22, 165888, s22
    s_add_u32 s21, s20, s22
    v_add_u32 v253, s21, v2
    s_sub_u32 s21, s22, s20
    s_add_u32 s21, s21, 1024
    v_add_u32 v254, s21, v2
    s_lshl_b32 s37, s6, 11
    s_and_b32 s21, s53, 1
    s_lshl_b32 s21, s21, 9
    s_add_u32 s37, s37, s21
    s_lshl_b32 s38, s6, 12
    s_add_u32 s39, s38, 16384
    s_bitcmp0_b32 s54, 0
    s_cselect_b64 vcc, -1, 0
    v_accvgpr_read_b32 v12, a234
    v_accvgpr_read_b32 v13, a235
    s_cmp_lt_u32 s6, 2
    s_cselect_b32 s20, -1, 0
    v_and_b32 v12, s20, v12
    v_and_b32 v13, s20, v13
    v_cndmask_b32 v14, 0, v12, vcc
    v_cndmask_b32 v15, 0, v13, vcc
    v_cndmask_b32 v16, v12, 0, vcc
    v_cndmask_b32 v17, v13, 0, vcc
    v_accvgpr_write_b32 a228, v14
    v_accvgpr_write_b32 a229, v15
    v_accvgpr_write_b32 a230, v16
    v_accvgpr_write_b32 a231, v17
    buffer_load_dwordx4 a[152:155], v2, s[28:31], s99 offen offset:2048 sc1
    buffer_load_dwordx4 a[24:27], v2, s[28:31], s100 offen offset:2048 sc1
    buffer_load_dwordx4 a[28:31], v2, s[28:31], s100 offen offset:3072 sc1
    buffer_load_dwordx4 a[156:159], v2, s[28:31], s99 offen offset:3072 sc1
    s_add_u32 s100, s100, 4096
    buffer_load_dwordx4 a[32:35], v2, s[28:31], s100 offen offset:0 sc1
    buffer_load_dwordx4 a[36:39], v2, s[28:31], s100 offen offset:1024 sc1
    s_add_u32 s99, s99, 4096
    buffer_load_dwordx4 a[160:163], v2, s[28:31], s99 offen offset:0 sc1
    buffer_load_dwordx4 a[40:43], v2, s[28:31], s100 offen offset:2048 sc1
    buffer_load_dwordx4 a[44:47], v2, s[28:31], s100 offen offset:3072 sc1
    buffer_load_dwordx4 a[164:167], v2, s[28:31], s99 offen offset:1024 sc1
    s_add_u32 s100, s100, 4096
    buffer_load_dwordx4 a[48:51], v2, s[28:31], s100 offen offset:0 sc1
    buffer_load_dwordx4 a[52:55], v2, s[28:31], s100 offen offset:1024 sc1
    buffer_load_dwordx4 a[168:171], v2, s[28:31], s99 offen offset:2048 sc1
    buffer_load_dwordx4 a[56:59], v2, s[28:31], s100 offen offset:2048 sc1
    buffer_load_dwordx4 a[60:63], v2, s[28:31], s100 offen offset:3072 sc1
    buffer_load_dwordx4 a[172:175], v2, s[28:31], s99 offen offset:3072 sc1
    s_add_u32 s100, s100, 4096
    buffer_load_dwordx4 a[64:67], v2, s[28:31], s100 offen offset:0 sc1
    buffer_load_dwordx4 a[68:71], v2, s[28:31], s100 offen offset:1024 sc1
    s_cmp_lg_u32 s6, 3
    s_cbranch_scc1 L_gb_done
    s_and_b32 s20, s2, 7
    s_lshl_b32 s20, s20, 12
    s_lshl_b32 s21, s44, 7
    s_add_u32 s20, s20, s21
    s_add_u32 s20, s20, 131072
    v_and_b32 v12, 15, v1
    v_lshl_add_u32 v12, v12, 8, s20
    s_add_u32 s23, s51, 12288
    v_lshl_add_u32 v13, v1, 2, s23
    v_cmp_gt_u32 vcc, 32, v1
    s_nop 1
    v_cndmask_b32 v12, v12, v13, vcc
    v_cndmask_b32 v13, 16, 1, vcc
    s_mov_b32 s21, 131072
L_gb_spin:
    buffer_load_dword v14, v12, s[56:59], 0 offen sc1
    s_waitcnt vmcnt(0)
    v_cmp_le_u32 vcc, v13, v14
    s_sub_u32 s21, s21, 1
    s_nop 0
    s_cmp_eq_u64 vcc, exec
    s_cbranch_scc1 L_gb_done
    s_cmp_lg_u32 s21, 0
    s_cbranch_scc1 L_gb_spin
L_gb_done:
    s_barrier
    s_cmp_eq_u32 s45, 1
    s_cbranch_scc1 L_gb_fast
    buffer_inv sc1
    s_waitcnt vmcnt(0)
L_gb_fast:
    s_mov_b32 s20, 4096
    s_mov_b32 s21, 0
    buffer_load_dwordx4 v[24:27], v2, s[8:11], s20 offen offset:0 sc1
    buffer_load_dwordx4 v[28:31], v2, s[8:11], s20 offen offset:1024 sc1
    buffer_load_dwordx4 v[8:11], v2, s[8:11], s21 offen offset:0 sc1
    buffer_load_dwordx4 v[12:15], v2, s[8:11], s21 offen offset:1024 sc1
    buffer_load_dwordx4 v[16:19], v2, s[8:11], s21 offen offset:2048 sc1
    buffer_load_dwordx4 v[20:23], v2, s[8:11], s21 offen offset:3072 sc1
    buffer_load_dword v56, v252, s[16:19], s37 offen offset:0 sc1
    buffer_load_dword v57, v252, s[16:19], s37 offen offset:1024 sc1
    buffer_load_dword v82, v252, s[16:19], s37 offen offset:256 sc1
    buffer_load_dword v83, v252, s[16:19], s37 offen offset:1280 sc1
    buffer_load_dwordx4 v[58:61], v2, s[12:15], s38 offen offset:0 sc1
    buffer_load_dwordx4 v[64:67], v2, s[12:15], s38 offen offset:1024 sc1
    buffer_load_dwordx4 v[84:87], v2, s[12:15], s39 offen offset:0 sc1
    buffer_load_dwordx4 v[90:93], v2, s[12:15], s39 offen offset:1024 sc1
    s_mov_b32 s20, 10240
    s_mov_b32 s21, 6144
    buffer_load_dwordx4 v[48:51], v2, s[8:11], s20 offen offset:0 sc1
    buffer_load_dwordx4 v[52:55], v2, s[8:11], s20 offen offset:1024 sc1
    buffer_load_dwordx4 v[32:35], v2, s[8:11], s21 offen offset:0 sc1
    buffer_load_dwordx4 v[36:39], v2, s[8:11], s21 offen offset:1024 sc1
    buffer_load_dwordx4 v[40:43], v2, s[8:11], s21 offen offset:2048 sc1
    buffer_load_dwordx4 v[44:47], v2, s[8:11], s21 offen offset:3072 sc1
    buffer_load_dwordx4 v[70:73], v2, s[12:15], s38 offen offset:2048 sc1
    buffer_load_dwordx4 v[76:79], v2, s[12:15], s38 offen offset:3072 sc1
    buffer_load_dwordx4 v[96:99], v2, s[12:15], s39 offen offset:2048 sc1
    buffer_load_dwordx4 v[102:105], v2, s[12:15], s39 offen offset:3072 sc1
    s_getreg_b32 s21, hwreg(HW_REG_XCC_ID, 0, 3)
    s_lshl_b32 s21, s21, 2
    s_and_b32 s20, s2, 7
    s_lshl_b32 s20, s20, 7
    s_add_u32 s20, s20, s21
    s_add_u32 s20, s20, 98304
    buffer_load_dword v3, off, s[56:59], s20 sc1
    buffer_load_dwordx4 a[216:219], v2, s[32:35], s40 offen sc1
    buffer_load_dwordx4 a[220:223], v2, s[32:35], s41 offen sc1
    buffer_load_dwordx4 a[224:227], v2, s[32:35], s42 offen sc1
    s_mov_b32 s12, 983055
    s_mov_b32 s13, 983055
    s_mov_b32 s20, 4294901760
    s_mov_b32 s21, 0
    s_mov_b32 s14, 15728880
    s_mov_b32 s15, 15728880
    s_mov_b32 s22, 0
    s_mov_b32 s23, 65535
    s_mov_b32 s16, 251662080
    s_mov_b32 s17, 251662080
    s_mov_b32 s24, 0
    s_mov_b32 s25, 4294901760
    s_mov_b32 s18, 4026593280
    s_mov_b32 s19, 4026593280
    s_mov_b32 s26, 65535
    s_mov_b32 s27, 0
    s_waitcnt vmcnt(22)
    v_cvt_pk_bf16_f32 v24, v24, v25
    v_cvt_pk_bf16_f32 v25, v26, v27
    v_cvt_pk_bf16_f32 v28, v28, v29
    v_cvt_pk_bf16_f32 v30, v30, v31
    v_cndmask_b32 v114, 0, v24, s[12:13]
    v_cndmask_b32 v115, 0, v25, s[12:13]
    v_cndmask_b32 v112, 0, v30, s[12:13]
    v_cndmask_b32 v120, 0, v24, s[14:15]
    v_cndmask_b32 v121, 0, v25, s[14:15]
    v_cndmask_b32 v122, 0, v30, s[14:15]
    v_cndmask_b32 v130, 0, v24, s[16:17]
    v_cndmask_b32 v131, 0, v25, s[16:17]
    v_cndmask_b32 v128, 0, v30, s[16:17]
    v_cndmask_b32 v136, 0, v24, s[18:19]
    v_cndmask_b32 v137, 0, v25, s[18:19]
    v_cndmask_b32 v138, 0, v30, s[18:19]
    v_cvt_pk_bf16_f32 v110, v8, v9
    v_cvt_pk_bf16_f32 v111, v10, v11
    v_cndmask_b32 v108, 0, v28, s[20:21]
    v_cvt_pk_bf16_f32 v116, v12, v13
    v_cvt_pk_bf16_f32 v117, v14, v15
    v_cndmask_b32 v118, 0, v28, s[22:23]
    v_cvt_pk_bf16_f32 v126, v16, v17
    v_cvt_pk_bf16_f32 v127, v18, v19
    v_cndmask_b32 v124, 0, v28, s[24:25]
    v_cvt_pk_bf16_f32 v132, v20, v21
    v_cvt_pk_bf16_f32 v133, v22, v23
    v_cndmask_b32 v134, 0, v28, s[26:27]
    s_waitcnt vmcnt(18)
    v_mov_b64 v[62:63], v[56:57]
    v_mov_b64 v[68:69], v[56:57]
    v_mov_b64 v[74:75], v[56:57]
    v_mov_b64 v[80:81], v[56:57]
    v_mov_b64 v[88:89], v[82:83]
    v_mov_b64 v[94:95], v[82:83]
    v_mov_b64 v[100:101], v[82:83]
    v_mov_b64 v[106:107], v[82:83]
    s_waitcnt vmcnt(8)
    v_mfma_f32_16x16x32_bf16 v[236:239], v[112:115], v[56:59], 0
    v_cvt_pk_bf16_f32 v48, v48, v49
    v_cvt_pk_bf16_f32 v49, v50, v51
    v_mfma_f32_16x16x32_bf16 v[240:243], v[112:115], v[82:85], 0
    s_add_u32 s99, s99, 4096
    buffer_load_dwordx4 a[176:179], v2, s[28:31], s99 offen offset:0 sc1
    v_cvt_pk_bf16_f32 v52, v52, v53
    v_cvt_pk_bf16_f32 v54, v54, v55
    v_mfma_f32_16x16x32_bf16 v[236:239], v[120:123], v[60:63], v[236:239]
    v_cndmask_b32 v146, 0, v48, s[12:13]
    v_cndmask_b32 v147, 0, v49, s[12:13]
    v_mfma_f32_16x16x32_bf16 v[240:243], v[120:123], v[86:89], v[240:243]
    v_cndmask_b32 v145, 0, v54, s[12:13]
    v_cndmask_b32 v152, 0, v48, s[14:15]
    v_mfma_f32_16x16x32_bf16 v[236:239], v[128:131], v[62:65], v[236:239]
    v_cndmask_b32 v153, 0, v49, s[14:15]
    v_cndmask_b32 v155, 0, v54, s[14:15]
    v_mfma_f32_16x16x32_bf16 v[240:243], v[128:131], v[88:91], v[240:243]
    s_mov_b32 s100, s101
    buffer_load_dwordx4 a[72:75], v2, s[28:31], s100 offen offset:0 sc1
    v_cndmask_b32 v162, 0, v48, s[16:17]
    v_cndmask_b32 v163, 0, v49, s[16:17]
    v_mfma_f32_16x16x32_bf16 v[236:239], v[136:139], v[66:69], v[236:239]
    v_cndmask_b32 v161, 0, v54, s[16:17]
    v_cndmask_b32 v168, 0, v48, s[18:19]
    v_mfma_f32_16x16x32_bf16 v[240:243], v[136:139], v[92:95], v[240:243]
    v_cndmask_b32 v169, 0, v49, s[18:19]
    v_cndmask_b32 v171, 0, v54, s[18:19]
    v_mfma_f32_16x16x32_bf16 v[172:175], v[108:111], v[56:59], 0
    v_cvt_pk_bf16_f32 v142, v32, v33
    v_cvt_pk_bf16_f32 v143, v34, v35
    v_mfma_f32_16x16x32_bf16 v[176:179], v[108:111], v[82:85], 0
    buffer_load_dwordx4 a[76:79], v2, s[28:31], s100 offen offset:1024 sc1
    v_cndmask_b32 v141, 0, v52, s[20:21]
    v_cvt_pk_bf16_f32 v148, v36, v37
    v_mfma_f32_16x16x32_bf16 v[180:183], v[116:119], v[60:63], 0
    v_cvt_pk_bf16_f32 v149, v38, v39
    v_cndmask_b32 v151, 0, v52, s[22:23]
    v_mfma_f32_16x16x32_bf16 v[184:187], v[116:119], v[86:89], 0
    v_cvt_pk_bf16_f32 v158, v40, v41
    v_cvt_pk_bf16_f32 v159, v42, v43
    v_mfma_f32_16x16x32_bf16 v[188:191], v[124:127], v[62:65], 0
    v_cndmask_b32 v157, 0, v52, s[24:25]
    v_mfma_f32_16x16x32_bf16 v[192:195], v[124:127], v[88:91], 0
    buffer_load_dwordx4 a[80:83], v2, s[28:31], s100 offen offset:2048 sc1
    v_cvt_pk_bf16_f32 v164, v44, v45
    v_mfma_f32_16x16x32_bf16 v[196:199], v[132:135], v[66:69], 0
    v_cvt_pk_bf16_f32 v165, v46, v47
    v_mfma_f32_16x16x32_bf16 v[200:203], v[132:135], v[92:95], 0
    v_cndmask_b32 v167, 0, v52, s[26:27]
    s_waitcnt vmcnt(8)
    v_mfma_f32_16x16x32_bf16 v[244:247], v[144:147], v[68:71], 0
    v_add_f32 v8, 897988541, v239
    v_add_f32 v12, 897988541, v243
    v_mfma_f32_16x16x32_bf16 v[248:251], v[144:147], v[94:97], 0
    buffer_load_dwordx4 a[84:87], v2, s[28:31], s100 offen offset:3072 sc1
    v_rcp_f32 v8, v8
    v_rcp_f32 v12, v12
    v_mfma_f32_16x16x32_bf16 v[244:247], v[152:155], v[72:75], v[244:247]
    v_mov_b32 v9, v8
    v_mov_b32 v13, v12
    v_mfma_f32_16x16x32_bf16 v[248:251], v[152:155], v[98:101], v[248:251]
    v_mul_f32 v236, v236, v8
    v_mul_f32 v237, v237, v8
    v_mfma_f32_16x16x32_bf16 v[244:247], v[160:163], v[74:77], v[244:247]
    v_mul_f32 v240, v240, v12
    v_mul_f32 v241, v241, v12
    v_mfma_f32_16x16x32_bf16 v[248:251], v[160:163], v[100:103], v[248:251]
    s_add_u32 s100, s100, 4096
    buffer_load_dwordx4 a[88:91], v2, s[28:31], s100 offen offset:0 sc1
    v_permlane16_swap_b32 v8, v9
    v_permlane16_swap_b32 v12, v13
    v_mfma_f32_16x16x32_bf16 v[244:247], v[168:171], v[78:81], v[244:247]
    v_cvt_pk_bf16_f32 v24, v236, v237
    v_mfma_f32_16x16x32_bf16 v[248:251], v[168:171], v[104:107], v[248:251]
    v_cvt_pk_bf16_f32 v26, v240, v241
    v_mfma_f32_16x16x32_bf16 v[204:207], v[140:143], v[68:71], 0
    v_mov_b32 v10, v8
    v_mfma_f32_16x16x32_bf16 v[208:211], v[140:143], v[94:97], 0
    buffer_load_dwordx4 a[92:95], v2, s[28:31], s100 offen offset:1024 sc1
    v_mov_b32 v11, v9
    v_mfma_f32_16x16x32_bf16 v[212:215], v[148:151], v[72:75], 0
    v_mov_b32 v14, v12
    v_mfma_f32_16x16x32_bf16 v[216:219], v[148:151], v[98:101], 0
    v_mov_b32 v15, v13
    v_mfma_f32_16x16x32_bf16 v[220:223], v[156:159], v[74:77], 0
    v_permlane32_swap_b32 v8, v10
    v_mfma_f32_16x16x32_bf16 v[224:227], v[156:159], v[100:103], 0
    buffer_load_dwordx4 a[96:99], v2, s[28:31], s100 offen offset:2048 sc1
    v_permlane32_swap_b32 v9, v11
    v_mfma_f32_16x16x32_bf16 v[228:231], v[164:167], v[78:81], 0
    v_permlane32_swap_b32 v12, v14
    v_mfma_f32_16x16x32_bf16 v[232:235], v[164:167], v[104:107], 0
    v_permlane32_swap_b32 v13, v15
    v_add_f32 v16, 897988541, v247
    v_add_f32 v20, 897988541, v251
    v_rcp_f32 v16, v16
    v_rcp_f32 v20, v20
    v_mov_b32 v17, v16
    v_mov_b32 v21, v20
    v_mul_f32 v244, v244, v16
    v_mul_f32 v245, v245, v16
    v_mul_f32 v248, v248, v20
    v_mul_f32 v249, v249, v20
    v_permlane16_swap_b32 v16, v17
    v_permlane16_swap_b32 v20, v21
    v_cvt_pk_bf16_f32 v25, v244, v245
    v_cvt_pk_bf16_f32 v27, v248, v249
    v_mov_b32 v18, v16
    v_mov_b32 v19, v17
    v_mov_b32 v22, v20
    v_mov_b32 v23, v21
    v_permlane32_swap_b32 v16, v18
    v_permlane32_swap_b32 v17, v19
    v_permlane32_swap_b32 v20, v22
    v_permlane32_swap_b32 v21, v23
    ds_write_b64 v7, v[24:25] offset:0
    ds_write_b64 v7, v[26:27] offset:1024
    v_pk_mul_f32 v[172:173], v[172:173], v[8:9] op_sel_hi:[1,0]
    v_pk_mul_f32 v[174:175], v[174:175], v[8:9] op_sel_hi:[1,0]
    v_pk_mul_f32 v[180:181], v[180:181], v[8:9] op_sel:[0,1]
    v_pk_mul_f32 v[182:183], v[182:183], v[8:9] op_sel:[0,1]
    v_cvt_pk_bf16_f32 v32, v172, v173
    v_cvt_pk_bf16_f32 v33, v174, v175
    v_cvt_pk_bf16_f32 v34, v180, v181
    v_cvt_pk_bf16_f32 v35, v182, v183
    ds_write_b128 v6, v[32:35] offset:0
    buffer_load_dwordx4 a[100:103], v2, s[28:31], s100 offen offset:3072 sc1
    v_pk_mul_f32 v[176:177], v[176:177], v[12:13] op_sel_hi:[1,0]
    v_pk_mul_f32 v[178:179], v[178:179], v[12:13] op_sel_hi:[1,0]
    v_pk_mul_f32 v[184:185], v[184:185], v[12:13] op_sel:[0,1]
    v_pk_mul_f32 v[186:187], v[186:187], v[12:13] op_sel:[0,1]
    v_cvt_pk_bf16_f32 v36, v176, v177
    v_cvt_pk_bf16_f32 v37, v178, v179
    v_cvt_pk_bf16_f32 v38, v184, v185
    v_cvt_pk_bf16_f32 v39, v186, v187
    ds_write_b128 v6, v[36:39] offset:1024
    s_add_u32 s100, s100, 4096
    buffer_load_dwordx4 a[104:107], v2, s[28:31], s100 offen offset:0 sc1
    v_pk_mul_f32 v[188:189], v[188:189], v[10:11] op_sel_hi:[1,0]
    v_pk_mul_f32 v[190:191], v[190:191], v[10:11] op_sel_hi:[1,0]
    v_pk_mul_f32 v[196:197], v[196:197], v[10:11] op_sel:[0,1]
    v_pk_mul_f32 v[198:199], v[198:199], v[10:11] op_sel:[0,1]
    v_cvt_pk_bf16_f32 v40, v188, v189
    v_cvt_pk_bf16_f32 v41, v190, v191
    v_cvt_pk_bf16_f32 v42, v196, v197
    v_cvt_pk_bf16_f32 v43, v198, v199
    ds_write_b128 v6, v[40:43] offset:2048
    buffer_load_dwordx4 a[108:111], v2, s[28:31], s100 offen offset:1024 sc1
    v_pk_mul_f32 v[192:193], v[192:193], v[14:15] op_sel_hi:[1,0]
    v_pk_mul_f32 v[194:195], v[194:195], v[14:15] op_sel_hi:[1,0]
    v_pk_mul_f32 v[200:201], v[200:201], v[14:15] op_sel:[0,1]
    v_pk_mul_f32 v[202:203], v[202:203], v[14:15] op_sel:[0,1]
    v_cvt_pk_bf16_f32 v44, v192, v193
    v_cvt_pk_bf16_f32 v45, v194, v195
    v_cvt_pk_bf16_f32 v46, v200, v201
    v_cvt_pk_bf16_f32 v47, v202, v203
    ds_write_b128 v6, v[44:47] offset:3072
    buffer_load_dwordx4 a[112:115], v2, s[28:31], s100 offen offset:2048 sc1
    v_pk_mul_f32 v[204:205], v[204:205], v[16:17] op_sel_hi:[1,0]
    v_pk_mul_f32 v[206:207], v[206:207], v[16:17] op_sel_hi:[1,0]
    v_pk_mul_f32 v[212:213], v[212:213], v[16:17] op_sel:[0,1]
    v_pk_mul_f32 v[214:215], v[214:215], v[16:17] op_sel:[0,1]
    v_cvt_pk_bf16_f32 v32, v204, v205
    v_cvt_pk_bf16_f32 v33, v206, v207
    v_cvt_pk_bf16_f32 v34, v212, v213
    v_cvt_pk_bf16_f32 v35, v214, v215
    ds_write_b128 v6, v[32:35] offset:4096
    buffer_load_dwordx4 a[116:119], v2, s[28:31], s100 offen offset:3072 sc1
    v_pk_mul_f32 v[208:209], v[208:209], v[20:21] op_sel_hi:[1,0]
    v_pk_mul_f32 v[210:211], v[210:211], v[20:21] op_sel_hi:[1,0]
    v_pk_mul_f32 v[216:217], v[216:217], v[20:21] op_sel:[0,1]
    v_pk_mul_f32 v[218:219], v[218:219], v[20:21] op_sel:[0,1]
    v_cvt_pk_bf16_f32 v36, v208, v209
    v_cvt_pk_bf16_f32 v37, v210, v211
    v_cvt_pk_bf16_f32 v38, v216, v217
    v_cvt_pk_bf16_f32 v39, v218, v219
    ds_write_b128 v6, v[36:39] offset:5120
    s_add_u32 s100, s100, 4096
    buffer_load_dwordx4 a[120:123], v2, s[28:31], s100 offen offset:0 sc1
    v_pk_mul_f32 v[220:221], v[220:221], v[18:19] op_sel_hi:[1,0]
    v_pk_mul_f32 v[222:223], v[222:223], v[18:19] op_sel_hi:[1,0]
    v_pk_mul_f32 v[228:229], v[228:229], v[18:19] op_sel:[0,1]
    v_pk_mul_f32 v[230:231], v[230:231], v[18:19] op_sel:[0,1]
    v_cvt_pk_bf16_f32 v40, v220, v221
    v_cvt_pk_bf16_f32 v41, v222, v223
    v_cvt_pk_bf16_f32 v42, v228, v229
    v_cvt_pk_bf16_f32 v43, v230, v231
    ds_write_b128 v6, v[40:43] offset:6144
    buffer_load_dwordx4 a[124:127], v2, s[28:31], s100 offen offset:1024 sc1
    v_pk_mul_f32 v[224:225], v[224:225], v[22:23] op_sel_hi:[1,0]
    v_pk_mul_f32 v[226:227], v[226:227], v[22:23] op_sel_hi:[1,0]
    v_pk_mul_f32 v[232:233], v[232:233], v[22:23] op_sel:[0,1]
    v_pk_mul_f32 v[234:235], v[234:235], v[22:23] op_sel:[0,1]
    v_cvt_pk_bf16_f32 v44, v224, v225
    v_cvt_pk_bf16_f32 v45, v226, v227
    v_cvt_pk_bf16_f32 v46, v232, v233
    v_cvt_pk_bf16_f32 v47, v234, v235
    ds_write_b128 v6, v[44:47] offset:7168
    buffer_load_dwordx4 a[128:131], v2, s[28:31], s100 offen offset:2048 sc1
    s_lshl_b32 s21, s3, 2
    s_add_u32 s21, s21, s6
    s_mul_i32 s21, s21, 331776
    s_add_u32 s8, s4, s21
    s_addc_u32 s9, s5, 0
    s_and_b32 s9, s9, 0xffff
    s_mov_b32 s10, 331776
    s_mov_b32 s11, 0x20000
    s_mov_b32 s26, 0
    s_waitcnt lgkmcnt(0)
    s_barrier
    ds_read_b128 v[8:11], v4 offset:0
    ds_read_b128 v[12:15], v5 offset:0
    ds_read_b128 v[16:19], v4 offset:2048
    ds_read_b128 v[20:23], v5 offset:2048
    ds_read_b128 v[24:27], v4 offset:4096
    ds_read_b128 v[28:31], v5 offset:4096
    ds_read_b128 v[32:35], v4 offset:6144
    ds_read_b128 v[36:39], v5 offset:6144
    ds_read_b128 v[40:43], v4 offset:8192
    ds_read_b128 v[44:47], v5 offset:8192
    ds_read_b128 v[48:51], v4 offset:10240
    ds_read_b128 v[52:55], v5 offset:10240
    s_waitcnt vmcnt(16)
    v_readfirstlane_b32 s45, v3
    s_nop 0
    s_cmp_eq_u32 s45, 32
    s_cselect_b32 s45, 1, 0
    v_mfma_f32_16x16x32_bf16 v[228:231], a[234:237], a[216:219], 0
    v_mfma_f32_16x16x32_bf16 v[232:235], a[234:237], a[220:223], 0
    v_mfma_f32_16x16x32_bf16 v[236:239], a[232:235], a[216:219], 0
    v_mfma_f32_16x16x32_bf16 v[240:243], a[232:235], a[220:223], 0
    v_mfma_f32_16x16x32_bf16 v[244:247], a[228:231], a[224:227], 0
    s_lshl_b32 s20, s6, 10
    s_add_u32 s20, s20, 110592
    v_add_u32 v6, s20, v2
    v_xor_b32 v7, 2048, v6
    s_waitcnt lgkmcnt(10)
    v_mfma_f32_16x16x32_bf16 v[228:231], a[0:3], v[8:11], v[228:231]
    ds_read_b128 v[56:59], v4 offset:12288
    v_mfma_f32_16x16x32_bf16 v[232:235], a[0:3], v[12:15], v[232:235]
    buffer_load_dwordx4 a[132:135], v2, s[28:31], s100 offen offset:3072 sc1
    v_mfma_f32_16x16x32_bf16 v[236:239], a[4:7], v[8:11], v[236:239]
    ds_read_b128 v[60:63], v5 offset:12288
    v_mfma_f32_16x16x32_bf16 v[240:243], a[4:7], v[12:15], v[240:243]
    s_add_u32 s100, s100, 4096
    buffer_load_dwordx4 a[136:139], v2, s[28:31], s100 offen offset:0 sc1
    v_mfma_f32_16x16x32_bf16 v[244:247], a[144:147], v[8:11], v[244:247]
    s_waitcnt lgkmcnt(10)
    v_mfma_f32_16x16x32_bf16 v[228:231], a[8:11], v[16:19], v[228:231]
    ds_read_b128 v[64:67], v4 offset:14336
    v_mfma_f32_16x16x32_bf16 v[232:235], a[8:11], v[20:23], v[232:235]
    buffer_load_dwordx4 a[140:143], v2, s[28:31], s100 offen offset:1024 sc1
    v_mfma_f32_16x16x32_bf16 v[236:239], a[12:15], v[16:19], v[236:239]
    ds_read_b128 v[68:71], v5 offset:14336
    v_mfma_f32_16x16x32_bf16 v[240:243], a[12:15], v[20:23], v[240:243]
    v_mfma_f32_16x16x32_bf16 v[244:247], a[148:151], v[16:19], v[244:247]
    s_waitcnt lgkmcnt(10)
    v_mfma_f32_16x16x32_bf16 v[228:231], a[16:19], v[24:27], v[228:231]
    ds_read_b128 v[72:75], v4 offset:16384
    v_mfma_f32_16x16x32_bf16 v[232:235], a[16:19], v[28:31], v[232:235]
    buffer_load_dwordx4 v[156:159], v2, s[8:11], s26 offen offset:0 sc1
    v_mfma_f32_16x16x32_bf16 v[236:239], a[20:23], v[24:27], v[236:239]
    ds_read_b128 v[76:79], v5 offset:16384
    v_mfma_f32_16x16x32_bf16 v[240:243], a[20:23], v[28:31], v[240:243]
    buffer_load_dwordx4 v[160:163], v2, s[8:11], s26 offen offset:1024 sc1
    v_mfma_f32_16x16x32_bf16 v[244:247], a[152:155], v[24:27], v[244:247]
    s_waitcnt lgkmcnt(10)
    v_mfma_f32_16x16x32_bf16 v[228:231], a[24:27], v[32:35], v[228:231]
    ds_read_b128 v[80:83], v253 offset:0
    v_mfma_f32_16x16x32_bf16 v[232:235], a[24:27], v[36:39], v[232:235]
    buffer_load_dwordx4 v[164:167], v2, s[8:11], s26 offen offset:2048 sc1
    v_mfma_f32_16x16x32_bf16 v[236:239], a[28:31], v[32:35], v[236:239]
    ds_read_b128 v[84:87], v254 offset:0
    v_mfma_f32_16x16x32_bf16 v[240:243], a[28:31], v[36:39], v[240:243]
    v_mfma_f32_16x16x32_bf16 v[244:247], a[156:159], v[32:35], v[244:247]
    s_waitcnt lgkmcnt(10)
    v_mfma_f32_16x16x32_bf16 v[228:231], a[32:35], v[40:43], v[228:231]
    ds_read_b128 v[88:91], v253 offset:2048
    v_mfma_f32_16x16x32_bf16 v[232:235], a[32:35], v[44:47], v[232:235]
    buffer_load_dwordx4 v[168:171], v2, s[8:11], s26 offen offset:3072 sc1
    v_mfma_f32_16x16x32_bf16 v[236:239], a[36:39], v[40:43], v[236:239]
    ds_read_b128 v[92:95], v254 offset:2048
    v_mfma_f32_16x16x32_bf16 v[240:243], a[36:39], v[44:47], v[240:243]
    s_add_u32 s26, s26, 4096
    buffer_load_dwordx4 v[172:175], v2, s[8:11], s26 offen offset:0 sc1
    v_mfma_f32_16x16x32_bf16 v[244:247], a[160:163], v[40:43], v[244:247]
    s_waitcnt lgkmcnt(10)
    v_mfma_f32_16x16x32_bf16 v[228:231], a[40:43], v[48:51], v[228:231]
    ds_read_b128 v[96:99], v253 offset:4096
    v_mfma_f32_16x16x32_bf16 v[232:235], a[40:43], v[52:55], v[232:235]
    buffer_load_dwordx4 v[176:179], v2, s[8:11], s26 offen offset:1024 sc1
    v_mfma_f32_16x16x32_bf16 v[236:239], a[44:47], v[48:51], v[236:239]
    ds_read_b128 v[100:103], v254 offset:4096
    v_mfma_f32_16x16x32_bf16 v[240:243], a[44:47], v[52:55], v[240:243]
    v_mfma_f32_16x16x32_bf16 v[244:247], a[164:167], v[48:51], v[244:247]
    s_waitcnt lgkmcnt(10)
    v_mfma_f32_16x16x32_bf16 v[228:231], a[48:51], v[56:59], v[228:231]
    ds_read_b128 v[104:107], v253 offset:6144
    v_mfma_f32_16x16x32_bf16 v[232:235], a[48:51], v[60:63], v[232:235]
    buffer_load_dwordx4 v[180:183], v2, s[8:11], s26 offen offset:2048 sc1
    v_mfma_f32_16x16x32_bf16 v[236:239], a[52:55], v[56:59], v[236:239]
    ds_read_b128 v[108:111], v254 offset:6144
    v_mfma_f32_16x16x32_bf16 v[240:243], a[52:55], v[60:63], v[240:243]
    buffer_load_dwordx4 v[184:187], v2, s[8:11], s26 offen offset:3072 sc1
    v_mfma_f32_16x16x32_bf16 v[244:247], a[168:171], v[56:59], v[244:247]
    s_waitcnt lgkmcnt(10)
    v_mfma_f32_16x16x32_bf16 v[228:231], a[56:59], v[64:67], v[228:231]
    ds_read_b128 v[112:115], v253 offset:8192
    v_mfma_f32_16x16x32_bf16 v[232:235], a[56:59], v[68:71], v[232:235]
    s_add_u32 s26, s26, 4096
    buffer_load_dwordx4 v[188:191], v2, s[8:11], s26 offen offset:0 sc1
    v_mfma_f32_16x16x32_bf16 v[236:239], a[60:63], v[64:67], v[236:239]
    ds_read_b128 v[116:119], v254 offset:8192
    v_mfma_f32_16x16x32_bf16 v[240:243], a[60:63], v[68:71], v[240:243]
    v_mfma_f32_16x16x32_bf16 v[244:247], a[172:175], v[64:67], v[244:247]
    s_waitcnt vmcnt(27) lgkmcnt(10)
    v_mfma_f32_16x16x32_bf16 v[228:231], a[64:67], v[72:75], v[228:231]
    ds_read_b128 v[120:123], v253 offset:10240
    v_mfma_f32_16x16x32_bf16 v[232:235], a[64:67], v[76:79], v[232:235]
    buffer_load_dwordx4 v[192:195], v2, s[8:11], s26 offen offset:1024 sc1
    v_mfma_f32_16x16x32_bf16 v[236:239], a[68:71], v[72:75], v[236:239]
    ds_read_b128 v[124:127], v254 offset:10240
    v_mfma_f32_16x16x32_bf16 v[240:243], a[68:71], v[76:79], v[240:243]
    buffer_load_dwordx4 v[196:199], v2, s[8:11], s26 offen offset:2048 sc1
    v_mfma_f32_16x16x32_bf16 v[244:247], a[176:179], v[72:75], v[244:247]
    s_waitcnt vmcnt(27) lgkmcnt(10)
    v_mfma_f32_16x16x32_bf16 v[228:231], a[72:75], v[80:83], v[228:231]
    ds_read_b128 v[128:131], v253 offset:12288
    v_mfma_f32_16x16x32_bf16 v[232:235], a[72:75], v[84:87], v[232:235]
    buffer_load_dwordx4 v[200:203], v2, s[8:11], s26 offen offset:3072 sc1
    v_mfma_f32_16x16x32_bf16 v[236:239], a[76:79], v[80:83], v[236:239]
    ds_read_b128 v[132:135], v254 offset:12288
    v_mfma_f32_16x16x32_bf16 v[240:243], a[76:79], v[84:87], v[240:243]
    s_waitcnt vmcnt(26) lgkmcnt(10)
    v_mfma_f32_16x16x32_bf16 v[228:231], a[80:83], v[88:91], v[228:231]
    ds_read_b128 v[136:139], v253 offset:14336
    v_mfma_f32_16x16x32_bf16 v[232:235], a[80:83], v[92:95], v[232:235]
    s_add_u32 s26, s26, 4096
    buffer_load_dwordx4 v[204:207], v2, s[8:11], s26 offen offset:0 sc1
    v_mfma_f32_16x16x32_bf16 v[236:239], a[84:87], v[88:91], v[236:239]
    ds_read_b128 v[140:143], v254 offset:14336
    v_mfma_f32_16x16x32_bf16 v[240:243], a[84:87], v[92:95], v[240:243]
    buffer_load_dwordx4 v[208:211], v2, s[8:11], s26 offen offset:1024 sc1
    s_waitcnt vmcnt(26) lgkmcnt(10)
    ds_write_b128 v6, v[244:247]
    v_mfma_f32_16x16x32_bf16 v[228:231], a[88:91], v[96:99], v[228:231]
    ds_read_b128 v[144:147], v253 offset:16384
    v_mfma_f32_16x16x32_bf16 v[232:235], a[88:91], v[100:103], v[232:235]
    buffer_load_dwordx4 v[212:215], v2, s[8:11], s26 offen offset:2048 sc1
    v_mfma_f32_16x16x32_bf16 v[236:239], a[92:95], v[96:99], v[236:239]
    ds_read_b128 v[148:151], v254 offset:16384
    v_mfma_f32_16x16x32_bf16 v[240:243], a[92:95], v[100:103], v[240:243]
    s_waitcnt vmcnt(25) lgkmcnt(11)
    v_mfma_f32_16x16x32_bf16 v[228:231], a[96:99], v[104:107], v[228:231]
    v_mfma_f32_16x16x32_bf16 v[232:235], a[96:99], v[108:111], v[232:235]
    buffer_load_dwordx4 v[216:219], v2, s[8:11], s26 offen offset:3072 sc1
    v_mfma_f32_16x16x32_bf16 v[236:239], a[100:103], v[104:107], v[236:239]
    v_mfma_f32_16x16x32_bf16 v[240:243], a[100:103], v[108:111], v[240:243]
    s_add_u32 s26, s26, 4096
    buffer_load_dwordx4 v[220:223], v2, s[8:11], s26 offen offset:0 sc1
    s_waitcnt vmcnt(25) lgkmcnt(9)
    s_waitcnt lgkmcnt(0)
    s_barrier
    ds_read_b128 v[248:251], v7
    v_mfma_f32_16x16x32_bf16 v[228:231], a[104:107], v[112:115], v[228:231]
    v_mfma_f32_16x16x32_bf16 v[232:235], a[104:107], v[116:119], v[232:235]
    buffer_load_dwordx4 v[224:227], v2, s[8:11], s26 offen offset:1024 sc1
    v_mfma_f32_16x16x32_bf16 v[236:239], a[108:111], v[112:115], v[236:239]
    v_mfma_f32_16x16x32_bf16 v[240:243], a[108:111], v[116:119], v[240:243]
    s_waitcnt vmcnt(24)
    v_mfma_f32_16x16x32_bf16 v[228:231], a[112:115], v[120:123], v[228:231]
    v_mfma_f32_16x16x32_bf16 v[232:235], a[112:115], v[124:127], v[232:235]
    v_mfma_f32_16x16x32_bf16 v[236:239], a[116:119], v[120:123], v[236:239]
    v_mfma_f32_16x16x32_bf16 v[240:243], a[116:119], v[124:127], v[240:243]
    s_waitcnt vmcnt(22)
    v_mfma_f32_16x16x32_bf16 v[228:231], a[120:123], v[128:131], v[228:231]
    v_mfma_f32_16x16x32_bf16 v[232:235], a[120:123], v[132:135], v[232:235]
    v_mfma_f32_16x16x32_bf16 v[236:239], a[124:127], v[128:131], v[236:239]
    v_mfma_f32_16x16x32_bf16 v[240:243], a[124:127], v[132:135], v[240:243]
    s_waitcnt lgkmcnt(0)
    v_add_f32 v244, v244, v248
    v_add_f32 v245, v245, v249
    v_add_f32 v246, v246, v250
    v_add_f32 v247, v247, v251
    v_cvt_pk_bf16_f32 v24, v244, v245
    v_cvt_pk_bf16_f32 v25, v246, v247
    s_cmp_ge_u32 s6, 2
    s_cbranch_scc1 L_o_noh
    buffer_store_dwordx2 v[24:25], v2, s[32:35], s43 offen
L_o_noh:
    s_waitcnt vmcnt(20)
    v_mfma_f32_16x16x32_bf16 v[228:231], a[128:131], v[136:139], v[228:231]
    v_mfma_f32_16x16x32_bf16 v[232:235], a[128:131], v[140:143], v[232:235]
    v_mfma_f32_16x16x32_bf16 v[236:239], a[132:135], v[136:139], v[236:239]
    v_mfma_f32_16x16x32_bf16 v[240:243], a[132:135], v[140:143], v[240:243]
    s_waitcnt vmcnt(18)
    v_mfma_f32_16x16x32_bf16 v[228:231], a[136:139], v[144:147], v[228:231]
    v_mfma_f32_16x16x32_bf16 v[232:235], a[136:139], v[148:151], v[232:235]
    v_mfma_f32_16x16x32_bf16 v[236:239], a[140:143], v[144:147], v[236:239]
    v_mfma_f32_16x16x32_bf16 v[240:243], a[140:143], v[148:151], v[240:243]
    s_nop 4
    v_cvt_pk_bf16_f32 v16, v228, v229
    v_cvt_pk_bf16_f32 v17, v230, v231
    v_cvt_pk_bf16_f32 v18, v236, v237
    v_cvt_pk_bf16_f32 v19, v238, v239
    buffer_store_dwordx4 v[16:19], v2, s[32:35], s40 offen
    v_cvt_pk_bf16_f32 v20, v232, v233
    v_cvt_pk_bf16_f32 v21, v234, v235
    v_cvt_pk_bf16_f32 v22, v240, v241
    v_cvt_pk_bf16_f32 v23, v242, v243
    buffer_store_dwordx4 v[20:23], v2, s[32:35], s41 offen
    s_add_u32 s20, s52, 0
    v_mov_b32 v3, 1
    s_waitcnt vmcnt(0)
    s_mov_b64 exec, 1
    s_cmp_eq_u32 s45, 1
    s_cbranch_scc1 L_sigf8
    buffer_wbl2 sc1
    s_waitcnt vmcnt(0)
    buffer_store_dword v3, off, s[56:59], s20 sc1
    s_branch L_sigd8
L_sigf8:
    buffer_store_dword v3, off, s[56:59], s20
L_sigd8:
    s_mov_b64 exec, -1
    s_mul_i32 s21, s7, 73728
    s_add_u32 s22, s21, 13893632
    s_add_u32 s12, s4, s22
    s_addc_u32 s13, s5, 0
    s_and_b32 s13, s13, 0xffff
    s_mov_b32 s14, 73728
    s_mov_b32 s15, 0x20000
    s_mul_i32 s90, s6, 18432
    v_mov_b32 v249, v2
    v_add_u32 v250, 1024, v2
    v_add_u32 v251, 36864, v249
    v_add_u32 v252, 36864, v250
    s_mul_i32 s20, s6, 18432
    v_add_u32 v253, s20, v249
    v_add_u32 v254, s20, v250
    v_mov_b32 v132, 0x3f803f80
    v_mov_b32 v133, 0x3f803f80
    v_mov_b32 v134, 0x3f803f80
    v_mov_b32 v135, 0x3f803f80
    s_mov_b32 s36, 0x22222222
    s_mov_b32 s37, 0x22222222
    s_mov_b32 s38, 0x44444444
    s_mov_b32 s39, 0x44444444
    s_mov_b32 s40, 0x88888888
    s_mov_b32 s41, 0x88888888
    s_mov_b32 s42, 0x00f0000f
    s_mov_b32 s43, 0xf0000f00
    v_add_u32 v5, 73728, v2
    v_add_u32 v6, 110592, v2
    s_lshl_b32 s20, s6, 12
    v_add_u32 v8, s20, v5
    s_lshr_b32 s24, s6, 1
    s_and_b32 s25, s6, 1
    s_lshl_b32 s25, s25, 3
    s_lshl_b32 s20, s24, 12
    s_add_u32 s20, s20, s25
    s_add_u32 s20, s20, 65536
    v_add_u32 v9, s20, v5
    s_mul_i32 s22, s7, 196608
    s_add_u32 s22, s22, 16777216
    s_add_u32 s16, s4, s22
    s_addc_u32 s17, s5, 0
    s_and_b32 s17, s17, 0xffff
    s_mov_b32 s18, 196608
    s_mov_b32 s19, 0x20000
    v_and_b32 v4, 15, v1
    v_lshlrev_b32 v10, 3, v4
    v_add_u32 v10, 156672, v10
    s_add_u32 s22, s4, 13893632
    s_addc_u32 s23, s5, 0
    s_cmp_eq_u32 s44, 0
    s_cselect_b32 s22, s22, s46
    s_cselect_b32 s23, s23, s47
    s_cselect_b32 s27, 10, 6
    s_cselect_b64 vcc, -1, 0
    s_add_u32 s28, s22, s21
    s_addc_u32 s29, s23, 0
    s_and_b32 s29, s29, 0xffff
    s_mov_b32 s30, 73728
    s_mov_b32 s31, 0x20000
    v_and_b32 v3, 31, v1
    v_lshlrev_b32 v3, 2, v3
    s_lshl_b32 s20, s3, 8
    s_lshl_b32 s21, s6, 11
    s_add_u32 s20, s20, s21
    s_add_u32 s20, s20, 131072
    v_lshl_add_u32 v244, v1, 2, s20
    v_lshrrev_b32 v11, 4, v1
    v_lshlrev_b32 v245, 13, v11
    v_lshl_add_u32 v245, v4, 4, v245
    v_mul_u32_u24 v246, 1152, v4
    v_lshl_add_u32 v246, v11, 4, v246
    v_cndmask_b32 v246, v246, v2, vcc
    s_lshl_b32 s20, s3, 1
    s_add_u32 s20, s20, s24
    s_lshl_b32 s50, s20, 10
    s_lshl_b32 s20, s20, s27
    s_add_u32 s20, s20, s25
    v_add_u32 v246, s20, v246
    v_bfe_u32 v11, v1, 1, 1
    v_mul_u32_u24 v11, 18432, v11
    v_and_b32 v4, 1, v1
    v_lshl_add_u32 v11, v4, 2, v11
    s_lshr_b32 s20, s3, 2
    s_mul_i32 s20, s20, 36864
    s_add_u32 s20, s20, s25
    v_add_u32 v11, s20, v11
    v_lshrrev_b32 v4, 2, v1
    v_lshl_add_u32 v247, v4, 4, v11
    v_mul_u32_u24 v4, 1152, v4
    v_add_u32 v248, v4, v11
    s_add_u32 s20, s24, 16
    s_and_b32 s21, s3, 3
    s_lshl_b32 s22, s20, 10
    s_lshl_b32 s23, s21, 8
    s_add_u32 s22, s22, s23
    v_add_u32 v247, s22, v247
    s_lshl_b32 s22, s20, 6
    s_lshl_b32 s23, s21, 4
    s_add_u32 s22, s22, s23
    v_add_u32 v248, s22, v248
    v_cndmask_b32 v248, v248, v247, vcc
    v_and_b32 v3, 31, v1
    v_lshlrev_b32 v3, 2, v3
    s_mov_b32 s21, 131072
L_cw9:
    buffer_load_dword v4, v3, s[56:59], s51 offen sc1
    s_waitcnt vmcnt(0)
    v_cmp_ne_u32 vcc, 0, v4
    s_sub_u32 s21, s21, 1
    s_nop 0
    s_cmp_eq_u32 vcc_lo, -1
    s_cbranch_scc1 L_cwd9
    s_cmp_lg_u32 s21, 0
    s_cbranch_scc1 L_cw9
L_cwd9:
    s_cmp_eq_u32 s45, 1
    s_cbranch_scc1 L_cwf9
    buffer_inv sc1
    s_waitcnt vmcnt(0)
L_cwf9:
    s_mov_b32 m0, s90
    s_nop 0
    buffer_load_dwordx4 v2, s[12:15], s90 offen offset:0 sc1 lds
    buffer_load_dwordx4 v2, s[12:15], s90 offen offset:1024 sc1 lds
    buffer_load_dwordx4 v2, s[12:15], s90 offen offset:2048 sc1 lds
    buffer_load_dwordx4 v2, s[12:15], s90 offen offset:3072 sc1 lds
    s_add_u32 s90, s90, 4096
    s_mov_b32 m0, s90
    s_nop 0
    buffer_load_dwordx4 v2, s[12:15], s90 offen offset:0 sc1 lds
    buffer_load_dwordx4 v2, s[12:15], s90 offen offset:1024 sc1 lds
    buffer_load_dwordx4 v2, s[12:15], s90 offen offset:2048 sc1 lds
    buffer_load_dwordx4 v2, s[12:15], s90 offen offset:3072 sc1 lds
    s_add_u32 s90, s90, 4096
    s_mov_b32 m0, s90
    s_nop 0
    buffer_load_dwordx4 v2, s[12:15], s90 offen offset:0 sc1 lds
    buffer_load_dwordx4 v2, s[12:15], s90 offen offset:1024 sc1 lds
    buffer_load_dwordx4 v2, s[12:15], s90 offen offset:2048 sc1 lds
    buffer_load_dwordx4 v2, s[12:15], s90 offen offset:3072 sc1 lds
    s_add_u32 s90, s90, 4096
    s_mov_b32 m0, s90
    s_nop 0
    buffer_load_dwordx4 v2, s[12:15], s90 offen offset:0 sc1 lds
    buffer_load_dwordx4 v2, s[12:15], s90 offen offset:1024 sc1 lds
    buffer_load_dwordx4 v2, s[12:15], s90 offen offset:2048 sc1 lds
    buffer_load_dwordx4 v2, s[12:15], s90 offen offset:3072 sc1 lds
    s_add_u32 s90, s90, 4096
    s_mov_b32 m0, s90
    s_nop 0
    buffer_load_dwordx4 v2, s[12:15], s90 offen offset:0 sc1 lds
    buffer_load_dwordx4 v2, s[12:15], s90 offen offset:1024 sc1 lds
    s_waitcnt vmcnt(12)
    s_barrier
    ds_read_b128 a[0:3], v249 offset:0
    ds_read_b128 a[4:7], v249 offset:18432
    ds_read_b128 a[8:11], v251 offset:0
    ds_read_b128 a[12:15], v251 offset:18432
    ds_read_b128 a[16:19], v250 offset:0
    ds_read_b128 a[20:23], v250 offset:18432
    ds_read_b128 a[24:27], v252 offset:0
    ds_read_b128 a[28:31], v252 offset:18432
    s_waitcnt lgkmcnt(4)
    v_mfma_f32_16x16x32_bf16 v[44:47], v[156:159], a[0:3], 0
    ds_read_b128 a[32:35], v249 offset:2048
    v_mfma_f32_16x16x32_bf16 v[48:51], v[156:159], a[4:7], 0
    ds_read_b128 a[36:39], v249 offset:20480
    v_mfma_f32_16x16x32_bf16 v[52:55], v[156:159], a[8:11], 0
    ds_read_b128 a[40:43], v251 offset:2048
    v_mfma_f32_16x16x32_bf16 v[56:59], v[156:159], a[12:15], 0
    ds_read_b128 a[44:47], v251 offset:20480
    buffer_load_dwordx4 v[156:159], v2, s[8:11], s26 offen offset:2048 sc1
    v_mfma_f32_16x16x32_bf16 v[60:63], v[160:163], a[0:3], 0
    v_mfma_f32_16x16x32_bf16 v[64:67], v[160:163], a[4:7], 0
    v_mfma_f32_16x16x32_bf16 v[68:71], v[160:163], a[8:11], 0
    v_mfma_f32_16x16x32_bf16 v[72:75], v[160:163], a[12:15], 0
    buffer_load_dwordx4 v[160:163], v2, s[8:11], s26 offen offset:3072 sc1
    s_waitcnt lgkmcnt(4)
    v_mfma_f32_16x16x32_bf16 v[44:47], v[164:167], a[16:19], v[44:47]
    ds_read_b128 a[48:51], v250 offset:2048
    v_mfma_f32_16x16x32_bf16 v[48:51], v[164:167], a[20:23], v[48:51]
    ds_read_b128 a[52:55], v250 offset:20480
    v_mfma_f32_16x16x32_bf16 v[52:55], v[164:167], a[24:27], v[52:55]
    ds_read_b128 a[56:59], v252 offset:2048
    v_mfma_f32_16x16x32_bf16 v[56:59], v[164:167], a[28:31], v[56:59]
    ds_read_b128 a[60:63], v252 offset:20480
    s_add_u32 s26, s26, 4096
    buffer_load_dwordx4 v[164:167], v2, s[8:11], s26 offen offset:0 sc1
    v_mfma_f32_16x16x32_bf16 v[60:63], v[168:171], a[16:19], v[60:63]
    v_mfma_f32_16x16x32_bf16 v[64:67], v[168:171], a[20:23], v[64:67]
    v_mfma_f32_16x16x32_bf16 v[68:71], v[168:171], a[24:27], v[68:71]
    v_mfma_f32_16x16x32_bf16 v[72:75], v[168:171], a[28:31], v[72:75]
    buffer_load_dwordx4 v[168:171], v2, s[8:11], s26 offen offset:1024 sc1
    s_waitcnt lgkmcnt(4)
    v_mfma_f32_16x16x32_bf16 v[44:47], v[172:175], a[32:35], v[44:47]
    ds_read_b128 a[64:67], v249 offset:4096
    v_mfma_f32_16x16x32_bf16 v[48:51], v[172:175], a[36:39], v[48:51]
    ds_read_b128 a[68:71], v249 offset:22528
    v_mfma_f32_16x16x32_bf16 v[52:55], v[172:175], a[40:43], v[52:55]
    ds_read_b128 a[72:75], v251 offset:4096
    v_mfma_f32_16x16x32_bf16 v[56:59], v[172:175], a[44:47], v[56:59]
    ds_read_b128 a[76:79], v251 offset:22528
    buffer_load_dwordx4 v[172:175], v2, s[8:11], s26 offen offset:2048 sc1
    v_mfma_f32_16x16x32_bf16 v[60:63], v[176:179], a[32:35], v[60:63]
    v_mfma_f32_16x16x32_bf16 v[64:67], v[176:179], a[36:39], v[64:67]
    v_mfma_f32_16x16x32_bf16 v[68:71], v[176:179], a[40:43], v[68:71]
    v_mfma_f32_16x16x32_bf16 v[72:75], v[176:179], a[44:47], v[72:75]
    buffer_load_dwordx4 v[176:179], v2, s[8:11], s26 offen offset:3072 sc1
    s_waitcnt lgkmcnt(4)
    s_waitcnt vmcnt(6)
    s_barrier
    v_mfma_f32_16x16x32_bf16 v[44:47], v[180:183], a[48:51], v[44:47]
    ds_read_b128 v[108:111], v253 offset:0
    v_mfma_f32_16x16x32_bf16 v[48:51], v[180:183], a[52:55], v[48:51]
    ds_read_b128 v[112:115], v254 offset:0
    v_mfma_f32_16x16x32_bf16 v[52:55], v[180:183], a[56:59], v[52:55]
    ds_read_b128 a[80:83], v250 offset:4096
    v_mfma_f32_16x16x32_bf16 v[56:59], v[180:183], a[60:63], v[56:59]
    ds_read_b128 a[84:87], v250 offset:22528
    s_add_u32 s26, s26, 4096
    buffer_load_dwordx4 v[180:183], v2, s[8:11], s26 offen offset:0 sc1
    v_mfma_f32_16x16x32_bf16 v[60:63], v[184:187], a[48:51], v[60:63]
    ds_read_b128 a[88:91], v252 offset:4096
    v_mfma_f32_16x16x32_bf16 v[64:67], v[184:187], a[52:55], v[64:67]
    ds_read_b128 a[92:95], v252 offset:22528
    v_mfma_f32_16x16x32_bf16 v[68:71], v[184:187], a[56:59], v[68:71]
    v_mfma_f32_16x16x32_bf16 v[72:75], v[184:187], a[60:63], v[72:75]
    buffer_load_dwordx4 v[184:187], v2, s[8:11], s26 offen offset:1024 sc1
    s_waitcnt lgkmcnt(4)
    v_mfma_f32_16x16x32_bf16 v[44:47], v[188:191], a[64:67], v[44:47]
    ds_read_b128 v[116:119], v253 offset:2048
    v_mfma_f32_16x16x32_bf16 v[48:51], v[188:191], a[68:71], v[48:51]
    ds_read_b128 v[120:123], v254 offset:2048
    v_mfma_f32_16x16x32_bf16 v[52:55], v[188:191], a[72:75], v[52:55]
    ds_read_b128 a[96:99], v249 offset:6144
    v_mfma_f32_16x16x32_bf16 v[56:59], v[188:191], a[76:79], v[56:59]
    ds_read_b128 a[100:103], v249 offset:24576
    v_mfma_f32_16x16x32_bf16 v[124:127], v[108:111], v[108:111], 0
    v_mfma_f32_16x16x32_bf16 v[128:131], v[132:135], v[108:111], 0
    buffer_load_dwordx4 v[188:191], v2, s[8:11], s26 offen offset:2048 sc1
    v_mfma_f32_16x16x32_bf16 v[60:63], v[192:195], a[64:67], v[60:63]
    ds_read_b128 a[104:107], v251 offset:6144
    v_mfma_f32_16x16x32_bf16 v[64:67], v[192:195], a[68:71], v[64:67]
    ds_read_b128 a[108:111], v251 offset:24576
    v_mfma_f32_16x16x32_bf16 v[68:71], v[192:195], a[72:75], v[68:71]
    v_mfma_f32_16x16x32_bf16 v[72:75], v[192:195], a[76:79], v[72:75]
    v_mfma_f32_16x16x32_bf16 v[124:127], v[112:115], v[112:115], v[124:127]
    v_mfma_f32_16x16x32_bf16 v[128:131], v[132:135], v[112:115], v[128:131]
    buffer_load_dwordx4 v[192:195], v2, s[8:11], s26 offen offset:3072 sc1
    s_waitcnt lgkmcnt(4)
    v_mfma_f32_16x16x32_bf16 v[44:47], v[196:199], a[80:83], v[44:47]
    ds_read_b128 v[108:111], v253 offset:4096
    v_mfma_f32_16x16x32_bf16 v[48:51], v[196:199], a[84:87], v[48:51]
    ds_read_b128 v[112:115], v254 offset:4096
    v_mfma_f32_16x16x32_bf16 v[52:55], v[196:199], a[88:91], v[52:55]
    ds_read_b128 a[112:115], v250 offset:6144
    v_mfma_f32_16x16x32_bf16 v[56:59], v[196:199], a[92:95], v[56:59]
    ds_read_b128 a[116:119], v250 offset:24576
    v_mfma_f32_16x16x32_bf16 v[124:127], v[116:119], v[116:119], v[124:127]
    v_mfma_f32_16x16x32_bf16 v[128:131], v[132:135], v[116:119], v[128:131]
    s_add_u32 s26, s26, 4096
    buffer_load_dwordx4 v[196:199], v2, s[8:11], s26 offen offset:0 sc1
    v_mfma_f32_16x16x32_bf16 v[60:63], v[200:203], a[80:83], v[60:63]
    ds_read_b128 a[120:123], v252 offset:6144
    v_mfma_f32_16x16x32_bf16 v[64:67], v[200:203], a[84:87], v[64:67]
    ds_read_b128 a[124:127], v252 offset:24576
    v_mfma_f32_16x16x32_bf16 v[68:71], v[200:203], a[88:91], v[68:71]
    v_mfma_f32_16x16x32_bf16 v[72:75], v[200:203], a[92:95], v[72:75]
    v_mfma_f32_16x16x32_bf16 v[124:127], v[120:123], v[120:123], v[124:127]
    v_mfma_f32_16x16x32_bf16 v[128:131], v[132:135], v[120:123], v[128:131]
    buffer_load_dwordx4 v[200:203], v2, s[8:11], s26 offen offset:1024 sc1
    s_waitcnt lgkmcnt(4)
    v_mfma_f32_16x16x32_bf16 v[44:47], v[204:207], a[96:99], v[44:47]
    ds_read_b128 v[116:119], v253 offset:6144
    v_mfma_f32_16x16x32_bf16 v[48:51], v[204:207], a[100:103], v[48:51]
    ds_read_b128 v[120:123], v254 offset:6144
    v_mfma_f32_16x16x32_bf16 v[52:55], v[204:207], a[104:107], v[52:55]
    ds_read_b128 a[128:131], v249 offset:8192
    v_mfma_f32_16x16x32_bf16 v[56:59], v[204:207], a[108:111], v[56:59]
    ds_read_b128 a[132:135], v249 offset:26624
    v_mfma_f32_16x16x32_bf16 v[124:127], v[108:111], v[108:111], v[124:127]
    v_mfma_f32_16x16x32_bf16 v[128:131], v[132:135], v[108:111], v[128:131]
    buffer_load_dwordx4 v[204:207], v2, s[8:11], s26 offen offset:2048 sc1
    v_mfma_f32_16x16x32_bf16 v[60:63], v[208:211], a[96:99], v[60:63]
    ds_read_b128 a[136:139], v251 offset:8192
    v_mfma_f32_16x16x32_bf16 v[64:67], v[208:211], a[100:103], v[64:67]
    ds_read_b128 a[140:143], v251 offset:26624
    v_mfma_f32_16x16x32_bf16 v[68:71], v[208:211], a[104:107], v[68:71]
    v_mfma_f32_16x16x32_bf16 v[72:75], v[208:211], a[108:111], v[72:75]
    v_mfma_f32_16x16x32_bf16 v[124:127], v[112:115], v[112:115], v[124:127]
    v_mfma_f32_16x16x32_bf16 v[128:131], v[132:135], v[112:115], v[128:131]
    buffer_load_dwordx4 v[208:211], v2, s[8:11], s26 offen offset:3072 sc1
    s_waitcnt lgkmcnt(4)
    v_mfma_f32_16x16x32_bf16 v[44:47], v[212:215], a[112:115], v[44:47]
    ds_read_b128 v[108:111], v253 offset:8192
    v_mfma_f32_16x16x32_bf16 v[48:51], v[212:215], a[116:119], v[48:51]
    ds_read_b128 v[112:115], v254 offset:8192
    v_mfma_f32_16x16x32_bf16 v[52:55], v[212:215], a[120:123], v[52:55]
    ds_read_b128 a[144:147], v250 offset:8192
    v_mfma_f32_16x16x32_bf16 v[56:59], v[212:215], a[124:127], v[56:59]
    ds_read_b128 a[148:151], v250 offset:26624
    v_mfma_f32_16x16x32_bf16 v[124:127], v[116:119], v[116:119], v[124:127]
    v_mfma_f32_16x16x32_bf16 v[128:131], v[132:135], v[116:119], v[128:131]
    s_add_u32 s26, s26, 4096
    buffer_load_dwordx4 v[212:215], v2, s[8:11], s26 offen offset:0 sc1
    v_mfma_f32_16x16x32_bf16 v[60:63], v[216:219], a[112:115], v[60:63]
    ds_read_b128 a[152:155], v252 offset:8192
    v_mfma_f32_16x16x32_bf16 v[64:67], v[216:219], a[116:119], v[64:67]
    ds_read_b128 a[156:159], v252 offset:26624
    v_mfma_f32_16x16x32_bf16 v[68:71], v[216:219], a[120:123], v[68:71]
    v_mfma_f32_16x16x32_bf16 v[72:75], v[216:219], a[124:127], v[72:75]
    v_mfma_f32_16x16x32_bf16 v[124:127], v[120:123], v[120:123], v[124:127]
    v_mfma_f32_16x16x32_bf16 v[128:131], v[132:135], v[120:123], v[128:131]
    buffer_load_dwordx4 v[216:219], v2, s[8:11], s26 offen offset:1024 sc1
    s_waitcnt lgkmcnt(4)
    v_mfma_f32_16x16x32_bf16 v[44:47], v[220:223], a[128:131], v[44:47]
    ds_read_b128 v[116:119], v253 offset:10240
    v_mfma_f32_16x16x32_bf16 v[48:51], v[220:223], a[132:135], v[48:51]
    ds_read_b128 v[120:123], v254 offset:10240
    v_mfma_f32_16x16x32_bf16 v[52:55], v[220:223], a[136:139], v[52:55]
    ds_read_b128 a[160:163], v249 offset:10240
    v_mfma_f32_16x16x32_bf16 v[56:59], v[220:223], a[140:143], v[56:59]
    ds_read_b128 a[164:167], v249 offset:28672
    v_mfma_f32_16x16x32_bf16 v[124:127], v[108:111], v[108:111], v[124:127]
    v_mfma_f32_16x16x32_bf16 v[128:131], v[132:135], v[108:111], v[128:131]
    buffer_load_dwordx4 v[220:223], v2, s[8:11], s26 offen offset:2048 sc1
    v_mfma_f32_16x16x32_bf16 v[60:63], v[224:227], a[128:131], v[60:63]
    ds_read_b128 a[168:171], v251 offset:10240
    v_mfma_f32_16x16x32_bf16 v[64:67], v[224:227], a[132:135], v[64:67]
    ds_read_b128 a[172:175], v251 offset:28672
    v_mfma_f32_16x16x32_bf16 v[68:71], v[224:227], a[136:139], v[68:71]
    v_mfma_f32_16x16x32_bf16 v[72:75], v[224:227], a[140:143], v[72:75]
    v_mfma_f32_16x16x32_bf16 v[124:127], v[112:115], v[112:115], v[124:127]
    v_mfma_f32_16x16x32_bf16 v[128:131], v[132:135], v[112:115], v[128:131]
    buffer_load_dwordx4 v[224:227], v2, s[8:11], s26 offen offset:3072 sc1
    s_waitcnt vmcnt(16) lgkmcnt(4)
    v_mfma_f32_16x16x32_bf16 v[44:47], v[156:159], a[144:147], v[44:47]
    ds_read_b128 v[108:111], v253 offset:12288
    v_mfma_f32_16x16x32_bf16 v[48:51], v[156:159], a[148:151], v[48:51]
    ds_read_b128 v[112:115], v254 offset:12288
    v_mfma_f32_16x16x32_bf16 v[52:55], v[156:159], a[152:155], v[52:55]
    ds_read_b128 a[176:179], v250 offset:10240
    v_mfma_f32_16x16x32_bf16 v[56:59], v[156:159], a[156:159], v[56:59]
    ds_read_b128 a[180:183], v250 offset:28672
    v_mfma_f32_16x16x32_bf16 v[124:127], v[116:119], v[116:119], v[124:127]
    v_mfma_f32_16x16x32_bf16 v[128:131], v[132:135], v[116:119], v[128:131]
    s_add_u32 s26, s26, 4096
    buffer_load_dwordx4 v[156:159], v2, s[8:11], s26 offen offset:0 sc1
    v_mfma_f32_16x16x32_bf16 v[60:63], v[160:163], a[144:147], v[60:63]
    ds_read_b128 a[184:187], v252 offset:10240
    v_mfma_f32_16x16x32_bf16 v[64:67], v[160:163], a[148:151], v[64:67]
    ds_read_b128 a[188:191], v252 offset:28672
    v_mfma_f32_16x16x32_bf16 v[68:71], v[160:163], a[152:155], v[68:71]
    v_mfma_f32_16x16x32_bf16 v[72:75], v[160:163], a[156:159], v[72:75]
    v_mfma_f32_16x16x32_bf16 v[124:127], v[120:123], v[120:123], v[124:127]
    v_mfma_f32_16x16x32_bf16 v[128:131], v[132:135], v[120:123], v[128:131]
    buffer_load_dwordx4 v[160:163], v2, s[8:11], s26 offen offset:1024 sc1
    s_waitcnt vmcnt(16) lgkmcnt(4)
    v_mfma_f32_16x16x32_bf16 v[44:47], v[164:167], a[160:163], v[44:47]
    ds_read_b128 v[116:119], v253 offset:14336
    v_mfma_f32_16x16x32_bf16 v[48:51], v[164:167], a[164:167], v[48:51]
    ds_read_b128 v[120:123], v254 offset:14336
    v_mfma_f32_16x16x32_bf16 v[52:55], v[164:167], a[168:171], v[52:55]
    ds_read_b128 a[192:195], v249 offset:12288
    v_mfma_f32_16x16x32_bf16 v[56:59], v[164:167], a[172:175], v[56:59]
    ds_read_b128 a[196:199], v249 offset:30720
    v_mfma_f32_16x16x32_bf16 v[124:127], v[108:111], v[108:111], v[124:127]
    v_mfma_f32_16x16x32_bf16 v[128:131], v[132:135], v[108:111], v[128:131]
    buffer_load_dwordx4 v[164:167], v2, s[8:11], s26 offen offset:2048 sc1
    v_mfma_f32_16x16x32_bf16 v[60:63], v[168:171], a[160:163], v[60:63]
    ds_read_b128 a[200:203], v251 offset:12288
    v_mfma_f32_16x16x32_bf16 v[64:67], v[168:171], a[164:167], v[64:67]
    ds_read_b128 a[204:207], v251 offset:30720
    v_mfma_f32_16x16x32_bf16 v[68:71], v[168:171], a[168:171], v[68:71]
    v_mfma_f32_16x16x32_bf16 v[72:75], v[168:171], a[172:175], v[72:75]
    v_mfma_f32_16x16x32_bf16 v[124:127], v[112:115], v[112:115], v[124:127]
    v_mfma_f32_16x16x32_bf16 v[128:131], v[132:135], v[112:115], v[128:131]
    buffer_load_dwordx4 v[168:171], v2, s[8:11], s26 offen offset:3072 sc1
    s_waitcnt vmcnt(16) lgkmcnt(4)
    v_mfma_f32_16x16x32_bf16 v[44:47], v[172:175], a[176:179], v[44:47]
    ds_read_b128 v[108:111], v253 offset:16384
    v_mfma_f32_16x16x32_bf16 v[48:51], v[172:175], a[180:183], v[48:51]
    ds_read_b128 v[112:115], v254 offset:16384
    v_mfma_f32_16x16x32_bf16 v[52:55], v[172:175], a[184:187], v[52:55]
    ds_read_b128 a[208:211], v250 offset:12288
    v_mfma_f32_16x16x32_bf16 v[56:59], v[172:175], a[188:191], v[56:59]
    ds_read_b128 a[212:215], v250 offset:30720
    v_mfma_f32_16x16x32_bf16 v[124:127], v[116:119], v[116:119], v[124:127]
    v_mfma_f32_16x16x32_bf16 v[128:131], v[132:135], v[116:119], v[128:131]
    s_add_u32 s26, s26, 4096
    buffer_load_dwordx4 v[172:175], v2, s[8:11], s26 offen offset:0 sc1
    v_mfma_f32_16x16x32_bf16 v[60:63], v[176:179], a[176:179], v[60:63]
    ds_read_b128 a[216:219], v252 offset:12288
    v_mfma_f32_16x16x32_bf16 v[64:67], v[176:179], a[180:183], v[64:67]
    ds_read_b128 a[220:223], v252 offset:30720
    v_mfma_f32_16x16x32_bf16 v[68:71], v[176:179], a[184:187], v[68:71]
    v_mfma_f32_16x16x32_bf16 v[72:75], v[176:179], a[188:191], v[72:75]
    v_mfma_f32_16x16x32_bf16 v[124:127], v[120:123], v[120:123], v[124:127]
    v_mfma_f32_16x16x32_bf16 v[128:131], v[132:135], v[120:123], v[128:131]
    buffer_load_dwordx4 v[176:179], v2, s[8:11], s26 offen offset:1024 sc1
    s_waitcnt vmcnt(16) lgkmcnt(4)
    v_mfma_f32_16x16x32_bf16 v[44:47], v[180:183], a[192:195], v[44:47]
    ds_read_b128 a[224:227], v249 offset:14336
    v_mfma_f32_16x16x32_bf16 v[48:51], v[180:183], a[196:199], v[48:51]
    ds_read_b128 a[228:231], v249 offset:32768
    v_mfma_f32_16x16x32_bf16 v[52:55], v[180:183], a[200:203], v[52:55]
    ds_read_b128 a[232:235], v251 offset:14336
    v_mfma_f32_16x16x32_bf16 v[56:59], v[180:183], a[204:207], v[56:59]
    ds_read_b128 a[236:239], v251 offset:32768
    v_mfma_f32_16x16x32_bf16 v[124:127], v[108:111], v[108:111], v[124:127]
    v_mfma_f32_16x16x32_bf16 v[128:131], v[132:135], v[108:111], v[128:131]
    buffer_load_dwordx4 v[180:183], v2, s[8:11], s26 offen offset:2048 sc1
    v_mfma_f32_16x16x32_bf16 v[60:63], v[184:187], a[192:195], v[60:63]
    v_mfma_f32_16x16x32_bf16 v[64:67], v[184:187], a[196:199], v[64:67]
    v_mfma_f32_16x16x32_bf16 v[68:71], v[184:187], a[200:203], v[68:71]
    v_mfma_f32_16x16x32_bf16 v[72:75], v[184:187], a[204:207], v[72:75]
    v_mfma_f32_16x16x32_bf16 v[124:127], v[112:115], v[112:115], v[124:127]
    v_mfma_f32_16x16x32_bf16 v[128:131], v[132:135], v[112:115], v[128:131]
    buffer_load_dwordx4 v[184:187], v2, s[8:11], s26 offen offset:3072 sc1
    s_waitcnt vmcnt(16) lgkmcnt(4)
    v_mfma_f32_16x16x32_bf16 v[44:47], v[188:191], a[208:211], v[44:47]
    ds_read_b128 a[240:243], v250 offset:14336
    v_mfma_f32_16x16x32_bf16 v[48:51], v[188:191], a[212:215], v[48:51]
    ds_read_b128 a[244:247], v250 offset:32768
    v_mfma_f32_16x16x32_bf16 v[52:55], v[188:191], a[216:219], v[52:55]
    ds_read_b128 a[248:251], v252 offset:14336
    v_mfma_f32_16x16x32_bf16 v[56:59], v[188:191], a[220:223], v[56:59]
    ds_read_b128 a[252:255], v252 offset:32768
    s_add_u32 s26, s26, 4096
    buffer_load_dwordx4 v[188:191], v2, s[8:11], s26 offen offset:0 sc1
    v_mfma_f32_16x16x32_bf16 v[60:63], v[192:195], a[208:211], v[60:63]
    v_mfma_f32_16x16x32_bf16 v[64:67], v[192:195], a[212:215], v[64:67]
    v_mfma_f32_16x16x32_bf16 v[68:71], v[192:195], a[216:219], v[68:71]
    v_mfma_f32_16x16x32_bf16 v[72:75], v[192:195], a[220:223], v[72:75]
    buffer_load_dwordx4 v[192:195], v2, s[8:11], s26 offen offset:1024 sc1
    s_waitcnt vmcnt(16) lgkmcnt(4)
    v_mfma_f32_16x16x32_bf16 v[44:47], v[196:199], a[224:227], v[44:47]
    ds_read_b128 v[12:15], v249 offset:16384
    v_cndmask_b32 v124, v124, v125, s[36:37]
    v_mul_f32 v128, 987991609, v128
    v_mfma_f32_16x16x32_bf16 v[48:51], v[196:199], a[228:231], v[48:51]
    ds_read_b128 v[16:19], v249 offset:34816
    v_cndmask_b32 v124, v124, v126, s[38:39]
    v_mul_f32 v128, v128, v128
    v_mfma_f32_16x16x32_bf16 v[52:55], v[196:199], a[232:235], v[52:55]
    ds_read_b128 v[20:23], v251 offset:16384
    v_cndmask_b32 v124, v124, v127, s[40:41]
    v_mfma_f32_16x16x32_bf16 v[56:59], v[196:199], a[236:239], v[56:59]
    ds_read_b128 v[24:27], v251 offset:34816
    v_mul_f32 v124, 987991609, v124
    buffer_load_dwordx4 v[196:199], v2, s[8:11], s26 offen offset:2048 sc1
    v_mfma_f32_16x16x32_bf16 v[60:63], v[200:203], a[224:227], v[60:63]
    v_sub_f32 v124, v124, v128
    v_mfma_f32_16x16x32_bf16 v[64:67], v[200:203], a[228:231], v[64:67]
    v_max_f32 v124, 0, v124
    v_mfma_f32_16x16x32_bf16 v[68:71], v[200:203], a[232:235], v[68:71]
    v_add_f32 v124, 925353388, v124
    v_mfma_f32_16x16x32_bf16 v[72:75], v[200:203], a[236:239], v[72:75]
    v_rsq_f32 v128, v124
    buffer_load_dwordx4 v[200:203], v2, s[8:11], s26 offen offset:3072 sc1
    s_waitcnt vmcnt(16) lgkmcnt(4)
    v_mul_f32 v137, v124, v128
    v_mul_f32 v136, 3216550459, v128
    s_lshl_b32 s20, s6, 7
    v_add_u32 v138, s20, v10
    s_mov_b64 exec, s[42:43]
    ds_write_b64 v138, v[136:137]
    s_mov_b64 exec, -1
    v_mfma_f32_16x16x32_bf16 v[44:47], v[204:207], a[240:243], v[44:47]
    ds_read_b128 v[28:31], v250 offset:16384
    v_mfma_f32_16x16x32_bf16 v[48:51], v[204:207], a[244:247], v[48:51]
    ds_read_b128 v[32:35], v250 offset:34816
    v_mfma_f32_16x16x32_bf16 v[52:55], v[204:207], a[248:251], v[52:55]
    ds_read_b128 v[36:39], v252 offset:16384
    v_mfma_f32_16x16x32_bf16 v[56:59], v[204:207], a[252:255], v[56:59]
    ds_read_b128 v[40:43], v252 offset:34816
    s_add_u32 s26, s26, 4096
    buffer_load_dwordx4 v[204:207], v2, s[8:11], s26 offen offset:0 sc1
    v_mfma_f32_16x16x32_bf16 v[60:63], v[208:211], a[240:243], v[60:63]
    v_mfma_f32_16x16x32_bf16 v[64:67], v[208:211], a[244:247], v[64:67]
    v_mfma_f32_16x16x32_bf16 v[68:71], v[208:211], a[248:251], v[68:71]
    v_mfma_f32_16x16x32_bf16 v[72:75], v[208:211], a[252:255], v[72:75]
    buffer_load_dwordx4 v[208:211], v2, s[8:11], s26 offen offset:1024 sc1
    s_waitcnt vmcnt(16) lgkmcnt(5)
    s_waitcnt lgkmcnt(0)
    s_barrier
    ds_read_b64 v[228:229], v10 offset:0
    ds_read_b64 v[230:231], v10 offset:128
    ds_read_b64 v[232:233], v10 offset:256
    ds_read_b64 v[234:235], v10 offset:384
    v_mfma_f32_16x16x32_bf16 v[44:47], v[212:215], v[12:15], v[44:47]
    s_mul_i32 s97, s6, 18432
    v_mfma_f32_16x16x32_bf16 v[48:51], v[212:215], v[16:19], v[48:51]
    v_mfma_f32_16x16x32_bf16 v[52:55], v[212:215], v[20:23], v[52:55]
    v_mfma_f32_16x16x32_bf16 v[56:59], v[212:215], v[24:27], v[56:59]
    buffer_load_dwordx4 v[212:215], v2, s[8:11], s26 offen offset:2048 sc1
    v_mfma_f32_16x16x32_bf16 v[60:63], v[216:219], v[12:15], v[60:63]
    v_mfma_f32_16x16x32_bf16 v[64:67], v[216:219], v[16:19], v[64:67]
    v_mfma_f32_16x16x32_bf16 v[68:71], v[216:219], v[20:23], v[68:71]
    v_mfma_f32_16x16x32_bf16 v[72:75], v[216:219], v[24:27], v[72:75]
    buffer_load_dwordx4 v[216:219], v2, s[8:11], s26 offen offset:3072 sc1
    s_waitcnt vmcnt(16)
    v_mfma_f32_16x16x32_bf16 v[44:47], v[220:223], v[28:31], v[44:47]
    v_mov_b32 v0, v253
    v_mfma_f32_16x16x32_bf16 v[48:51], v[220:223], v[32:35], v[48:51]
    v_mfma_f32_16x16x32_bf16 v[52:55], v[220:223], v[36:39], v[52:55]
    v_mfma_f32_16x16x32_bf16 v[56:59], v[220:223], v[40:43], v[56:59]
    s_add_u32 s26, s26, 4096
    buffer_load_dwordx4 v[220:223], v2, s[8:11], s26 offen offset:0 sc1
    v_mfma_f32_16x16x32_bf16 v[60:63], v[224:227], v[28:31], v[60:63]
    v_mfma_f32_16x16x32_bf16 v[64:67], v[224:227], v[32:35], v[64:67]
    v_mfma_f32_16x16x32_bf16 v[68:71], v[224:227], v[36:39], v[68:71]
    v_mfma_f32_16x16x32_bf16 v[72:75], v[224:227], v[40:43], v[72:75]
    buffer_load_dwordx4 v[224:227], v2, s[8:11], s26 offen offset:1024 sc1
    s_waitcnt lgkmcnt(0)
    s_waitcnt vmcnt(14)
    v_mfma_f32_16x16x32_bf16 v[76:79], v[156:159], a[0:3], 0
    v_mfma_f32_16x16x32_bf16 v[80:83], v[156:159], a[4:7], 0
    v_mfma_f32_16x16x32_bf16 v[84:87], v[156:159], a[8:11], 0
    v_mul_f32 v236, v44, v228
    v_mul_f32 v237, v45, v228
    v_mul_f32 v238, v46, v228
    v_mul_f32 v239, v47, v228
    v_exp_f32 v236, v236
    v_mfma_f32_16x16x32_bf16 v[88:91], v[156:159], a[12:15], 0
    buffer_load_dwordx4 v[156:159], v2, s[8:11], s26 offen offset:2048 sc1
    v_mfma_f32_16x16x32_bf16 v[92:95], v[160:163], a[0:3], 0
    v_exp_f32 v237, v237
    v_exp_f32 v238, v238
    v_mfma_f32_16x16x32_bf16 v[96:99], v[160:163], a[4:7], 0
    v_exp_f32 v239, v239
    v_mfma_f32_16x16x32_bf16 v[100:103], v[160:163], a[8:11], 0
    v_fma_f32 v236, v236, v229, v229
    v_fma_f32 v237, v237, v229, v229
    v_mfma_f32_16x16x32_bf16 v[104:107], v[160:163], a[12:15], 0
    buffer_load_dwordx4 v[160:163], v2, s[8:11], s26 offen offset:3072 sc1
    v_mfma_f32_16x16x32_bf16 v[76:79], v[164:167], a[16:19], v[76:79]
    v_rcp_f32 v236, v236
    v_mul_f32 v240, v48, v230
    v_mfma_f32_16x16x32_bf16 v[80:83], v[164:167], a[20:23], v[80:83]
    v_fma_f32 v238, v238, v229, v229
    v_mfma_f32_16x16x32_bf16 v[84:87], v[164:167], a[24:27], v[84:87]
    v_rcp_f32 v237, v237
    v_mul_f32 v241, v49, v230
    v_mfma_f32_16x16x32_bf16 v[88:91], v[164:167], a[28:31], v[88:91]
    s_add_u32 s26, s26, 4096
    buffer_load_dwordx4 v[164:167], v2, s[8:11], s26 offen offset:0 sc1
    v_mfma_f32_16x16x32_bf16 v[92:95], v[168:171], a[16:19], v[92:95]
    v_fma_f32 v239, v239, v229, v229
    v_mfma_f32_16x16x32_bf16 v[96:99], v[168:171], a[20:23], v[96:99]
    v_rcp_f32 v238, v238
    v_mul_f32 v242, v50, v230
    v_mfma_f32_16x16x32_bf16 v[100:103], v[168:171], a[24:27], v[100:103]
    v_rcp_f32 v239, v239
    v_mfma_f32_16x16x32_bf16 v[104:107], v[168:171], a[28:31], v[104:107]
    v_mul_f32 v243, v51, v230
    buffer_load_dwordx4 v[168:171], v2, s[8:11], s26 offen offset:1024 sc1
    s_waitcnt vmcnt(14)
    v_mfma_f32_16x16x32_bf16 v[76:79], v[172:175], a[32:35], v[76:79]
    v_exp_f32 v240, v240
    v_mfma_f32_16x16x32_bf16 v[80:83], v[172:175], a[36:39], v[80:83]
    s_add_u32 m0, s97, 0
    s_mov_b32 s98, 240640
    buffer_load_dwordx4 v2, s[8:11], s98 offen sc1 lds
    v_mfma_f32_16x16x32_bf16 v[84:87], v[172:175], a[40:43], v[84:87]
    v_mfma_f32_16x16x32_bf16 v[88:91], v[172:175], a[44:47], v[88:91]
    v_mul_f32 v236, v44, v236
    buffer_load_dwordx4 v[172:175], v2, s[8:11], s26 offen offset:2048 sc1
    v_mfma_f32_16x16x32_bf16 v[92:95], v[176:179], a[32:35], v[92:95]
    v_mul_f32 v237, v45, v237
    v_exp_f32 v241, v241
    v_mfma_f32_16x16x32_bf16 v[96:99], v[176:179], a[36:39], v[96:99]
    v_mul_f32 v238, v46, v238
    v_mul_f32 v239, v47, v239
    v_mfma_f32_16x16x32_bf16 v[100:103], v[176:179], a[40:43], v[100:103]
    v_exp_f32 v242, v242
    v_mfma_f32_16x16x32_bf16 v[104:107], v[176:179], a[44:47], v[104:107]
    buffer_load_dwordx4 v[176:179], v2, s[8:11], s26 offen offset:3072 sc1
    v_mfma_f32_16x16x32_bf16 v[76:79], v[180:183], a[48:51], v[76:79]
    v_cvt_pk_bf16_f32 v44, v236, v237
    v_exp_f32 v243, v243
    v_mfma_f32_16x16x32_bf16 v[80:83], v[180:183], a[52:55], v[80:83]
    v_cvt_pk_bf16_f32 v45, v238, v239
    v_fma_f32 v240, v240, v231, v231
    v_mfma_f32_16x16x32_bf16 v[84:87], v[180:183], a[56:59], v[84:87]
    v_fma_f32 v241, v241, v231, v231
    v_mfma_f32_16x16x32_bf16 v[88:91], v[180:183], a[60:63], v[88:91]
    v_rcp_f32 v240, v240
    s_add_u32 s26, s26, 4096
    buffer_load_dwordx4 v[180:183], v2, s[8:11], s26 offen offset:0 sc1
    v_mfma_f32_16x16x32_bf16 v[92:95], v[184:187], a[48:51], v[92:95]
    v_mul_f32 v236, v52, v232
    v_mfma_f32_16x16x32_bf16 v[96:99], v[184:187], a[52:55], v[96:99]
    v_fma_f32 v242, v242, v231, v231
    v_rcp_f32 v241, v241
    v_mfma_f32_16x16x32_bf16 v[100:103], v[184:187], a[56:59], v[100:103]
    v_mul_f32 v237, v53, v232
    v_mfma_f32_16x16x32_bf16 v[104:107], v[184:187], a[60:63], v[104:107]
    v_fma_f32 v243, v243, v231, v231
    buffer_load_dwordx4 v[184:187], v2, s[8:11], s26 offen offset:1024 sc1
    s_waitcnt vmcnt(15)
    v_mfma_f32_16x16x32_bf16 v[76:79], v[188:191], a[64:67], v[76:79]
    v_rcp_f32 v242, v242
    v_mfma_f32_16x16x32_bf16 v[80:83], v[188:191], a[68:71], v[80:83]
    v_mul_f32 v238, v54, v232
    v_mfma_f32_16x16x32_bf16 v[84:87], v[188:191], a[72:75], v[84:87]
    v_rcp_f32 v243, v243
    v_mfma_f32_16x16x32_bf16 v[88:91], v[188:191], a[76:79], v[88:91]
    v_mul_f32 v239, v55, v232
    buffer_load_dwordx4 v[188:191], v2, s[8:11], s26 offen offset:2048 sc1
    v_mfma_f32_16x16x32_bf16 v[92:95], v[192:195], a[64:67], v[92:95]
    v_exp_f32 v236, v236
    v_mul_f32 v240, v48, v240
    v_mfma_f32_16x16x32_bf16 v[96:99], v[192:195], a[68:71], v[96:99]
    v_mul_f32 v241, v49, v241
    v_mfma_f32_16x16x32_bf16 v[100:103], v[192:195], a[72:75], v[100:103]
    v_exp_f32 v237, v237
    v_mul_f32 v242, v50, v242
    v_mfma_f32_16x16x32_bf16 v[104:107], v[192:195], a[76:79], v[104:107]
    buffer_load_dwordx4 v[192:195], v2, s[8:11], s26 offen offset:3072 sc1
    v_mfma_f32_16x16x32_bf16 v[76:79], v[196:199], a[80:83], v[76:79]
    v_mul_f32 v243, v51, v243
    v_exp_f32 v238, v238
    v_mfma_f32_16x16x32_bf16 v[80:83], v[196:199], a[84:87], v[80:83]
    v_cvt_pk_bf16_f32 v48, v240, v241
    v_mfma_f32_16x16x32_bf16 v[84:87], v[196:199], a[88:91], v[84:87]
    v_exp_f32 v239, v239
    v_cvt_pk_bf16_f32 v49, v242, v243
    v_mfma_f32_16x16x32_bf16 v[88:91], v[196:199], a[92:95], v[88:91]
    v_fma_f32 v236, v236, v233, v233
    s_add_u32 s26, s26, 4096
    buffer_load_dwordx4 v[196:199], v2, s[8:11], s26 offen offset:0 sc1
    v_mfma_f32_16x16x32_bf16 v[92:95], v[200:203], a[80:83], v[92:95]
    v_fma_f32 v237, v237, v233, v233
    v_mfma_f32_16x16x32_bf16 v[96:99], v[200:203], a[84:87], v[96:99]
    v_rcp_f32 v236, v236
    v_mfma_f32_16x16x32_bf16 v[100:103], v[200:203], a[88:91], v[100:103]
    v_mul_f32 v240, v56, v234
    v_fma_f32 v238, v238, v233, v233
    v_mfma_f32_16x16x32_bf16 v[104:107], v[200:203], a[92:95], v[104:107]
    buffer_load_dwordx4 v[200:203], v2, s[8:11], s26 offen offset:1024 sc1
    s_waitcnt vmcnt(15)
    v_mfma_f32_16x16x32_bf16 v[76:79], v[204:207], a[96:99], v[76:79]
    v_rcp_f32 v237, v237
    v_mfma_f32_16x16x32_bf16 v[80:83], v[204:207], a[100:103], v[80:83]
    v_mul_f32 v241, v57, v234
    v_fma_f32 v239, v239, v233, v233
    v_mfma_f32_16x16x32_bf16 v[84:87], v[204:207], a[104:107], v[84:87]
    v_rcp_f32 v238, v238
    v_mul_f32 v242, v58, v234
    v_mfma_f32_16x16x32_bf16 v[88:91], v[204:207], a[108:111], v[88:91]
    buffer_load_dwordx4 v[204:207], v2, s[8:11], s26 offen offset:2048 sc1
    v_mfma_f32_16x16x32_bf16 v[92:95], v[208:211], a[96:99], v[92:95]
    v_rcp_f32 v239, v239
    v_mul_f32 v243, v59, v234
    v_mfma_f32_16x16x32_bf16 v[96:99], v[208:211], a[100:103], v[96:99]
    s_add_u32 m0, s97, 1024
    s_mov_b32 s98, 242688
    buffer_load_dwordx4 v2, s[8:11], s98 offen sc1 lds
    v_mfma_f32_16x16x32_bf16 v[100:103], v[208:211], a[104:107], v[100:103]
    v_mfma_f32_16x16x32_bf16 v[104:107], v[208:211], a[108:111], v[104:107]
    v_exp_f32 v240, v240
    buffer_load_dwordx4 v[208:211], v2, s[8:11], s26 offen offset:3072 sc1
    v_mfma_f32_16x16x32_bf16 v[76:79], v[212:215], a[112:115], v[76:79]
    v_mul_f32 v236, v52, v236
    v_mul_f32 v237, v53, v237
    v_mfma_f32_16x16x32_bf16 v[80:83], v[212:215], a[116:119], v[80:83]
    v_exp_f32 v241, v241
    v_mfma_f32_16x16x32_bf16 v[84:87], v[212:215], a[120:123], v[84:87]
    v_mul_f32 v238, v54, v238
    v_mul_f32 v239, v55, v239
    v_mfma_f32_16x16x32_bf16 v[88:91], v[212:215], a[124:127], v[88:91]
    s_add_u32 s26, s26, 4096
    buffer_load_dwordx4 v[212:215], v2, s[8:11], s26 offen offset:0 sc1
    v_mfma_f32_16x16x32_bf16 v[92:95], v[216:219], a[112:115], v[92:95]
    v_exp_f32 v242, v242
    v_mfma_f32_16x16x32_bf16 v[96:99], v[216:219], a[116:119], v[96:99]
    v_cvt_pk_bf16_f32 v52, v236, v237
    v_exp_f32 v243, v243
    v_mfma_f32_16x16x32_bf16 v[100:103], v[216:219], a[120:123], v[100:103]
    v_cvt_pk_bf16_f32 v53, v238, v239
    v_mfma_f32_16x16x32_bf16 v[104:107], v[216:219], a[124:127], v[104:107]
    v_fma_f32 v240, v240, v235, v235
    buffer_load_dwordx4 v[216:219], v2, s[8:11], s26 offen offset:1024 sc1
    s_waitcnt vmcnt(16)
    v_mfma_f32_16x16x32_bf16 v[76:79], v[220:223], a[128:131], v[76:79]
    v_fma_f32 v241, v241, v235, v235
    v_mfma_f32_16x16x32_bf16 v[80:83], v[220:223], a[132:135], v[80:83]
    v_rcp_f32 v240, v240
    v_mul_f32 v236, v60, v228
    v_mfma_f32_16x16x32_bf16 v[84:87], v[220:223], a[136:139], v[84:87]
    v_fma_f32 v242, v242, v235, v235
    v_mfma_f32_16x16x32_bf16 v[88:91], v[220:223], a[140:143], v[88:91]
    v_rcp_f32 v241, v241
    buffer_load_dwordx4 v[220:223], v2, s[8:11], s26 offen offset:2048 sc1
    v_mfma_f32_16x16x32_bf16 v[92:95], v[224:227], a[128:131], v[92:95]
    v_mul_f32 v237, v61, v228
    v_fma_f32 v243, v243, v235, v235
    v_mfma_f32_16x16x32_bf16 v[96:99], v[224:227], a[132:135], v[96:99]
    v_rcp_f32 v242, v242
    v_mfma_f32_16x16x32_bf16 v[100:103], v[224:227], a[136:139], v[100:103]
    v_mul_f32 v238, v62, v228
    v_mfma_f32_16x16x32_bf16 v[104:107], v[224:227], a[140:143], v[104:107]
    v_rcp_f32 v243, v243
    buffer_load_dwordx4 v[224:227], v2, s[8:11], s26 offen offset:3072 sc1
    v_mfma_f32_16x16x32_bf16 v[76:79], v[156:159], a[144:147], v[76:79]
    v_mul_f32 v239, v63, v228
    v_exp_f32 v236, v236
    v_mfma_f32_16x16x32_bf16 v[80:83], v[156:159], a[148:151], v[80:83]
    v_mul_f32 v240, v56, v240
    v_mfma_f32_16x16x32_bf16 v[84:87], v[156:159], a[152:155], v[84:87]
    v_mul_f32 v241, v57, v241
    v_exp_f32 v237, v237
    v_mfma_f32_16x16x32_bf16 v[88:91], v[156:159], a[156:159], v[88:91]
    s_add_u32 s26, s26, 4096
    buffer_load_dwordx4 v[156:159], v2, s[8:11], s26 offen offset:0 sc1
    v_mfma_f32_16x16x32_bf16 v[92:95], v[160:163], a[144:147], v[92:95]
    v_mul_f32 v242, v58, v242
    v_mfma_f32_16x16x32_bf16 v[96:99], v[160:163], a[148:151], v[96:99]
    v_mul_f32 v243, v59, v243
    v_exp_f32 v238, v238
    v_mfma_f32_16x16x32_bf16 v[100:103], v[160:163], a[152:155], v[100:103]
    v_cvt_pk_bf16_f32 v56, v240, v241
    v_mfma_f32_16x16x32_bf16 v[104:107], v[160:163], a[156:159], v[104:107]
    v_exp_f32 v239, v239
    buffer_load_dwordx4 v[160:163], v2, s[8:11], s26 offen offset:1024 sc1
    s_waitcnt vmcnt(15)
    v_mfma_f32_16x16x32_bf16 v[76:79], v[164:167], a[160:163], v[76:79]
    v_cvt_pk_bf16_f32 v57, v242, v243
    v_mfma_f32_16x16x32_bf16 v[80:83], v[164:167], a[164:167], v[80:83]
    v_fma_f32 v236, v236, v229, v229
    v_fma_f32 v237, v237, v229, v229
    v_mfma_f32_16x16x32_bf16 v[84:87], v[164:167], a[168:171], v[84:87]
    v_rcp_f32 v236, v236
    v_mfma_f32_16x16x32_bf16 v[88:91], v[164:167], a[172:175], v[88:91]
    buffer_load_dwordx4 v[164:167], v2, s[8:11], s26 offen offset:2048 sc1
    v_mfma_f32_16x16x32_bf16 v[92:95], v[168:171], a[160:163], v[92:95]
    v_mul_f32 v240, v64, v230
    v_fma_f32 v238, v238, v229, v229
    v_mfma_f32_16x16x32_bf16 v[96:99], v[168:171], a[164:167], v[96:99]
    v_rcp_f32 v237, v237
    v_mul_f32 v241, v65, v230
    v_mfma_f32_16x16x32_bf16 v[100:103], v[168:171], a[168:171], v[100:103]
    v_fma_f32 v239, v239, v229, v229
    v_rcp_f32 v238, v238
    v_mfma_f32_16x16x32_bf16 v[104:107], v[168:171], a[172:175], v[104:107]
    buffer_load_dwordx4 v[168:171], v2, s[8:11], s26 offen offset:3072 sc1
    v_mfma_f32_16x16x32_bf16 v[76:79], v[172:175], a[176:179], v[76:79]
    v_mul_f32 v242, v66, v230
    v_rcp_f32 v239, v239
    v_mfma_f32_16x16x32_bf16 v[80:83], v[172:175], a[180:183], v[80:83]
    v_mul_f32 v243, v67, v230
    v_mfma_f32_16x16x32_bf16 v[84:87], v[172:175], a[184:187], v[84:87]
    v_exp_f32 v240, v240
    v_mfma_f32_16x16x32_bf16 v[88:91], v[172:175], a[188:191], v[88:91]
    v_mul_f32 v236, v60, v236
    s_add_u32 s26, s26, 4096
    buffer_load_dwordx4 v[172:175], v2, s[8:11], s26 offen offset:0 sc1
    v_mfma_f32_16x16x32_bf16 v[92:95], v[176:179], a[176:179], v[92:95]
    v_mul_f32 v237, v61, v237
    v_mfma_f32_16x16x32_bf16 v[96:99], v[176:179], a[180:183], v[96:99]
    s_add_u32 m0, s97, 2048
    s_mov_b32 s98, 244736
    buffer_load_dwordx4 v2, s[8:11], s98 offen sc1 lds
    v_mfma_f32_16x16x32_bf16 v[100:103], v[176:179], a[184:187], v[100:103]
    v_exp_f32 v241, v241
    v_mfma_f32_16x16x32_bf16 v[104:107], v[176:179], a[188:191], v[104:107]
    buffer_load_dwordx4 v[176:179], v2, s[8:11], s26 offen offset:1024 sc1
    s_waitcnt vmcnt(16)
    v_mfma_f32_16x16x32_bf16 v[76:79], v[180:183], a[192:195], v[76:79]
    v_mul_f32 v238, v62, v238
    v_mul_f32 v239, v63, v239
    v_mfma_f32_16x16x32_bf16 v[80:83], v[180:183], a[196:199], v[80:83]
    v_exp_f32 v242, v242
    v_mfma_f32_16x16x32_bf16 v[84:87], v[180:183], a[200:203], v[84:87]
    v_cvt_pk_bf16_f32 v46, v236, v237
    v_cvt_pk_bf16_f32 v47, v238, v239
    v_mfma_f32_16x16x32_bf16 v[88:91], v[180:183], a[204:207], v[88:91]
    buffer_load_dwordx4 v[180:183], v2, s[8:11], s26 offen offset:2048 sc1
    v_mfma_f32_16x16x32_bf16 v[92:95], v[184:187], a[192:195], v[92:95]
    v_exp_f32 v243, v243
    ds_write_b128 v8, v[44:47] offset:0
    v_mfma_f32_16x16x32_bf16 v[96:99], v[184:187], a[196:199], v[96:99]
    v_fma_f32 v240, v240, v231, v231
    v_fma_f32 v241, v241, v231, v231
    v_mfma_f32_16x16x32_bf16 v[100:103], v[184:187], a[200:203], v[100:103]
    v_rcp_f32 v240, v240
    v_mfma_f32_16x16x32_bf16 v[104:107], v[184:187], a[204:207], v[104:107]
    v_mul_f32 v236, v68, v232
    buffer_load_dwordx4 v[184:187], v2, s[8:11], s26 offen offset:3072 sc1
    v_mfma_f32_16x16x32_bf16 v[76:79], v[188:191], a[208:211], v[76:79]
    v_fma_f32 v242, v242, v231, v231
    v_rcp_f32 v241, v241
    v_mfma_f32_16x16x32_bf16 v[80:83], v[188:191], a[212:215], v[80:83]
    v_mul_f32 v237, v69, v232
    v_mfma_f32_16x16x32_bf16 v[84:87], v[188:191], a[216:219], v[84:87]
    v_fma_f32 v243, v243, v231, v231
    v_rcp_f32 v242, v242
    v_mfma_f32_16x16x32_bf16 v[88:91], v[188:191], a[220:223], v[88:91]
    s_add_u32 s26, s26, 4096
    buffer_load_dwordx4 v[188:191], v2, s[8:11], s26 offen offset:0 sc1
    v_mfma_f32_16x16x32_bf16 v[92:95], v[192:195], a[208:211], v[92:95]
    v_mul_f32 v238, v70, v232
    v_mfma_f32_16x16x32_bf16 v[96:99], v[192:195], a[212:215], v[96:99]
    v_rcp_f32 v243, v243
    v_mul_f32 v239, v71, v232
    v_mfma_f32_16x16x32_bf16 v[100:103], v[192:195], a[216:219], v[100:103]
    v_exp_f32 v236, v236
    v_mfma_f32_16x16x32_bf16 v[104:107], v[192:195], a[220:223], v[104:107]
    buffer_load_dwordx4 v[192:195], v2, s[8:11], s26 offen offset:1024 sc1
    s_waitcnt vmcnt(15)
    v_mfma_f32_16x16x32_bf16 v[76:79], v[196:199], a[224:227], v[76:79]
    v_mul_f32 v240, v64, v240
    v_mul_f32 v241, v65, v241
    v_mfma_f32_16x16x32_bf16 v[80:83], v[196:199], a[228:231], v[80:83]
    v_exp_f32 v237, v237
    v_mfma_f32_16x16x32_bf16 v[84:87], v[196:199], a[232:235], v[84:87]
    v_mul_f32 v242, v66, v242
    v_mul_f32 v243, v67, v243
    v_mfma_f32_16x16x32_bf16 v[88:91], v[196:199], a[236:239], v[88:91]
    buffer_load_dwordx4 v[196:199], v2, s[8:11], s26 offen offset:2048 sc1
    v_mfma_f32_16x16x32_bf16 v[92:95], v[200:203], a[224:227], v[92:95]
    v_exp_f32 v238, v238
    v_cvt_pk_bf16_f32 v50, v240, v241
    v_mfma_f32_16x16x32_bf16 v[96:99], v[200:203], a[228:231], v[96:99]
    v_cvt_pk_bf16_f32 v51, v242, v243
    v_exp_f32 v239, v239
    v_mfma_f32_16x16x32_bf16 v[100:103], v[200:203], a[232:235], v[100:103]
    ds_write_b128 v8, v[48:51] offset:1024
    v_mfma_f32_16x16x32_bf16 v[104:107], v[200:203], a[236:239], v[104:107]
    v_fma_f32 v236, v236, v233, v233
    buffer_load_dwordx4 v[200:203], v2, s[8:11], s26 offen offset:3072 sc1
    v_mfma_f32_16x16x32_bf16 v[76:79], v[204:207], a[240:243], v[76:79]
    v_fma_f32 v237, v237, v233, v233
    v_rcp_f32 v236, v236
    v_mfma_f32_16x16x32_bf16 v[80:83], v[204:207], a[244:247], v[80:83]
    v_mul_f32 v240, v72, v234
    v_fma_f32 v238, v238, v233, v233
    v_mfma_f32_16x16x32_bf16 v[84:87], v[204:207], a[248:251], v[84:87]
    v_rcp_f32 v237, v237
    v_mfma_f32_16x16x32_bf16 v[88:91], v[204:207], a[252:255], v[88:91]
    s_add_u32 s26, s26, 4096
    buffer_load_dwordx4 v[204:207], v2, s[8:11], s26 offen offset:0 sc1
    v_mfma_f32_16x16x32_bf16 v[92:95], v[208:211], a[240:243], v[92:95]
    v_mul_f32 v241, v73, v234
    v_fma_f32 v239, v239, v233, v233
    v_mfma_f32_16x16x32_bf16 v[96:99], v[208:211], a[244:247], v[96:99]
    v_rcp_f32 v238, v238
    v_mfma_f32_16x16x32_bf16 v[100:103], v[208:211], a[248:251], v[100:103]
    v_mul_f32 v242, v74, v234
    v_mfma_f32_16x16x32_bf16 v[104:107], v[208:211], a[252:255], v[104:107]
    v_rcp_f32 v239, v239
    buffer_load_dwordx4 v[208:211], v2, s[8:11], s26 offen offset:1024 sc1
    s_waitcnt vmcnt(15)
    v_mfma_f32_16x16x32_bf16 v[76:79], v[212:215], v[12:15], v[76:79]
    v_mul_f32 v243, v75, v234
    v_mfma_f32_16x16x32_bf16 v[80:83], v[212:215], v[16:19], v[80:83]
    v_exp_f32 v240, v240
    v_mfma_f32_16x16x32_bf16 v[84:87], v[212:215], v[20:23], v[84:87]
    v_mul_f32 v236, v68, v236
    v_mul_f32 v237, v69, v237
    v_mfma_f32_16x16x32_bf16 v[88:91], v[212:215], v[24:27], v[88:91]
    buffer_load_dwordx4 v[212:215], v2, s[8:11], s26 offen offset:2048 sc1
    v_mfma_f32_16x16x32_bf16 v[92:95], v[216:219], v[12:15], v[92:95]
    v_exp_f32 v241, v241
    v_mul_f32 v238, v70, v238
    v_mfma_f32_16x16x32_bf16 v[96:99], v[216:219], v[16:19], v[96:99]
    s_add_u32 m0, s97, 3072
    s_mov_b32 s98, 246784
    buffer_load_dwordx4 v2, s[8:11], s98 offen sc1 lds
    v_mfma_f32_16x16x32_bf16 v[100:103], v[216:219], v[20:23], v[100:103]
    v_mul_f32 v239, v71, v239
    v_mfma_f32_16x16x32_bf16 v[104:107], v[216:219], v[24:27], v[104:107]
    buffer_load_dwordx4 v[216:219], v2, s[8:11], s26 offen offset:3072 sc1
    v_mfma_f32_16x16x32_bf16 v[76:79], v[220:223], v[28:31], v[76:79]
    v_exp_f32 v242, v242
    v_cvt_pk_bf16_f32 v54, v236, v237
    v_cvt_pk_bf16_f32 v55, v238, v239
    v_mfma_f32_16x16x32_bf16 v[80:83], v[220:223], v[32:35], v[80:83]
    v_exp_f32 v243, v243
    v_mfma_f32_16x16x32_bf16 v[84:87], v[220:223], v[36:39], v[84:87]
    ds_write_b128 v8, v[52:55] offset:2048
    v_fma_f32 v240, v240, v235, v235
    v_mfma_f32_16x16x32_bf16 v[88:91], v[220:223], v[40:43], v[88:91]
    s_add_u32 s26, s26, 4096
    buffer_load_dwordx4 v[220:223], v2, s[8:11], s26 offen offset:0 sc1
    v_mfma_f32_16x16x32_bf16 v[92:95], v[224:227], v[28:31], v[92:95]
    v_fma_f32 v241, v241, v235, v235
    v_mfma_f32_16x16x32_bf16 v[96:99], v[224:227], v[32:35], v[96:99]
    v_rcp_f32 v240, v240
    v_fma_f32 v242, v242, v235, v235
    v_mfma_f32_16x16x32_bf16 v[100:103], v[224:227], v[36:39], v[100:103]
    v_rcp_f32 v241, v241
    v_mfma_f32_16x16x32_bf16 v[104:107], v[224:227], v[40:43], v[104:107]
    v_fma_f32 v243, v243, v235, v235
    v_rcp_f32 v242, v242
    v_rcp_f32 v243, v243
    v_mul_f32 v240, v72, v240
    v_mul_f32 v241, v73, v241
    v_mul_f32 v242, v74, v242
    v_mul_f32 v243, v75, v243
    v_cvt_pk_bf16_f32 v58, v240, v241
    v_cvt_pk_bf16_f32 v59, v242, v243
    ds_write_b128 v8, v[56:59] offset:3072
    buffer_load_dwordx4 v[224:227], v2, s[8:11], s26 offen offset:1024 sc1
    s_waitcnt vmcnt(16)
    v_mfma_f32_16x16x32_bf16 v[44:47], v[156:159], a[0:3], 0
    v_mfma_f32_16x16x32_bf16 v[48:51], v[156:159], a[4:7], 0
    v_mfma_f32_16x16x32_bf16 v[52:55], v[156:159], a[8:11], 0
    v_mul_f32 v236, v76, v228
    v_mul_f32 v237, v77, v228
    v_mul_f32 v238, v78, v228
    v_mul_f32 v239, v79, v228
    v_exp_f32 v236, v236
    v_mfma_f32_16x16x32_bf16 v[56:59], v[156:159], a[12:15], 0
    buffer_load_dwordx4 v[156:159], v2, s[8:11], s26 offen offset:2048 sc1
    v_mfma_f32_16x16x32_bf16 v[60:63], v[160:163], a[0:3], 0
    v_exp_f32 v237, v237
    v_exp_f32 v238, v238
    v_mfma_f32_16x16x32_bf16 v[64:67], v[160:163], a[4:7], 0
    v_exp_f32 v239, v239
    v_mfma_f32_16x16x32_bf16 v[68:71], v[160:163], a[8:11], 0
    v_fma_f32 v236, v236, v229, v229
    v_fma_f32 v237, v237, v229, v229
    v_mfma_f32_16x16x32_bf16 v[72:75], v[160:163], a[12:15], 0
    buffer_load_dwordx4 v[160:163], v2, s[8:11], s26 offen offset:3072 sc1
    v_mfma_f32_16x16x32_bf16 v[44:47], v[164:167], a[16:19], v[44:47]
    v_rcp_f32 v236, v236
    v_mul_f32 v240, v80, v230
    v_mfma_f32_16x16x32_bf16 v[48:51], v[164:167], a[20:23], v[48:51]
    v_fma_f32 v238, v238, v229, v229
    v_mfma_f32_16x16x32_bf16 v[52:55], v[164:167], a[24:27], v[52:55]
    v_rcp_f32 v237, v237
    v_mul_f32 v241, v81, v230
    v_mfma_f32_16x16x32_bf16 v[56:59], v[164:167], a[28:31], v[56:59]
    s_add_u32 s26, s26, 4096
    buffer_load_dwordx4 v[164:167], v2, s[8:11], s26 offen offset:0 sc1
    v_mfma_f32_16x16x32_bf16 v[60:63], v[168:171], a[16:19], v[60:63]
    v_fma_f32 v239, v239, v229, v229
    v_mfma_f32_16x16x32_bf16 v[64:67], v[168:171], a[20:23], v[64:67]
    v_rcp_f32 v238, v238
    v_mul_f32 v242, v82, v230
    v_mfma_f32_16x16x32_bf16 v[68:71], v[168:171], a[24:27], v[68:71]
    v_rcp_f32 v239, v239
    v_mfma_f32_16x16x32_bf16 v[72:75], v[168:171], a[28:31], v[72:75]
    v_mul_f32 v243, v83, v230
    buffer_load_dwordx4 v[168:171], v2, s[8:11], s26 offen offset:1024 sc1
    s_waitcnt vmcnt(15)
    v_mfma_f32_16x16x32_bf16 v[44:47], v[172:175], a[32:35], v[44:47]
    v_exp_f32 v240, v240
    v_mfma_f32_16x16x32_bf16 v[48:51], v[172:175], a[36:39], v[48:51]
    v_mul_f32 v236, v76, v236
    v_mfma_f32_16x16x32_bf16 v[52:55], v[172:175], a[40:43], v[52:55]
    v_mul_f32 v237, v77, v237
    v_exp_f32 v241, v241
    v_mfma_f32_16x16x32_bf16 v[56:59], v[172:175], a[44:47], v[56:59]
    buffer_load_dwordx4 v[172:175], v2, s[8:11], s26 offen offset:2048 sc1
    v_mfma_f32_16x16x32_bf16 v[60:63], v[176:179], a[32:35], v[60:63]
    v_mul_f32 v238, v78, v238
    v_mul_f32 v239, v79, v239
    v_mfma_f32_16x16x32_bf16 v[64:67], v[176:179], a[36:39], v[64:67]
    v_exp_f32 v242, v242
    v_cvt_pk_bf16_f32 v76, v236, v237
    v_mfma_f32_16x16x32_bf16 v[68:71], v[176:179], a[40:43], v[68:71]
    v_exp_f32 v243, v243
    v_mfma_f32_16x16x32_bf16 v[72:75], v[176:179], a[44:47], v[72:75]
    buffer_load_dwordx4 v[176:179], v2, s[8:11], s26 offen offset:3072 sc1
    v_mfma_f32_16x16x32_bf16 v[44:47], v[180:183], a[48:51], v[44:47]
    v_cvt_pk_bf16_f32 v77, v238, v239
    v_fma_f32 v240, v240, v231, v231
    v_fma_f32 v241, v241, v231, v231
    v_mfma_f32_16x16x32_bf16 v[48:51], v[180:183], a[52:55], v[48:51]
    s_add_u32 m0, s97, 4096
    s_mov_b32 s98, 268288
    buffer_load_dwordx4 v2, s[8:11], s98 offen sc1 lds
    v_mfma_f32_16x16x32_bf16 v[52:55], v[180:183], a[56:59], v[52:55]
    v_mfma_f32_16x16x32_bf16 v[56:59], v[180:183], a[60:63], v[56:59]
    v_rcp_f32 v240, v240
    s_add_u32 s26, s26, 4096
    buffer_load_dwordx4 v[180:183], v2, s[8:11], s26 offen offset:0 sc1
    v_mfma_f32_16x16x32_bf16 v[60:63], v[184:187], a[48:51], v[60:63]
    v_mul_f32 v236, v84, v232
    v_mfma_f32_16x16x32_bf16 v[64:67], v[184:187], a[52:55], v[64:67]
    v_fma_f32 v242, v242, v231, v231
    v_rcp_f32 v241, v241
    v_mfma_f32_16x16x32_bf16 v[68:71], v[184:187], a[56:59], v[68:71]
    v_mul_f32 v237, v85, v232
    v_mfma_f32_16x16x32_bf16 v[72:75], v[184:187], a[60:63], v[72:75]
    v_fma_f32 v243, v243, v231, v231
    buffer_load_dwordx4 v[184:187], v2, s[8:11], s26 offen offset:1024 sc1
    s_waitcnt vmcnt(16)
    v_mfma_f32_16x16x32_bf16 v[44:47], v[188:191], a[64:67], v[44:47]
    v_rcp_f32 v242, v242
    v_mfma_f32_16x16x32_bf16 v[48:51], v[188:191], a[68:71], v[48:51]
    v_mul_f32 v238, v86, v232
    v_mfma_f32_16x16x32_bf16 v[52:55], v[188:191], a[72:75], v[52:55]
    v_rcp_f32 v243, v243
    v_mfma_f32_16x16x32_bf16 v[56:59], v[188:191], a[76:79], v[56:59]
    v_mul_f32 v239, v87, v232
    buffer_load_dwordx4 v[188:191], v2, s[8:11], s26 offen offset:2048 sc1
    v_mfma_f32_16x16x32_bf16 v[60:63], v[192:195], a[64:67], v[60:63]
    v_exp_f32 v236, v236
    v_mul_f32 v240, v80, v240
    v_mfma_f32_16x16x32_bf16 v[64:67], v[192:195], a[68:71], v[64:67]
    v_mul_f32 v241, v81, v241
    v_mfma_f32_16x16x32_bf16 v[68:71], v[192:195], a[72:75], v[68:71]
    v_exp_f32 v237, v237
    v_mul_f32 v242, v82, v242
    v_mfma_f32_16x16x32_bf16 v[72:75], v[192:195], a[76:79], v[72:75]
    buffer_load_dwordx4 v[192:195], v2, s[8:11], s26 offen offset:3072 sc1
    v_mfma_f32_16x16x32_bf16 v[44:47], v[196:199], a[80:83], v[44:47]
    v_mul_f32 v243, v83, v243
    v_exp_f32 v238, v238
    v_mfma_f32_16x16x32_bf16 v[48:51], v[196:199], a[84:87], v[48:51]
    v_cvt_pk_bf16_f32 v80, v240, v241
    v_mfma_f32_16x16x32_bf16 v[52:55], v[196:199], a[88:91], v[52:55]
    v_exp_f32 v239, v239
    v_cvt_pk_bf16_f32 v81, v242, v243
    v_mfma_f32_16x16x32_bf16 v[56:59], v[196:199], a[92:95], v[56:59]
    v_fma_f32 v236, v236, v233, v233
    s_add_u32 s26, s26, 4096
    buffer_load_dwordx4 v[196:199], v2, s[8:11], s26 offen offset:0 sc1
    v_mfma_f32_16x16x32_bf16 v[60:63], v[200:203], a[80:83], v[60:63]
    v_fma_f32 v237, v237, v233, v233
    v_mfma_f32_16x16x32_bf16 v[64:67], v[200:203], a[84:87], v[64:67]
    v_rcp_f32 v236, v236
    v_mfma_f32_16x16x32_bf16 v[68:71], v[200:203], a[88:91], v[68:71]
    v_mul_f32 v240, v88, v234
    v_fma_f32 v238, v238, v233, v233
    v_mfma_f32_16x16x32_bf16 v[72:75], v[200:203], a[92:95], v[72:75]
    buffer_load_dwordx4 v[200:203], v2, s[8:11], s26 offen offset:1024 sc1
    s_waitcnt vmcnt(15)
    v_mfma_f32_16x16x32_bf16 v[44:47], v[204:207], a[96:99], v[44:47]
    v_rcp_f32 v237, v237
    v_mfma_f32_16x16x32_bf16 v[48:51], v[204:207], a[100:103], v[48:51]
    v_mul_f32 v241, v89, v234
    v_fma_f32 v239, v239, v233, v233
    v_mfma_f32_16x16x32_bf16 v[52:55], v[204:207], a[104:107], v[52:55]
    v_rcp_f32 v238, v238
    v_mul_f32 v242, v90, v234
    v_mfma_f32_16x16x32_bf16 v[56:59], v[204:207], a[108:111], v[56:59]
    buffer_load_dwordx4 v[204:207], v2, s[8:11], s26 offen offset:2048 sc1
    v_mfma_f32_16x16x32_bf16 v[60:63], v[208:211], a[96:99], v[60:63]
    v_rcp_f32 v239, v239
    v_mul_f32 v243, v91, v234
    v_mfma_f32_16x16x32_bf16 v[64:67], v[208:211], a[100:103], v[64:67]
    v_exp_f32 v240, v240
    v_mfma_f32_16x16x32_bf16 v[68:71], v[208:211], a[104:107], v[68:71]
    v_mul_f32 v236, v84, v236
    v_mul_f32 v237, v85, v237
    v_mfma_f32_16x16x32_bf16 v[72:75], v[208:211], a[108:111], v[72:75]
    buffer_load_dwordx4 v[208:211], v2, s[8:11], s26 offen offset:3072 sc1
    v_mfma_f32_16x16x32_bf16 v[44:47], v[212:215], a[112:115], v[44:47]
    v_exp_f32 v241, v241
    v_mul_f32 v238, v86, v238
    v_mfma_f32_16x16x32_bf16 v[48:51], v[212:215], a[116:119], v[48:51]
    v_mul_f32 v239, v87, v239
    v_exp_f32 v242, v242
    v_mfma_f32_16x16x32_bf16 v[52:55], v[212:215], a[120:123], v[52:55]
    v_cvt_pk_bf16_f32 v84, v236, v237
    v_mfma_f32_16x16x32_bf16 v[56:59], v[212:215], a[124:127], v[56:59]
    s_add_u32 s26, s26, 4096
    buffer_load_dwordx4 v[212:215], v2, s[8:11], s26 offen offset:0 sc1
    v_mfma_f32_16x16x32_bf16 v[60:63], v[216:219], a[112:115], v[60:63]
    v_exp_f32 v243, v243
    v_mfma_f32_16x16x32_bf16 v[64:67], v[216:219], a[116:119], v[64:67]
    v_cvt_pk_bf16_f32 v85, v238, v239
    v_fma_f32 v240, v240, v235, v235
    v_mfma_f32_16x16x32_bf16 v[68:71], v[216:219], a[120:123], v[68:71]
    v_fma_f32 v241, v241, v235, v235
    v_rcp_f32 v240, v240
    v_mfma_f32_16x16x32_bf16 v[72:75], v[216:219], a[124:127], v[72:75]
    buffer_load_dwordx4 v[216:219], v2, s[8:11], s26 offen offset:1024 sc1
    s_waitcnt vmcnt(15)
    v_mfma_f32_16x16x32_bf16 v[44:47], v[220:223], a[128:131], v[44:47]
    v_mul_f32 v236, v92, v228
    v_fma_f32 v242, v242, v235, v235
    v_mfma_f32_16x16x32_bf16 v[48:51], v[220:223], a[132:135], v[48:51]
    s_add_u32 m0, s97, 5120
    s_mov_b32 s98, 270336
    buffer_load_dwordx4 v2, s[8:11], s98 offen sc1 lds
    v_mfma_f32_16x16x32_bf16 v[52:55], v[220:223], a[136:139], v[52:55]
    v_mfma_f32_16x16x32_bf16 v[56:59], v[220:223], a[140:143], v[56:59]
    v_rcp_f32 v241, v241
    buffer_load_dwordx4 v[220:223], v2, s[8:11], s26 offen offset:2048 sc1
    v_mfma_f32_16x16x32_bf16 v[60:63], v[224:227], a[128:131], v[60:63]
    v_mul_f32 v237, v93, v228
    v_fma_f32 v243, v243, v235, v235
    v_mfma_f32_16x16x32_bf16 v[64:67], v[224:227], a[132:135], v[64:67]
    v_rcp_f32 v242, v242
    v_mfma_f32_16x16x32_bf16 v[68:71], v[224:227], a[136:139], v[68:71]
    v_mul_f32 v238, v94, v228
    v_mfma_f32_16x16x32_bf16 v[72:75], v[224:227], a[140:143], v[72:75]
    v_rcp_f32 v243, v243
    buffer_load_dwordx4 v[224:227], v2, s[8:11], s26 offen offset:3072 sc1
    v_mfma_f32_16x16x32_bf16 v[44:47], v[156:159], a[144:147], v[44:47]
    v_mul_f32 v239, v95, v228
    v_exp_f32 v236, v236
    v_mfma_f32_16x16x32_bf16 v[48:51], v[156:159], a[148:151], v[48:51]
    v_mul_f32 v240, v88, v240
    v_mfma_f32_16x16x32_bf16 v[52:55], v[156:159], a[152:155], v[52:55]
    v_mul_f32 v241, v89, v241
    v_exp_f32 v237, v237
    v_mfma_f32_16x16x32_bf16 v[56:59], v[156:159], a[156:159], v[56:59]
    s_add_u32 s26, s26, 4096
    buffer_load_dwordx4 v[156:159], v2, s[8:11], s26 offen offset:0 sc1
    v_mfma_f32_16x16x32_bf16 v[60:63], v[160:163], a[144:147], v[60:63]
    v_mul_f32 v242, v90, v242
    v_mfma_f32_16x16x32_bf16 v[64:67], v[160:163], a[148:151], v[64:67]
    v_mul_f32 v243, v91, v243
    v_exp_f32 v238, v238
    v_mfma_f32_16x16x32_bf16 v[68:71], v[160:163], a[152:155], v[68:71]
    v_cvt_pk_bf16_f32 v88, v240, v241
    v_mfma_f32_16x16x32_bf16 v[72:75], v[160:163], a[156:159], v[72:75]
    v_exp_f32 v239, v239
    buffer_load_dwordx4 v[160:163], v2, s[8:11], s26 offen offset:1024 sc1
    s_waitcnt vmcnt(16)
    v_mfma_f32_16x16x32_bf16 v[44:47], v[164:167], a[160:163], v[44:47]
    v_cvt_pk_bf16_f32 v89, v242, v243
    v_mfma_f32_16x16x32_bf16 v[48:51], v[164:167], a[164:167], v[48:51]
    v_fma_f32 v236, v236, v229, v229
    v_fma_f32 v237, v237, v229, v229
    v_mfma_f32_16x16x32_bf16 v[52:55], v[164:167], a[168:171], v[52:55]
    v_rcp_f32 v236, v236
    v_mfma_f32_16x16x32_bf16 v[56:59], v[164:167], a[172:175], v[56:59]
    buffer_load_dwordx4 v[164:167], v2, s[8:11], s26 offen offset:2048 sc1
    v_mfma_f32_16x16x32_bf16 v[60:63], v[168:171], a[160:163], v[60:63]
    v_mul_f32 v240, v96, v230
    v_fma_f32 v238, v238, v229, v229
    v_mfma_f32_16x16x32_bf16 v[64:67], v[168:171], a[164:167], v[64:67]
    v_rcp_f32 v237, v237
    v_mul_f32 v241, v97, v230
    v_mfma_f32_16x16x32_bf16 v[68:71], v[168:171], a[168:171], v[68:71]
    v_fma_f32 v239, v239, v229, v229
    v_rcp_f32 v238, v238
    v_mfma_f32_16x16x32_bf16 v[72:75], v[168:171], a[172:175], v[72:75]
    buffer_load_dwordx4 v[168:171], v2, s[8:11], s26 offen offset:3072 sc1
    v_mfma_f32_16x16x32_bf16 v[44:47], v[172:175], a[176:179], v[44:47]
    v_mul_f32 v242, v98, v230
    v_rcp_f32 v239, v239
    v_mfma_f32_16x16x32_bf16 v[48:51], v[172:175], a[180:183], v[48:51]
    v_mul_f32 v243, v99, v230
    v_mfma_f32_16x16x32_bf16 v[52:55], v[172:175], a[184:187], v[52:55]
    v_exp_f32 v240, v240
    v_mfma_f32_16x16x32_bf16 v[56:59], v[172:175], a[188:191], v[56:59]
    v_mul_f32 v236, v92, v236
    s_add_u32 s26, s26, 4096
    buffer_load_dwordx4 v[172:175], v2, s[8:11], s26 offen offset:0 sc1
    v_mfma_f32_16x16x32_bf16 v[60:63], v[176:179], a[176:179], v[60:63]
    v_mul_f32 v237, v93, v237
    v_mfma_f32_16x16x32_bf16 v[64:67], v[176:179], a[180:183], v[64:67]
    v_exp_f32 v241, v241
    v_mul_f32 v238, v94, v238
    v_mfma_f32_16x16x32_bf16 v[68:71], v[176:179], a[184:187], v[68:71]
    v_mul_f32 v239, v95, v239
    v_mfma_f32_16x16x32_bf16 v[72:75], v[176:179], a[188:191], v[72:75]
    v_exp_f32 v242, v242
    buffer_load_dwordx4 v[176:179], v2, s[8:11], s26 offen offset:1024 sc1
    s_waitcnt vmcnt(15)
    v_mfma_f32_16x16x32_bf16 v[44:47], v[180:183], a[192:195], v[44:47]
    v_cvt_pk_bf16_f32 v78, v236, v237
    v_mfma_f32_16x16x32_bf16 v[48:51], v[180:183], a[196:199], v[48:51]
    v_cvt_pk_bf16_f32 v79, v238, v239
    v_mfma_f32_16x16x32_bf16 v[52:55], v[180:183], a[200:203], v[52:55]
    v_exp_f32 v243, v243
    ds_write_b128 v8, v[76:79] offset:16384
    v_mfma_f32_16x16x32_bf16 v[56:59], v[180:183], a[204:207], v[56:59]
    buffer_load_dwordx4 v[180:183], v2, s[8:11], s26 offen offset:2048 sc1
    v_mfma_f32_16x16x32_bf16 v[60:63], v[184:187], a[192:195], v[60:63]
    v_fma_f32 v240, v240, v231, v231
    v_fma_f32 v241, v241, v231, v231
    v_rcp_f32 v240, v240
    v_mfma_f32_16x16x32_bf16 v[64:67], v[184:187], a[196:199], v[64:67]
    v_mul_f32 v236, v100, v232
    v_mfma_f32_16x16x32_bf16 v[68:71], v[184:187], a[200:203], v[68:71]
    v_fma_f32 v242, v242, v231, v231
    v_rcp_f32 v241, v241
    v_mfma_f32_16x16x32_bf16 v[72:75], v[184:187], a[204:207], v[72:75]
    buffer_load_dwordx4 v[184:187], v2, s[8:11], s26 offen offset:3072 sc1
    v_mfma_f32_16x16x32_bf16 v[44:47], v[188:191], a[208:211], v[44:47]
    v_mul_f32 v237, v101, v232
    v_fma_f32 v243, v243, v231, v231
    v_mfma_f32_16x16x32_bf16 v[48:51], v[188:191], a[212:215], v[48:51]
    s_add_u32 m0, s97, 6144
    s_mov_b32 s98, 272384
    buffer_load_dwordx4 v2, s[8:11], s98 offen sc1 lds
    v_mfma_f32_16x16x32_bf16 v[52:55], v[188:191], a[216:219], v[52:55]
    v_rcp_f32 v242, v242
    v_mfma_f32_16x16x32_bf16 v[56:59], v[188:191], a[220:223], v[56:59]
    s_add_u32 s26, s26, 4096
    buffer_load_dwordx4 v[188:191], v2, s[8:11], s26 offen offset:0 sc1
    v_mfma_f32_16x16x32_bf16 v[60:63], v[192:195], a[208:211], v[60:63]
    v_mul_f32 v238, v102, v232
    v_mfma_f32_16x16x32_bf16 v[64:67], v[192:195], a[212:215], v[64:67]
    v_rcp_f32 v243, v243
    v_mul_f32 v239, v103, v232
    v_mfma_f32_16x16x32_bf16 v[68:71], v[192:195], a[216:219], v[68:71]
    v_exp_f32 v236, v236
    v_mfma_f32_16x16x32_bf16 v[72:75], v[192:195], a[220:223], v[72:75]
    buffer_load_dwordx4 v[192:195], v2, s[8:11], s26 offen offset:1024 sc1
    s_waitcnt vmcnt(16)
    v_mfma_f32_16x16x32_bf16 v[44:47], v[196:199], a[224:227], v[44:47]
    v_mul_f32 v240, v96, v240
    v_mul_f32 v241, v97, v241
    v_mfma_f32_16x16x32_bf16 v[48:51], v[196:199], a[228:231], v[48:51]
    v_exp_f32 v237, v237
    v_mfma_f32_16x16x32_bf16 v[52:55], v[196:199], a[232:235], v[52:55]
    v_mul_f32 v242, v98, v242
    v_mul_f32 v243, v99, v243
    v_mfma_f32_16x16x32_bf16 v[56:59], v[196:199], a[236:239], v[56:59]
    buffer_load_dwordx4 v[196:199], v2, s[8:11], s26 offen offset:2048 sc1
    v_mfma_f32_16x16x32_bf16 v[60:63], v[200:203], a[224:227], v[60:63]
    v_exp_f32 v238, v238
    v_cvt_pk_bf16_f32 v82, v240, v241
    v_mfma_f32_16x16x32_bf16 v[64:67], v[200:203], a[228:231], v[64:67]
    v_cvt_pk_bf16_f32 v83, v242, v243
    v_exp_f32 v239, v239
    v_mfma_f32_16x16x32_bf16 v[68:71], v[200:203], a[232:235], v[68:71]
    ds_write_b128 v8, v[80:83] offset:17408
    v_mfma_f32_16x16x32_bf16 v[72:75], v[200:203], a[236:239], v[72:75]
    v_fma_f32 v236, v236, v233, v233
    buffer_load_dwordx4 v[200:203], v2, s[8:11], s26 offen offset:3072 sc1
    v_mfma_f32_16x16x32_bf16 v[44:47], v[204:207], a[240:243], v[44:47]
    v_fma_f32 v237, v237, v233, v233
    v_rcp_f32 v236, v236
    v_mfma_f32_16x16x32_bf16 v[48:51], v[204:207], a[244:247], v[48:51]
    v_mul_f32 v240, v104, v234
    v_fma_f32 v238, v238, v233, v233
    v_mfma_f32_16x16x32_bf16 v[52:55], v[204:207], a[248:251], v[52:55]
    v_rcp_f32 v237, v237
    v_mfma_f32_16x16x32_bf16 v[56:59], v[204:207], a[252:255], v[56:59]
    s_add_u32 s26, s26, 4096
    buffer_load_dwordx4 v[204:207], v2, s[8:11], s26 offen offset:0 sc1
    v_mfma_f32_16x16x32_bf16 v[60:63], v[208:211], a[240:243], v[60:63]
    v_mul_f32 v241, v105, v234
    v_fma_f32 v239, v239, v233, v233
    v_mfma_f32_16x16x32_bf16 v[64:67], v[208:211], a[244:247], v[64:67]
    v_rcp_f32 v238, v238
    v_mfma_f32_16x16x32_bf16 v[68:71], v[208:211], a[248:251], v[68:71]
    v_mul_f32 v242, v106, v234
    v_mfma_f32_16x16x32_bf16 v[72:75], v[208:211], a[252:255], v[72:75]
    v_rcp_f32 v239, v239
    buffer_load_dwordx4 v[208:211], v2, s[8:11], s26 offen offset:1024 sc1
    s_waitcnt vmcnt(15)
    v_mfma_f32_16x16x32_bf16 v[44:47], v[212:215], v[12:15], v[44:47]
    v_mul_f32 v243, v107, v234
    v_mfma_f32_16x16x32_bf16 v[48:51], v[212:215], v[16:19], v[48:51]
    v_exp_f32 v240, v240
    v_mfma_f32_16x16x32_bf16 v[52:55], v[212:215], v[20:23], v[52:55]
    v_mul_f32 v236, v100, v236
    v_mul_f32 v237, v101, v237
    v_mfma_f32_16x16x32_bf16 v[56:59], v[212:215], v[24:27], v[56:59]
    buffer_load_dwordx4 v[212:215], v2, s[8:11], s26 offen offset:2048 sc1
    v_mfma_f32_16x16x32_bf16 v[60:63], v[216:219], v[12:15], v[60:63]
    v_exp_f32 v241, v241
    v_mul_f32 v238, v102, v238
    v_mfma_f32_16x16x32_bf16 v[64:67], v[216:219], v[16:19], v[64:67]
    v_mul_f32 v239, v103, v239
    v_exp_f32 v242, v242
    v_mfma_f32_16x16x32_bf16 v[68:71], v[216:219], v[20:23], v[68:71]
    v_cvt_pk_bf16_f32 v86, v236, v237
    v_mfma_f32_16x16x32_bf16 v[72:75], v[216:219], v[24:27], v[72:75]
    v_cvt_pk_bf16_f32 v87, v238, v239
    buffer_load_dwordx4 v[216:219], v2, s[8:11], s26 offen offset:3072 sc1
    v_mfma_f32_16x16x32_bf16 v[44:47], v[220:223], v[28:31], v[44:47]
    v_exp_f32 v243, v243
    ds_write_b128 v8, v[84:87] offset:18432
    v_mfma_f32_16x16x32_bf16 v[48:51], v[220:223], v[32:35], v[48:51]
    v_fma_f32 v240, v240, v235, v235
    v_fma_f32 v241, v241, v235, v235
    v_mfma_f32_16x16x32_bf16 v[52:55], v[220:223], v[36:39], v[52:55]
    v_rcp_f32 v240, v240
    v_mfma_f32_16x16x32_bf16 v[56:59], v[220:223], v[40:43], v[56:59]
    s_add_u32 s26, s26, 4096
    buffer_load_dwordx4 v[220:223], v2, s[8:11], s26 offen offset:0 sc1
    v_mfma_f32_16x16x32_bf16 v[60:63], v[224:227], v[28:31], v[60:63]
    v_fma_f32 v242, v242, v235, v235
    v_mfma_f32_16x16x32_bf16 v[64:67], v[224:227], v[32:35], v[64:67]
    s_add_u32 m0, s97, 7168
    s_mov_b32 s98, 274432
    buffer_load_dwordx4 v2, s[8:11], s98 offen sc1 lds
    v_mfma_f32_16x16x32_bf16 v[68:71], v[224:227], v[36:39], v[68:71]
    v_rcp_f32 v241, v241
    v_mfma_f32_16x16x32_bf16 v[72:75], v[224:227], v[40:43], v[72:75]
    v_fma_f32 v243, v243, v235, v235
    v_rcp_f32 v242, v242
    v_rcp_f32 v243, v243
    v_mul_f32 v240, v104, v240
    v_mul_f32 v241, v105, v241
    v_mul_f32 v242, v106, v242
    v_mul_f32 v243, v107, v243
    v_cvt_pk_bf16_f32 v90, v240, v241
    v_cvt_pk_bf16_f32 v91, v242, v243
    ds_write_b128 v8, v[88:91] offset:19456
    buffer_load_dwordx4 v[224:227], v2, s[8:11], s26 offen offset:1024 sc1
    s_waitcnt vmcnt(16)
    v_mfma_f32_16x16x32_bf16 v[76:79], v[156:159], a[0:3], 0
    v_mfma_f32_16x16x32_bf16 v[80:83], v[156:159], a[4:7], 0
    v_mfma_f32_16x16x32_bf16 v[84:87], v[156:159], a[8:11], 0
    v_mul_f32 v236, v44, v228
    v_mul_f32 v237, v45, v228
    v_mul_f32 v238, v46, v228
    v_mul_f32 v239, v47, v228
    v_exp_f32 v236, v236
    v_mfma_f32_16x16x32_bf16 v[88:91], v[156:159], a[12:15], 0
    buffer_load_dwordx4 v[156:159], v2, s[8:11], s26 offen offset:2048 sc1
    v_mfma_f32_16x16x32_bf16 v[92:95], v[160:163], a[0:3], 0
    v_exp_f32 v237, v237
    v_exp_f32 v238, v238
    v_mfma_f32_16x16x32_bf16 v[96:99], v[160:163], a[4:7], 0
    v_exp_f32 v239, v239
    v_mfma_f32_16x16x32_bf16 v[100:103], v[160:163], a[8:11], 0
    v_fma_f32 v236, v236, v229, v229
    v_fma_f32 v237, v237, v229, v229
    v_mfma_f32_16x16x32_bf16 v[104:107], v[160:163], a[12:15], 0
    buffer_load_dwordx4 v[160:163], v2, s[8:11], s26 offen offset:3072 sc1
    v_mfma_f32_16x16x32_bf16 v[76:79], v[164:167], a[16:19], v[76:79]
    v_rcp_f32 v236, v236
    v_mul_f32 v240, v48, v230
    v_mfma_f32_16x16x32_bf16 v[80:83], v[164:167], a[20:23], v[80:83]
    v_fma_f32 v238, v238, v229, v229
    v_mfma_f32_16x16x32_bf16 v[84:87], v[164:167], a[24:27], v[84:87]
    v_rcp_f32 v237, v237
    v_mul_f32 v241, v49, v230
    v_mfma_f32_16x16x32_bf16 v[88:91], v[164:167], a[28:31], v[88:91]
    s_add_u32 s26, s26, 4096
    buffer_load_dwordx4 v[164:167], v2, s[8:11], s26 offen offset:0 sc1
    v_mfma_f32_16x16x32_bf16 v[92:95], v[168:171], a[16:19], v[92:95]
    v_fma_f32 v239, v239, v229, v229
    v_mfma_f32_16x16x32_bf16 v[96:99], v[168:171], a[20:23], v[96:99]
    v_rcp_f32 v238, v238
    v_mul_f32 v242, v50, v230
    v_mfma_f32_16x16x32_bf16 v[100:103], v[168:171], a[24:27], v[100:103]
    v_rcp_f32 v239, v239
    v_mfma_f32_16x16x32_bf16 v[104:107], v[168:171], a[28:31], v[104:107]
    v_mul_f32 v243, v51, v230
    buffer_load_dwordx4 v[168:171], v2, s[8:11], s26 offen offset:1024 sc1
    s_waitcnt vmcnt(16)
    v_mfma_f32_16x16x32_bf16 v[76:79], v[172:175], a[32:35], v[76:79]
    v_exp_f32 v240, v240
    v_mfma_f32_16x16x32_bf16 v[80:83], v[172:175], a[36:39], v[80:83]
    v_mul_f32 v236, v44, v236
    v_mfma_f32_16x16x32_bf16 v[84:87], v[172:175], a[40:43], v[84:87]
    v_mul_f32 v237, v45, v237
    v_exp_f32 v241, v241
    v_mfma_f32_16x16x32_bf16 v[88:91], v[172:175], a[44:47], v[88:91]
    buffer_load_dwordx4 v[172:175], v2, s[8:11], s26 offen offset:2048 sc1
    v_mfma_f32_16x16x32_bf16 v[92:95], v[176:179], a[32:35], v[92:95]
    v_mul_f32 v238, v46, v238
    v_mul_f32 v239, v47, v239
    v_mfma_f32_16x16x32_bf16 v[96:99], v[176:179], a[36:39], v[96:99]
    v_exp_f32 v242, v242
    v_cvt_pk_bf16_f32 v44, v236, v237
    v_mfma_f32_16x16x32_bf16 v[100:103], v[176:179], a[40:43], v[100:103]
    v_exp_f32 v243, v243
    v_mfma_f32_16x16x32_bf16 v[104:107], v[176:179], a[44:47], v[104:107]
    buffer_load_dwordx4 v[176:179], v2, s[8:11], s26 offen offset:3072 sc1
    v_mfma_f32_16x16x32_bf16 v[76:79], v[180:183], a[48:51], v[76:79]
    v_cvt_pk_bf16_f32 v45, v238, v239
    v_fma_f32 v240, v240, v231, v231
    v_fma_f32 v241, v241, v231, v231
    v_mfma_f32_16x16x32_bf16 v[80:83], v[180:183], a[52:55], v[80:83]
    v_rcp_f32 v240, v240
    v_mfma_f32_16x16x32_bf16 v[84:87], v[180:183], a[56:59], v[84:87]
    v_mul_f32 v236, v52, v232
    v_fma_f32 v242, v242, v231, v231
    v_mfma_f32_16x16x32_bf16 v[88:91], v[180:183], a[60:63], v[88:91]
    s_add_u32 s26, s26, 4096
    buffer_load_dwordx4 v[180:183], v2, s[8:11], s26 offen offset:0 sc1
    v_mfma_f32_16x16x32_bf16 v[92:95], v[184:187], a[48:51], v[92:95]
    v_rcp_f32 v241, v241
    v_mfma_f32_16x16x32_bf16 v[96:99], v[184:187], a[52:55], v[96:99]
    v_mul_f32 v237, v53, v232
    v_fma_f32 v243, v243, v231, v231
    v_mfma_f32_16x16x32_bf16 v[100:103], v[184:187], a[56:59], v[100:103]
    v_rcp_f32 v242, v242
    v_mfma_f32_16x16x32_bf16 v[104:107], v[184:187], a[60:63], v[104:107]
    v_mul_f32 v238, v54, v232
    buffer_load_dwordx4 v[184:187], v2, s[8:11], s26 offen offset:1024 sc1
    s_waitcnt vmcnt(15)
    v_mfma_f32_16x16x32_bf16 v[76:79], v[188:191], a[64:67], v[76:79]
    v_rcp_f32 v243, v243
    v_mfma_f32_16x16x32_bf16 v[80:83], v[188:191], a[68:71], v[80:83]
    v_mul_f32 v239, v55, v232
    v_mfma_f32_16x16x32_bf16 v[84:87], v[188:191], a[72:75], v[84:87]
    v_exp_f32 v236, v236
    v_mfma_f32_16x16x32_bf16 v[88:91], v[188:191], a[76:79], v[88:91]
    v_mul_f32 v240, v48, v240
    buffer_load_dwordx4 v[188:191], v2, s[8:11], s26 offen offset:2048 sc1
    v_mfma_f32_16x16x32_bf16 v[92:95], v[192:195], a[64:67], v[92:95]
    v_mul_f32 v241, v49, v241
    v_exp_f32 v237, v237
    v_mfma_f32_16x16x32_bf16 v[96:99], v[192:195], a[68:71], v[96:99]
    s_add_u32 m0, s97, 8192
    s_mov_b32 s98, 276480
    buffer_load_dwordx4 v2, s[8:11], s98 offen sc1 lds
    v_mfma_f32_16x16x32_bf16 v[100:103], v[192:195], a[72:75], v[100:103]
    v_mul_f32 v242, v50, v242
    v_mfma_f32_16x16x32_bf16 v[104:107], v[192:195], a[76:79], v[104:107]
    buffer_load_dwordx4 v[192:195], v2, s[8:11], s26 offen offset:3072 sc1
    v_mfma_f32_16x16x32_bf16 v[76:79], v[196:199], a[80:83], v[76:79]
    v_mul_f32 v243, v51, v243
    v_exp_f32 v238, v238
    v_mfma_f32_16x16x32_bf16 v[80:83], v[196:199], a[84:87], v[80:83]
    v_cvt_pk_bf16_f32 v48, v240, v241
    v_mfma_f32_16x16x32_bf16 v[84:87], v[196:199], a[88:91], v[84:87]
    v_exp_f32 v239, v239
    v_cvt_pk_bf16_f32 v49, v242, v243
    v_mfma_f32_16x16x32_bf16 v[88:91], v[196:199], a[92:95], v[88:91]
    v_fma_f32 v236, v236, v233, v233
    s_add_u32 s26, s26, 4096
    buffer_load_dwordx4 v[196:199], v2, s[8:11], s26 offen offset:0 sc1
    v_mfma_f32_16x16x32_bf16 v[92:95], v[200:203], a[80:83], v[92:95]
    v_fma_f32 v237, v237, v233, v233
    v_mfma_f32_16x16x32_bf16 v[96:99], v[200:203], a[84:87], v[96:99]
    v_rcp_f32 v236, v236
    v_mfma_f32_16x16x32_bf16 v[100:103], v[200:203], a[88:91], v[100:103]
    v_mul_f32 v240, v56, v234
    v_fma_f32 v238, v238, v233, v233
    v_mfma_f32_16x16x32_bf16 v[104:107], v[200:203], a[92:95], v[104:107]
    buffer_load_dwordx4 v[200:203], v2, s[8:11], s26 offen offset:1024 sc1
    s_waitcnt vmcnt(16)
    v_mfma_f32_16x16x32_bf16 v[76:79], v[204:207], a[96:99], v[76:79]
    v_rcp_f32 v237, v237
    v_mfma_f32_16x16x32_bf16 v[80:83], v[204:207], a[100:103], v[80:83]
    v_mul_f32 v241, v57, v234
    v_fma_f32 v239, v239, v233, v233
    v_mfma_f32_16x16x32_bf16 v[84:87], v[204:207], a[104:107], v[84:87]
    v_rcp_f32 v238, v238
    v_mul_f32 v242, v58, v234
    v_mfma_f32_16x16x32_bf16 v[88:91], v[204:207], a[108:111], v[88:91]
    buffer_load_dwordx4 v[204:207], v2, s[8:11], s26 offen offset:2048 sc1
    v_mfma_f32_16x16x32_bf16 v[92:95], v[208:211], a[96:99], v[92:95]
    v_rcp_f32 v239, v239
    v_mul_f32 v243, v59, v234
    v_mfma_f32_16x16x32_bf16 v[96:99], v[208:211], a[100:103], v[96:99]
    v_exp_f32 v240, v240
    v_mfma_f32_16x16x32_bf16 v[100:103], v[208:211], a[104:107], v[100:103]
    v_mul_f32 v236, v52, v236
    v_mul_f32 v237, v53, v237
    v_mfma_f32_16x16x32_bf16 v[104:107], v[208:211], a[108:111], v[104:107]
    buffer_load_dwordx4 v[208:211], v2, s[8:11], s26 offen offset:3072 sc1
    v_mfma_f32_16x16x32_bf16 v[76:79], v[212:215], a[112:115], v[76:79]
    v_exp_f32 v241, v241
    v_mul_f32 v238, v54, v238
    v_mfma_f32_16x16x32_bf16 v[80:83], v[212:215], a[116:119], v[80:83]
    v_mul_f32 v239, v55, v239
    v_exp_f32 v242, v242
    v_mfma_f32_16x16x32_bf16 v[84:87], v[212:215], a[120:123], v[84:87]
    v_cvt_pk_bf16_f32 v52, v236, v237
    v_mfma_f32_16x16x32_bf16 v[88:91], v[212:215], a[124:127], v[88:91]
    s_add_u32 s26, s26, 4096
    buffer_load_dwordx4 v[212:215], v2, s[8:11], s26 offen offset:0 sc1
    v_mfma_f32_16x16x32_bf16 v[92:95], v[216:219], a[112:115], v[92:95]
    v_exp_f32 v243, v243
    v_mfma_f32_16x16x32_bf16 v[96:99], v[216:219], a[116:119], v[96:99]
    v_cvt_pk_bf16_f32 v53, v238, v239
    v_fma_f32 v240, v240, v235, v235
    v_mfma_f32_16x16x32_bf16 v[100:103], v[216:219], a[120:123], v[100:103]
    v_fma_f32 v241, v241, v235, v235
    v_rcp_f32 v240, v240
    v_mfma_f32_16x16x32_bf16 v[104:107], v[216:219], a[124:127], v[104:107]
    buffer_load_dwordx4 v[216:219], v2, s[8:11], s26 offen offset:1024 sc1
    s_waitcnt vmcnt(15)
    v_mfma_f32_16x16x32_bf16 v[76:79], v[220:223], a[128:131], v[76:79]
    v_mul_f32 v236, v60, v228
    v_fma_f32 v242, v242, v235, v235
    v_mfma_f32_16x16x32_bf16 v[80:83], v[220:223], a[132:135], v[80:83]
    v_rcp_f32 v241, v241
    v_mfma_f32_16x16x32_bf16 v[84:87], v[220:223], a[136:139], v[84:87]
    v_mul_f32 v237, v61, v228
    v_fma_f32 v243, v243, v235, v235
    v_mfma_f32_16x16x32_bf16 v[88:91], v[220:223], a[140:143], v[88:91]
    buffer_load_dwordx4 v[220:223], v2, s[8:11], s26 offen offset:2048 sc1
    v_mfma_f32_16x16x32_bf16 v[92:95], v[224:227], a[128:131], v[92:95]
    v_rcp_f32 v242, v242
    v_mul_f32 v238, v62, v228
    v_mfma_f32_16x16x32_bf16 v[96:99], v[224:227], a[132:135], v[96:99]
    v_rcp_f32 v243, v243
    v_mfma_f32_16x16x32_bf16 v[100:103], v[224:227], a[136:139], v[100:103]
    v_mul_f32 v239, v63, v228
    v_mfma_f32_16x16x32_bf16 v[104:107], v[224:227], a[140:143], v[104:107]
    v_exp_f32 v236, v236
    buffer_load_dwordx4 v[224:227], v2, s[8:11], s26 offen offset:3072 sc1
    v_mfma_f32_16x16x32_bf16 v[76:79], v[156:159], a[144:147], v[76:79]
    v_mul_f32 v240, v56, v240
    v_mul_f32 v241, v57, v241
    v_mfma_f32_16x16x32_bf16 v[80:83], v[156:159], a[148:151], v[80:83]
    v_exp_f32 v237, v237
    v_mfma_f32_16x16x32_bf16 v[84:87], v[156:159], a[152:155], v[84:87]
    v_mul_f32 v242, v58, v242
    v_mul_f32 v243, v59, v243
    v_mfma_f32_16x16x32_bf16 v[88:91], v[156:159], a[156:159], v[88:91]
    s_add_u32 s26, s26, 4096
    buffer_load_dwordx4 v[156:159], v2, s[8:11], s26 offen offset:0 sc1
    v_mfma_f32_16x16x32_bf16 v[92:95], v[160:163], a[144:147], v[92:95]
    v_exp_f32 v238, v238
    v_mfma_f32_16x16x32_bf16 v[96:99], v[160:163], a[148:151], v[96:99]
    s_add_u32 m0, s97, 9216
    s_mov_b32 s98, 279552
    buffer_load_dwordx4 v2, s[8:11], s98 offen sc1 lds
    v_mfma_f32_16x16x32_bf16 v[100:103], v[160:163], a[152:155], v[100:103]
    v_cvt_pk_bf16_f32 v56, v240, v241
    v_mfma_f32_16x16x32_bf16 v[104:107], v[160:163], a[156:159], v[104:107]
    v_exp_f32 v239, v239
    buffer_load_dwordx4 v[160:163], v2, s[8:11], s26 offen offset:1024 sc1
    s_waitcnt vmcnt(16)
    v_mfma_f32_16x16x32_bf16 v[76:79], v[164:167], a[160:163], v[76:79]
    v_cvt_pk_bf16_f32 v57, v242, v243
    v_mfma_f32_16x16x32_bf16 v[80:83], v[164:167], a[164:167], v[80:83]
    v_fma_f32 v236, v236, v229, v229
    v_fma_f32 v237, v237, v229, v229
    v_mfma_f32_16x16x32_bf16 v[84:87], v[164:167], a[168:171], v[84:87]
    v_rcp_f32 v236, v236
    v_mfma_f32_16x16x32_bf16 v[88:91], v[164:167], a[172:175], v[88:91]
    buffer_load_dwordx4 v[164:167], v2, s[8:11], s26 offen offset:2048 sc1
    v_mfma_f32_16x16x32_bf16 v[92:95], v[168:171], a[160:163], v[92:95]
    v_mul_f32 v240, v64, v230
    v_fma_f32 v238, v238, v229, v229
    v_mfma_f32_16x16x32_bf16 v[96:99], v[168:171], a[164:167], v[96:99]
    v_rcp_f32 v237, v237
    v_mul_f32 v241, v65, v230
    v_mfma_f32_16x16x32_bf16 v[100:103], v[168:171], a[168:171], v[100:103]
    v_fma_f32 v239, v239, v229, v229
    v_rcp_f32 v238, v238
    v_mfma_f32_16x16x32_bf16 v[104:107], v[168:171], a[172:175], v[104:107]
    buffer_load_dwordx4 v[168:171], v2, s[8:11], s26 offen offset:3072 sc1
    v_mfma_f32_16x16x32_bf16 v[76:79], v[172:175], a[176:179], v[76:79]
    v_mul_f32 v242, v66, v230
    v_rcp_f32 v239, v239
    v_mfma_f32_16x16x32_bf16 v[80:83], v[172:175], a[180:183], v[80:83]
    v_mul_f32 v243, v67, v230
    v_mfma_f32_16x16x32_bf16 v[84:87], v[172:175], a[184:187], v[84:87]
    v_exp_f32 v240, v240
    v_mfma_f32_16x16x32_bf16 v[88:91], v[172:175], a[188:191], v[88:91]
    v_mul_f32 v236, v60, v236
    s_add_u32 s26, s26, 4096
    buffer_load_dwordx4 v[172:175], v2, s[8:11], s26 offen offset:0 sc1
    v_mfma_f32_16x16x32_bf16 v[92:95], v[176:179], a[176:179], v[92:95]
    v_mul_f32 v237, v61, v237
    v_mfma_f32_16x16x32_bf16 v[96:99], v[176:179], a[180:183], v[96:99]
    v_exp_f32 v241, v241
    v_mul_f32 v238, v62, v238
    v_mfma_f32_16x16x32_bf16 v[100:103], v[176:179], a[184:187], v[100:103]
    v_mul_f32 v239, v63, v239
    v_mfma_f32_16x16x32_bf16 v[104:107], v[176:179], a[188:191], v[104:107]
    v_exp_f32 v242, v242
    buffer_load_dwordx4 v[176:179], v2, s[8:11], s26 offen offset:1024 sc1
    s_waitcnt vmcnt(15)
    v_mfma_f32_16x16x32_bf16 v[76:79], v[180:183], a[192:195], v[76:79]
    v_cvt_pk_bf16_f32 v46, v236, v237
    v_mfma_f32_16x16x32_bf16 v[80:83], v[180:183], a[196:199], v[80:83]
    v_cvt_pk_bf16_f32 v47, v238, v239
    v_mfma_f32_16x16x32_bf16 v[84:87], v[180:183], a[200:203], v[84:87]
    v_exp_f32 v243, v243
    ds_write_b128 v8, v[44:47] offset:32768
    v_mfma_f32_16x16x32_bf16 v[88:91], v[180:183], a[204:207], v[88:91]
    buffer_load_dwordx4 v[180:183], v2, s[8:11], s26 offen offset:2048 sc1
    v_mfma_f32_16x16x32_bf16 v[92:95], v[184:187], a[192:195], v[92:95]
    v_fma_f32 v240, v240, v231, v231
    v_fma_f32 v241, v241, v231, v231
    v_rcp_f32 v240, v240
    v_mfma_f32_16x16x32_bf16 v[96:99], v[184:187], a[196:199], v[96:99]
    v_mul_f32 v236, v68, v232
    v_mfma_f32_16x16x32_bf16 v[100:103], v[184:187], a[200:203], v[100:103]
    v_fma_f32 v242, v242, v231, v231
    v_rcp_f32 v241, v241
    v_mfma_f32_16x16x32_bf16 v[104:107], v[184:187], a[204:207], v[104:107]
    buffer_load_dwordx4 v[184:187], v2, s[8:11], s26 offen offset:3072 sc1
    v_mfma_f32_16x16x32_bf16 v[76:79], v[188:191], a[208:211], v[76:79]
    v_mul_f32 v237, v69, v232
    v_fma_f32 v243, v243, v231, v231
    v_mfma_f32_16x16x32_bf16 v[80:83], v[188:191], a[212:215], v[80:83]
    v_rcp_f32 v242, v242
    v_mfma_f32_16x16x32_bf16 v[84:87], v[188:191], a[216:219], v[84:87]
    v_mul_f32 v238, v70, v232
    v_rcp_f32 v243, v243
    v_mfma_f32_16x16x32_bf16 v[88:91], v[188:191], a[220:223], v[88:91]
    s_add_u32 s26, s26, 4096
    buffer_load_dwordx4 v[188:191], v2, s[8:11], s26 offen offset:0 sc1
    v_mfma_f32_16x16x32_bf16 v[92:95], v[192:195], a[208:211], v[92:95]
    v_mul_f32 v239, v71, v232
    v_mfma_f32_16x16x32_bf16 v[96:99], v[192:195], a[212:215], v[96:99]
    v_exp_f32 v236, v236
    v_mul_f32 v240, v64, v240
    v_mfma_f32_16x16x32_bf16 v[100:103], v[192:195], a[216:219], v[100:103]
    v_mul_f32 v241, v65, v241
    v_mfma_f32_16x16x32_bf16 v[104:107], v[192:195], a[220:223], v[104:107]
    v_exp_f32 v237, v237
    buffer_load_dwordx4 v[192:195], v2, s[8:11], s26 offen offset:1024 sc1
    s_waitcnt vmcnt(15)
    v_mfma_f32_16x16x32_bf16 v[76:79], v[196:199], a[224:227], v[76:79]
    v_mul_f32 v242, v66, v242
    v_mfma_f32_16x16x32_bf16 v[80:83], v[196:199], a[228:231], v[80:83]
    v_mul_f32 v243, v67, v243
    v_mfma_f32_16x16x32_bf16 v[84:87], v[196:199], a[232:235], v[84:87]
    v_exp_f32 v238, v238
    v_cvt_pk_bf16_f32 v50, v240, v241
    v_mfma_f32_16x16x32_bf16 v[88:91], v[196:199], a[236:239], v[88:91]
    v_cvt_pk_bf16_f32 v51, v242, v243
    buffer_load_dwordx4 v[196:199], v2, s[8:11], s26 offen offset:2048 sc1
    v_mfma_f32_16x16x32_bf16 v[92:95], v[200:203], a[224:227], v[92:95]
    v_exp_f32 v239, v239
    v_mfma_f32_16x16x32_bf16 v[96:99], v[200:203], a[228:231], v[96:99]
    s_add_u32 m0, s97, 10240
    s_mov_b32 s98, 281600
    buffer_load_dwordx4 v2, s[8:11], s98 offen sc1 lds
    v_mfma_f32_16x16x32_bf16 v[100:103], v[200:203], a[232:235], v[100:103]
    ds_write_b128 v8, v[48:51] offset:33792
    v_mfma_f32_16x16x32_bf16 v[104:107], v[200:203], a[236:239], v[104:107]
    v_fma_f32 v236, v236, v233, v233
    buffer_load_dwordx4 v[200:203], v2, s[8:11], s26 offen offset:3072 sc1
    v_mfma_f32_16x16x32_bf16 v[76:79], v[204:207], a[240:243], v[76:79]
    v_fma_f32 v237, v237, v233, v233
    v_rcp_f32 v236, v236
    v_mfma_f32_16x16x32_bf16 v[80:83], v[204:207], a[244:247], v[80:83]
    v_mul_f32 v240, v72, v234
    v_fma_f32 v238, v238, v233, v233
    v_mfma_f32_16x16x32_bf16 v[84:87], v[204:207], a[248:251], v[84:87]
    v_rcp_f32 v237, v237
    v_mfma_f32_16x16x32_bf16 v[88:91], v[204:207], a[252:255], v[88:91]
    s_add_u32 s26, s26, 4096
    buffer_load_dwordx4 v[204:207], v2, s[8:11], s26 offen offset:0 sc1
    v_mfma_f32_16x16x32_bf16 v[92:95], v[208:211], a[240:243], v[92:95]
    v_mul_f32 v241, v73, v234
    v_fma_f32 v239, v239, v233, v233
    v_mfma_f32_16x16x32_bf16 v[96:99], v[208:211], a[244:247], v[96:99]
    v_rcp_f32 v238, v238
    v_mfma_f32_16x16x32_bf16 v[100:103], v[208:211], a[248:251], v[100:103]
    v_mul_f32 v242, v74, v234
    v_mfma_f32_16x16x32_bf16 v[104:107], v[208:211], a[252:255], v[104:107]
    v_rcp_f32 v239, v239
    buffer_load_dwordx4 v[208:211], v2, s[8:11], s26 offen offset:1024 sc1
    s_waitcnt vmcnt(16)
    v_mfma_f32_16x16x32_bf16 v[76:79], v[212:215], v[12:15], v[76:79]
    v_mul_f32 v243, v75, v234
    v_mfma_f32_16x16x32_bf16 v[80:83], v[212:215], v[16:19], v[80:83]
    v_exp_f32 v240, v240
    v_mfma_f32_16x16x32_bf16 v[84:87], v[212:215], v[20:23], v[84:87]
    v_mul_f32 v236, v68, v236
    v_mul_f32 v237, v69, v237
    v_mfma_f32_16x16x32_bf16 v[88:91], v[212:215], v[24:27], v[88:91]
    buffer_load_dwordx4 v[212:215], v2, s[8:11], s26 offen offset:2048 sc1
    v_mfma_f32_16x16x32_bf16 v[92:95], v[216:219], v[12:15], v[92:95]
    v_exp_f32 v241, v241
    v_mul_f32 v238, v70, v238
    v_mfma_f32_16x16x32_bf16 v[96:99], v[216:219], v[16:19], v[96:99]
    v_mul_f32 v239, v71, v239
    v_exp_f32 v242, v242
    v_mfma_f32_16x16x32_bf16 v[100:103], v[216:219], v[20:23], v[100:103]
    v_cvt_pk_bf16_f32 v54, v236, v237
    v_mfma_f32_16x16x32_bf16 v[104:107], v[216:219], v[24:27], v[104:107]
    v_cvt_pk_bf16_f32 v55, v238, v239
    buffer_load_dwordx4 v[216:219], v2, s[8:11], s26 offen offset:3072 sc1
    v_mfma_f32_16x16x32_bf16 v[76:79], v[220:223], v[28:31], v[76:79]
    v_exp_f32 v243, v243
    ds_write_b128 v8, v[52:55] offset:34816
    v_mfma_f32_16x16x32_bf16 v[80:83], v[220:223], v[32:35], v[80:83]
    v_fma_f32 v240, v240, v235, v235
    v_fma_f32 v241, v241, v235, v235
    v_mfma_f32_16x16x32_bf16 v[84:87], v[220:223], v[36:39], v[84:87]
    v_rcp_f32 v240, v240
    v_mfma_f32_16x16x32_bf16 v[88:91], v[220:223], v[40:43], v[88:91]
    s_add_u32 s26, s26, 4096
    buffer_load_dwordx4 v[220:223], v2, s[8:11], s26 offen offset:0 sc1
    v_mfma_f32_16x16x32_bf16 v[92:95], v[224:227], v[28:31], v[92:95]
    v_fma_f32 v242, v242, v235, v235
    v_mfma_f32_16x16x32_bf16 v[96:99], v[224:227], v[32:35], v[96:99]
    v_rcp_f32 v241, v241
    v_fma_f32 v243, v243, v235, v235
    v_mfma_f32_16x16x32_bf16 v[100:103], v[224:227], v[36:39], v[100:103]
    v_rcp_f32 v242, v242
    v_mfma_f32_16x16x32_bf16 v[104:107], v[224:227], v[40:43], v[104:107]
    v_rcp_f32 v243, v243
    v_mul_f32 v240, v72, v240
    v_mul_f32 v241, v73, v241
    v_mul_f32 v242, v74, v242
    v_mul_f32 v243, v75, v243
    v_cvt_pk_bf16_f32 v58, v240, v241
    v_cvt_pk_bf16_f32 v59, v242, v243
    ds_write_b128 v8, v[56:59] offset:35840
    buffer_load_dwordx4 v[224:227], v2, s[8:11], s26 offen offset:1024 sc1
    s_waitcnt vmcnt(15)
    v_mfma_f32_16x16x32_bf16 v[44:47], v[156:159], a[0:3], 0
    v_mfma_f32_16x16x32_bf16 v[48:51], v[156:159], a[4:7], 0
    v_mfma_f32_16x16x32_bf16 v[52:55], v[156:159], a[8:11], 0
    v_mul_f32 v236, v76, v228
    v_mul_f32 v237, v77, v228
    v_mul_f32 v238, v78, v228
    v_mul_f32 v239, v79, v228
    v_exp_f32 v236, v236
    v_exp_f32 v237, v237
    v_mfma_f32_16x16x32_bf16 v[56:59], v[156:159], a[12:15], 0
    buffer_load_dwordx4 v[156:159], v2, s[8:11], s26 offen offset:2048 sc1
    s_waitcnt lgkmcnt(0)
    s_barrier
    v_mfma_f32_16x16x32_bf16 v[44:47], v[160:163], a[16:19], v[44:47]
    v_mfma_f32_16x16x32_bf16 v[48:51], v[160:163], a[20:23], v[48:51]
    v_exp_f32 v238, v238
    v_mfma_f32_16x16x32_bf16 v[52:55], v[160:163], a[24:27], v[52:55]
    v_exp_f32 v239, v239
    v_fma_f32 v236, v236, v229, v229
    v_mfma_f32_16x16x32_bf16 v[56:59], v[160:163], a[28:31], v[56:59]
    v_fma_f32 v237, v237, v229, v229
    buffer_load_dwordx4 v[160:163], v2, s[8:11], s26 offen offset:3072 sc1
    v_mfma_f32_16x16x32_bf16 v[44:47], v[164:167], a[32:35], v[44:47]
    ds_read_b128 a[0:3], v5 offset:0
    v_rcp_f32 v236, v236
    v_mfma_f32_16x16x32_bf16 v[48:51], v[164:167], a[36:39], v[48:51]
    s_add_u32 m0, s97, 11264
    s_mov_b32 s98, 283648
    buffer_load_dwordx4 v2, s[8:11], s98 offen sc1 lds
    v_mfma_f32_16x16x32_bf16 v[52:55], v[164:167], a[40:43], v[52:55]
    v_mul_f32 v240, v80, v230
    v_mfma_f32_16x16x32_bf16 v[56:59], v[164:167], a[44:47], v[56:59]
    v_fma_f32 v238, v238, v229, v229
    s_add_u32 s26, s26, 4096
    buffer_load_dwordx4 v[164:167], v2, s[8:11], s26 offen offset:0 sc1
    v_mfma_f32_16x16x32_bf16 v[44:47], v[168:171], a[48:51], v[44:47]
    ds_read_b128 a[4:7], v5 offset:1024
    v_mfma_f32_16x16x32_bf16 v[48:51], v[168:171], a[52:55], v[48:51]
    v_rcp_f32 v237, v237
    v_mul_f32 v241, v81, v230
    v_mfma_f32_16x16x32_bf16 v[52:55], v[168:171], a[56:59], v[52:55]
    v_fma_f32 v239, v239, v229, v229
    v_rcp_f32 v238, v238
    v_mfma_f32_16x16x32_bf16 v[56:59], v[168:171], a[60:63], v[56:59]
    buffer_load_dwordx4 v[168:171], v2, s[8:11], s26 offen offset:1024 sc1
    s_waitcnt vmcnt(16)
    v_mfma_f32_16x16x32_bf16 v[44:47], v[172:175], a[64:67], v[44:47]
    ds_read_b128 a[8:11], v5 offset:2048
    v_mul_f32 v242, v82, v230
    v_mfma_f32_16x16x32_bf16 v[48:51], v[172:175], a[68:71], v[48:51]
    v_rcp_f32 v239, v239
    v_mfma_f32_16x16x32_bf16 v[52:55], v[172:175], a[72:75], v[52:55]
    v_mul_f32 v243, v83, v230
    v_exp_f32 v240, v240
    v_mfma_f32_16x16x32_bf16 v[56:59], v[172:175], a[76:79], v[56:59]
    buffer_load_dwordx4 v[172:175], v2, s[8:11], s26 offen offset:2048 sc1
    v_mfma_f32_16x16x32_bf16 v[44:47], v[176:179], a[80:83], v[44:47]
    ds_read_b128 a[12:15], v5 offset:3072
    v_mul_f32 v236, v76, v236
    v_mul_f32 v237, v77, v237
    v_mfma_f32_16x16x32_bf16 v[48:51], v[176:179], a[84:87], v[48:51]
    v_exp_f32 v241, v241
    v_mul_f32 v238, v78, v238
    v_mfma_f32_16x16x32_bf16 v[52:55], v[176:179], a[88:91], v[52:55]
    v_mul_f32 v239, v79, v239
    v_mfma_f32_16x16x32_bf16 v[56:59], v[176:179], a[92:95], v[56:59]
    v_exp_f32 v242, v242
    buffer_load_dwordx4 v[176:179], v2, s[8:11], s26 offen offset:3072 sc1
    v_mfma_f32_16x16x32_bf16 v[44:47], v[180:183], a[96:99], v[44:47]
    ds_read_b128 a[16:19], v5 offset:4096
    v_cvt_pk_bf16_f32 v76, v236, v237
    v_mfma_f32_16x16x32_bf16 v[48:51], v[180:183], a[100:103], v[48:51]
    v_exp_f32 v243, v243
    v_cvt_pk_bf16_f32 v77, v238, v239
    v_mfma_f32_16x16x32_bf16 v[52:55], v[180:183], a[104:107], v[52:55]
    v_fma_f32 v240, v240, v231, v231
    v_fma_f32 v241, v241, v231, v231
    v_mfma_f32_16x16x32_bf16 v[56:59], v[180:183], a[108:111], v[56:59]
    s_add_u32 s26, s26, 4096
    buffer_load_dwordx4 v[180:183], v2, s[8:11], s26 offen offset:0 sc1
    v_mfma_f32_16x16x32_bf16 v[44:47], v[184:187], a[112:115], v[44:47]
    ds_read_b128 a[20:23], v5 offset:5120
    v_rcp_f32 v240, v240
    v_mfma_f32_16x16x32_bf16 v[48:51], v[184:187], a[116:119], v[48:51]
    v_mul_f32 v236, v84, v232
    v_fma_f32 v242, v242, v231, v231
    v_mfma_f32_16x16x32_bf16 v[52:55], v[184:187], a[120:123], v[52:55]
    v_rcp_f32 v241, v241
    v_mfma_f32_16x16x32_bf16 v[56:59], v[184:187], a[124:127], v[56:59]
    v_mul_f32 v237, v85, v232
    buffer_load_dwordx4 v[184:187], v2, s[8:11], s26 offen offset:1024 sc1
    s_waitcnt vmcnt(15)
    v_mfma_f32_16x16x32_bf16 v[44:47], v[188:191], a[128:131], v[44:47]
    ds_read_b128 a[24:27], v5 offset:6144
    v_fma_f32 v243, v243, v231, v231
    v_mfma_f32_16x16x32_bf16 v[48:51], v[188:191], a[132:135], v[48:51]
    v_rcp_f32 v242, v242
    v_mfma_f32_16x16x32_bf16 v[52:55], v[188:191], a[136:139], v[52:55]
    v_mul_f32 v238, v86, v232
    v_rcp_f32 v243, v243
    v_mfma_f32_16x16x32_bf16 v[56:59], v[188:191], a[140:143], v[56:59]
    buffer_load_dwordx4 v[188:191], v2, s[8:11], s26 offen offset:2048 sc1
    v_mfma_f32_16x16x32_bf16 v[44:47], v[192:195], a[144:147], v[44:47]
    ds_read_b128 a[28:31], v5 offset:7168
    v_mul_f32 v239, v87, v232
    v_mfma_f32_16x16x32_bf16 v[48:51], v[192:195], a[148:151], v[48:51]
    v_exp_f32 v236, v236
    v_mul_f32 v240, v80, v240
    v_mfma_f32_16x16x32_bf16 v[52:55], v[192:195], a[152:155], v[52:55]
    v_mul_f32 v241, v81, v241
    v_exp_f32 v237, v237
    v_mfma_f32_16x16x32_bf16 v[56:59], v[192:195], a[156:159], v[56:59]
    buffer_load_dwordx4 v[192:195], v2, s[8:11], s26 offen offset:3072 sc1
    v_mfma_f32_16x16x32_bf16 v[44:47], v[196:199], a[160:163], v[44:47]
    ds_read_b128 a[32:35], v5 offset:8192
    v_mul_f32 v242, v82, v242
    v_mul_f32 v243, v83, v243
    v_mfma_f32_16x16x32_bf16 v[48:51], v[196:199], a[164:167], v[48:51]
    v_exp_f32 v238, v238
    v_mfma_f32_16x16x32_bf16 v[52:55], v[196:199], a[168:171], v[52:55]
    v_cvt_pk_bf16_f32 v80, v240, v241
    v_exp_f32 v239, v239
    v_mfma_f32_16x16x32_bf16 v[56:59], v[196:199], a[172:175], v[56:59]
    s_add_u32 s26, s26, 4096
    buffer_load_dwordx4 v[196:199], v2, s[8:11], s26 offen offset:0 sc1
    v_mfma_f32_16x16x32_bf16 v[44:47], v[200:203], a[176:179], v[44:47]
    ds_read_b128 a[36:39], v5 offset:9216
    v_cvt_pk_bf16_f32 v81, v242, v243
    v_mfma_f32_16x16x32_bf16 v[48:51], v[200:203], a[180:183], v[48:51]
    v_fma_f32 v236, v236, v233, v233
    v_fma_f32 v237, v237, v233, v233
    v_mfma_f32_16x16x32_bf16 v[52:55], v[200:203], a[184:187], v[52:55]
    v_rcp_f32 v236, v236
    v_mul_f32 v240, v88, v234
    v_mfma_f32_16x16x32_bf16 v[56:59], v[200:203], a[188:191], v[56:59]
    v_fma_f32 v238, v238, v233, v233
    buffer_load_dwordx4 v[200:203], v2, s[8:11], s26 offen offset:1024 sc1
    s_waitcnt vmcnt(15)
    v_mfma_f32_16x16x32_bf16 v[44:47], v[204:207], a[192:195], v[44:47]
    ds_read_b128 a[40:43], v5 offset:10240
    v_mfma_f32_16x16x32_bf16 v[48:51], v[204:207], a[196:199], v[48:51]
    s_add_u32 m0, s97, 12288
    s_mov_b32 s98, 305152
    buffer_load_dwordx4 v2, s[8:11], s98 offen sc1 lds
    v_mfma_f32_16x16x32_bf16 v[52:55], v[204:207], a[200:203], v[52:55]
    v_rcp_f32 v237, v237
    v_mfma_f32_16x16x32_bf16 v[56:59], v[204:207], a[204:207], v[56:59]
    v_mul_f32 v241, v89, v234
    buffer_load_dwordx4 v[204:207], v2, s[8:11], s26 offen offset:2048 sc1
    v_mfma_f32_16x16x32_bf16 v[44:47], v[208:211], a[208:211], v[44:47]
    ds_read_b128 a[44:47], v5 offset:11264
    v_fma_f32 v239, v239, v233, v233
    v_mfma_f32_16x16x32_bf16 v[48:51], v[208:211], a[212:215], v[48:51]
    v_rcp_f32 v238, v238
    v_mul_f32 v242, v90, v234
    v_mfma_f32_16x16x32_bf16 v[52:55], v[208:211], a[216:219], v[52:55]
    v_rcp_f32 v239, v239
    v_mfma_f32_16x16x32_bf16 v[56:59], v[208:211], a[220:223], v[56:59]
    v_mul_f32 v243, v91, v234
    buffer_load_dwordx4 v[208:211], v2, s[8:11], s26 offen offset:3072 sc1
    v_mfma_f32_16x16x32_bf16 v[44:47], v[212:215], a[224:227], v[44:47]
    ds_read_b128 a[48:51], v5 offset:12288
    v_exp_f32 v240, v240
    v_mfma_f32_16x16x32_bf16 v[48:51], v[212:215], a[228:231], v[48:51]
    v_mul_f32 v236, v84, v236
    v_mul_f32 v237, v85, v237
    v_mfma_f32_16x16x32_bf16 v[52:55], v[212:215], a[232:235], v[52:55]
    v_exp_f32 v241, v241
    v_mfma_f32_16x16x32_bf16 v[56:59], v[212:215], a[236:239], v[56:59]
    v_mul_f32 v238, v86, v238
    s_add_u32 s26, s26, 4096
    buffer_load_dwordx4 v[212:215], v2, s[8:11], s26 offen offset:0 sc1
    v_mfma_f32_16x16x32_bf16 v[44:47], v[216:219], a[240:243], v[44:47]
    ds_read_b128 a[52:55], v5 offset:13312
    v_mul_f32 v239, v87, v239
    v_mfma_f32_16x16x32_bf16 v[48:51], v[216:219], a[244:247], v[48:51]
    v_exp_f32 v242, v242
    v_mfma_f32_16x16x32_bf16 v[52:55], v[216:219], a[248:251], v[52:55]
    v_cvt_pk_bf16_f32 v84, v236, v237
    v_exp_f32 v243, v243
    v_mfma_f32_16x16x32_bf16 v[56:59], v[216:219], a[252:255], v[56:59]
    buffer_load_dwordx4 v[216:219], v2, s[8:11], s26 offen offset:1024 sc1
    s_waitcnt vmcnt(18)
    v_mfma_f32_16x16x32_bf16 v[44:47], v[220:223], v[12:15], v[44:47]
    ds_read_b128 a[56:59], v5 offset:14336
    v_cvt_pk_bf16_f32 v85, v238, v239
    v_mfma_f32_16x16x32_bf16 v[48:51], v[220:223], v[16:19], v[48:51]
    v_fma_f32 v240, v240, v235, v235
    v_fma_f32 v241, v241, v235, v235
    v_mfma_f32_16x16x32_bf16 v[52:55], v[220:223], v[20:23], v[52:55]
    v_rcp_f32 v240, v240
    v_fma_f32 v242, v242, v235, v235
    v_mfma_f32_16x16x32_bf16 v[56:59], v[220:223], v[24:27], v[56:59]
    buffer_load_dwordx4 v[220:223], v2, s[8:11], s26 offen offset:2048 sc1
    v_mfma_f32_16x16x32_bf16 v[44:47], v[224:227], v[28:31], v[44:47]
    ds_read_b128 a[60:63], v5 offset:15360
    v_rcp_f32 v241, v241
    v_mfma_f32_16x16x32_bf16 v[48:51], v[224:227], v[32:35], v[48:51]
    v_fma_f32 v243, v243, v235, v235
    v_rcp_f32 v242, v242
    v_mfma_f32_16x16x32_bf16 v[52:55], v[224:227], v[36:39], v[52:55]
    v_rcp_f32 v243, v243
    v_mfma_f32_16x16x32_bf16 v[56:59], v[224:227], v[40:43], v[56:59]
    v_mul_f32 v240, v88, v240
    v_mul_f32 v241, v89, v241
    v_mul_f32 v242, v90, v242
    v_mul_f32 v243, v91, v243
    v_cvt_pk_bf16_f32 v88, v240, v241
    v_cvt_pk_bf16_f32 v89, v242, v243
    buffer_load_dwordx4 v[224:227], v2, s[8:11], s26 offen offset:3072 sc1
    s_waitcnt vmcnt(16) lgkmcnt(12)
    v_mfma_f32_16x16x32_bf16 v[108:111], v[156:159], a[0:3], 0
    v_mfma_f32_16x16x32_bf16 v[112:115], v[156:159], a[4:7], 0
    v_mfma_f32_16x16x32_bf16 v[116:119], v[156:159], a[8:11], 0
    v_mul_f32 v236, v92, v228
    v_mul_f32 v237, v93, v228
    v_mul_f32 v238, v94, v228
    v_mul_f32 v239, v95, v228
    v_exp_f32 v236, v236
    v_mfma_f32_16x16x32_bf16 v[120:123], v[156:159], a[12:15], 0
    v_exp_f32 v237, v237
    s_add_u32 s26, s26, 4096
    buffer_load_dwordx4 v[156:159], v2, s[8:11], s26 offen offset:0 sc1
    v_mfma_f32_16x16x32_bf16 v[124:127], v[160:163], a[0:3], 0
    v_exp_f32 v238, v238
    v_mfma_f32_16x16x32_bf16 v[128:131], v[160:163], a[4:7], 0
    v_exp_f32 v239, v239
    v_mfma_f32_16x16x32_bf16 v[132:135], v[160:163], a[8:11], 0
    v_fma_f32 v236, v236, v229, v229
    v_fma_f32 v237, v237, v229, v229
    v_mfma_f32_16x16x32_bf16 v[136:139], v[160:163], a[12:15], 0
    buffer_load_dwordx4 v[160:163], v2, s[8:11], s26 offen offset:1024 sc1
    v_mfma_f32_16x16x32_bf16 v[140:143], v[164:167], a[0:3], 0
    v_rcp_f32 v236, v236
    v_mul_f32 v240, v96, v230
    v_fma_f32 v238, v238, v229, v229
    v_mfma_f32_16x16x32_bf16 v[144:147], v[164:167], a[4:7], 0
    v_rcp_f32 v237, v237
    v_mfma_f32_16x16x32_bf16 v[148:151], v[164:167], a[8:11], 0
    v_mul_f32 v241, v97, v230
    v_fma_f32 v239, v239, v229, v229
    v_mfma_f32_16x16x32_bf16 v[152:155], v[164:167], a[12:15], 0
    buffer_load_dwordx4 v[164:167], v2, s[8:11], s26 offen offset:2048 sc1
    s_waitcnt vmcnt(16) lgkmcnt(8)
    v_mfma_f32_16x16x32_bf16 v[108:111], v[168:171], a[16:19], v[108:111]
    v_rcp_f32 v238, v238
    v_mul_f32 v242, v98, v230
    v_mfma_f32_16x16x32_bf16 v[112:115], v[168:171], a[20:23], v[112:115]
    v_rcp_f32 v239, v239
    v_mfma_f32_16x16x32_bf16 v[116:119], v[168:171], a[24:27], v[116:119]
    v_mul_f32 v243, v99, v230
    v_exp_f32 v240, v240
    v_mfma_f32_16x16x32_bf16 v[120:123], v[168:171], a[28:31], v[120:123]
    buffer_load_dwordx4 v[168:171], v2, s[8:11], s26 offen offset:3072 sc1
    v_mfma_f32_16x16x32_bf16 v[124:127], v[172:175], a[16:19], v[124:127]
    v_mul_f32 v236, v92, v236
    v_mul_f32 v237, v93, v237
    v_mfma_f32_16x16x32_bf16 v[128:131], v[172:175], a[20:23], v[128:131]
    s_add_u32 m0, s97, 13312
    s_mov_b32 s98, 307200
    buffer_load_dwordx4 v2, s[8:11], s98 offen sc1 lds
    v_mfma_f32_16x16x32_bf16 v[132:135], v[172:175], a[24:27], v[132:135]
    v_exp_f32 v241, v241
    v_mfma_f32_16x16x32_bf16 v[136:139], v[172:175], a[28:31], v[136:139]
    v_mul_f32 v238, v94, v238
    s_add_u32 s26, s26, 4096
    buffer_load_dwordx4 v[172:175], v2, s[8:11], s26 offen offset:0 sc1
    v_mfma_f32_16x16x32_bf16 v[140:143], v[176:179], a[16:19], v[140:143]
    v_mul_f32 v239, v95, v239
    v_mfma_f32_16x16x32_bf16 v[144:147], v[176:179], a[20:23], v[144:147]
    v_exp_f32 v242, v242
    v_cvt_pk_bf16_f32 v78, v236, v237
    v_mfma_f32_16x16x32_bf16 v[148:151], v[176:179], a[24:27], v[148:151]
    v_cvt_pk_bf16_f32 v79, v238, v239
    v_exp_f32 v243, v243
    v_mfma_f32_16x16x32_bf16 v[152:155], v[176:179], a[28:31], v[152:155]
    buffer_load_dwordx4 v[176:179], v2, s[8:11], s26 offen offset:1024 sc1
    s_waitcnt vmcnt(17) lgkmcnt(4)
    v_mfma_f32_16x16x32_bf16 v[108:111], v[180:183], a[32:35], v[108:111]
    ds_read_b128 a[64:67], v5 offset:16384
    ds_write_b128 v8, v[76:79] offset:49152
    v_mfma_f32_16x16x32_bf16 v[112:115], v[180:183], a[36:39], v[112:115]
    v_fma_f32 v240, v240, v231, v231
    v_fma_f32 v241, v241, v231, v231
    v_mfma_f32_16x16x32_bf16 v[116:119], v[180:183], a[40:43], v[116:119]
    ds_read_b128 a[68:71], v5 offset:17408
    v_rcp_f32 v240, v240
    v_mfma_f32_16x16x32_bf16 v[120:123], v[180:183], a[44:47], v[120:123]
    buffer_load_dwordx4 v[180:183], v2, s[8:11], s26 offen offset:2048 sc1
    v_mfma_f32_16x16x32_bf16 v[124:127], v[184:187], a[32:35], v[124:127]
    ds_read_b128 a[72:75], v5 offset:18432
    v_mul_f32 v236, v100, v232
    v_fma_f32 v242, v242, v231, v231
    v_mfma_f32_16x16x32_bf16 v[128:131], v[184:187], a[36:39], v[128:131]
    v_rcp_f32 v241, v241
    v_mfma_f32_16x16x32_bf16 v[132:135], v[184:187], a[40:43], v[132:135]
    ds_read_b128 a[76:79], v5 offset:19456
    v_mul_f32 v237, v101, v232
    v_fma_f32 v243, v243, v231, v231
    v_mfma_f32_16x16x32_bf16 v[136:139], v[184:187], a[44:47], v[136:139]
    buffer_load_dwordx4 v[184:187], v2, s[8:11], s26 offen offset:3072 sc1
    v_mfma_f32_16x16x32_bf16 v[140:143], v[188:191], a[32:35], v[140:143]
    v_rcp_f32 v242, v242
    v_mul_f32 v238, v102, v232
    v_mfma_f32_16x16x32_bf16 v[144:147], v[188:191], a[36:39], v[144:147]
    v_rcp_f32 v243, v243
    v_mfma_f32_16x16x32_bf16 v[148:151], v[188:191], a[40:43], v[148:151]
    v_mul_f32 v239, v103, v232
    v_exp_f32 v236, v236
    v_mfma_f32_16x16x32_bf16 v[152:155], v[188:191], a[44:47], v[152:155]
    s_add_u32 s26, s26, 4096
    buffer_load_dwordx4 v[188:191], v2, s[8:11], s26 offen offset:0 sc1
    s_waitcnt vmcnt(17) lgkmcnt(5)
    v_mfma_f32_16x16x32_bf16 v[108:111], v[192:195], a[48:51], v[108:111]
    ds_read_b128 a[80:83], v5 offset:20480
    v_mfma_f32_16x16x32_bf16 v[112:115], v[192:195], a[52:55], v[112:115]
    v_mul_f32 v240, v96, v240
    v_mul_f32 v241, v97, v241
    v_mfma_f32_16x16x32_bf16 v[116:119], v[192:195], a[56:59], v[116:119]
    ds_read_b128 a[84:87], v5 offset:21504
    v_exp_f32 v237, v237
    v_mfma_f32_16x16x32_bf16 v[120:123], v[192:195], a[60:63], v[120:123]
    v_mul_f32 v242, v98, v242
    buffer_load_dwordx4 v[192:195], v2, s[8:11], s26 offen offset:1024 sc1
    v_mfma_f32_16x16x32_bf16 v[124:127], v[196:199], a[48:51], v[124:127]
    ds_read_b128 a[88:91], v5 offset:22528
    v_mul_f32 v243, v99, v243
    v_mfma_f32_16x16x32_bf16 v[128:131], v[196:199], a[52:55], v[128:131]
    v_exp_f32 v238, v238
    v_cvt_pk_bf16_f32 v82, v240, v241
    v_mfma_f32_16x16x32_bf16 v[132:135], v[196:199], a[56:59], v[132:135]
    ds_read_b128 a[92:95], v5 offset:23552
    v_cvt_pk_bf16_f32 v83, v242, v243
    v_mfma_f32_16x16x32_bf16 v[136:139], v[196:199], a[60:63], v[136:139]
    buffer_load_dwordx4 v[196:199], v2, s[8:11], s26 offen offset:2048 sc1
    v_mfma_f32_16x16x32_bf16 v[140:143], v[200:203], a[48:51], v[140:143]
    v_exp_f32 v239, v239
    ds_write_b128 v8, v[80:83] offset:50176
    v_mfma_f32_16x16x32_bf16 v[144:147], v[200:203], a[52:55], v[144:147]
    v_fma_f32 v236, v236, v233, v233
    v_fma_f32 v237, v237, v233, v233
    v_mfma_f32_16x16x32_bf16 v[148:151], v[200:203], a[56:59], v[148:151]
    v_rcp_f32 v236, v236
    v_mul_f32 v240, v104, v234
    v_mfma_f32_16x16x32_bf16 v[152:155], v[200:203], a[60:63], v[152:155]
    v_fma_f32 v238, v238, v233, v233
    buffer_load_dwordx4 v[200:203], v2, s[8:11], s26 offen offset:3072 sc1
    s_waitcnt vmcnt(16) lgkmcnt(5)
    v_mfma_f32_16x16x32_bf16 v[108:111], v[204:207], a[64:67], v[108:111]
    ds_read_b128 a[96:99], v5 offset:24576
    v_mfma_f32_16x16x32_bf16 v[112:115], v[204:207], a[68:71], v[112:115]
    v_rcp_f32 v237, v237
    v_mul_f32 v241, v105, v234
    v_mfma_f32_16x16x32_bf16 v[116:119], v[204:207], a[72:75], v[116:119]
    ds_read_b128 a[100:103], v5 offset:25600
    v_fma_f32 v239, v239, v233, v233
    v_mfma_f32_16x16x32_bf16 v[120:123], v[204:207], a[76:79], v[120:123]
    s_add_u32 s26, s26, 4096
    buffer_load_dwordx4 v[204:207], v2, s[8:11], s26 offen offset:0 sc1
    v_mfma_f32_16x16x32_bf16 v[124:127], v[208:211], a[64:67], v[124:127]
    ds_read_b128 a[104:107], v5 offset:26624
    v_rcp_f32 v238, v238
    v_mfma_f32_16x16x32_bf16 v[128:131], v[208:211], a[68:71], v[128:131]
    s_add_u32 m0, s97, 14336
    s_mov_b32 s98, 309248
    buffer_load_dwordx4 v2, s[8:11], s98 offen sc1 lds
    v_mfma_f32_16x16x32_bf16 v[132:135], v[208:211], a[72:75], v[132:135]
    ds_read_b128 a[108:111], v5 offset:27648
    v_mfma_f32_16x16x32_bf16 v[136:139], v[208:211], a[76:79], v[136:139]
    v_mul_f32 v242, v106, v234
    buffer_load_dwordx4 v[208:211], v2, s[8:11], s26 offen offset:1024 sc1
    v_mfma_f32_16x16x32_bf16 v[140:143], v[212:215], a[64:67], v[140:143]
    v_rcp_f32 v239, v239
    v_mul_f32 v243, v107, v234
    v_mfma_f32_16x16x32_bf16 v[144:147], v[212:215], a[68:71], v[144:147]
    v_exp_f32 v240, v240
    v_mfma_f32_16x16x32_bf16 v[148:151], v[212:215], a[72:75], v[148:151]
    v_mul_f32 v236, v100, v236
    v_mul_f32 v237, v101, v237
    v_mfma_f32_16x16x32_bf16 v[152:155], v[212:215], a[76:79], v[152:155]
    buffer_load_dwordx4 v[212:215], v2, s[8:11], s26 offen offset:2048 sc1
    s_waitcnt vmcnt(17) lgkmcnt(5)
    v_mfma_f32_16x16x32_bf16 v[108:111], v[216:219], a[80:83], v[108:111]
    ds_read_b128 a[112:115], v5 offset:28672
    v_exp_f32 v241, v241
    v_mfma_f32_16x16x32_bf16 v[112:115], v[216:219], a[84:87], v[112:115]
    v_mul_f32 v238, v102, v238
    v_mul_f32 v239, v103, v239
    v_mfma_f32_16x16x32_bf16 v[116:119], v[216:219], a[88:91], v[116:119]
    ds_read_b128 a[116:119], v5 offset:29696
    v_exp_f32 v242, v242
    v_mfma_f32_16x16x32_bf16 v[120:123], v[216:219], a[92:95], v[120:123]
    buffer_load_dwordx4 v[216:219], v2, s[8:11], s26 offen offset:3072 sc1
    v_mfma_f32_16x16x32_bf16 v[124:127], v[220:223], a[80:83], v[124:127]
    ds_read_b128 a[120:123], v5 offset:30720
    v_cvt_pk_bf16_f32 v86, v236, v237
    v_cvt_pk_bf16_f32 v87, v238, v239
    v_mfma_f32_16x16x32_bf16 v[128:131], v[220:223], a[84:87], v[128:131]
    v_exp_f32 v243, v243
    v_mfma_f32_16x16x32_bf16 v[132:135], v[220:223], a[88:91], v[132:135]
    ds_read_b128 a[124:127], v5 offset:31744
    ds_write_b128 v8, v[84:87] offset:51200
    v_mfma_f32_16x16x32_bf16 v[136:139], v[220:223], a[92:95], v[136:139]
    v_fma_f32 v240, v240, v235, v235
    s_add_u32 s26, s26, 4096
    buffer_load_dwordx4 v[220:223], v2, s[8:11], s26 offen offset:0 sc1
    v_mfma_f32_16x16x32_bf16 v[140:143], v[224:227], a[80:83], v[140:143]
    v_fma_f32 v241, v241, v235, v235
    v_mfma_f32_16x16x32_bf16 v[144:147], v[224:227], a[84:87], v[144:147]
    v_rcp_f32 v240, v240
    v_mul_f32 v236, v44, v228
    v_mfma_f32_16x16x32_bf16 v[148:151], v[224:227], a[88:91], v[148:151]
    v_fma_f32 v242, v242, v235, v235
    v_rcp_f32 v241, v241
    v_mfma_f32_16x16x32_bf16 v[152:155], v[224:227], a[92:95], v[152:155]
    buffer_load_dwordx4 v[224:227], v2, s[8:11], s26 offen offset:1024 sc1
    s_waitcnt vmcnt(17) lgkmcnt(5)
    v_mfma_f32_16x16x32_bf16 v[108:111], v[156:159], a[96:99], v[108:111]
    ds_read_b128 a[128:131], v5 offset:32768
    v_mul_f32 v237, v45, v228
    v_mfma_f32_16x16x32_bf16 v[112:115], v[156:159], a[100:103], v[112:115]
    v_fma_f32 v243, v243, v235, v235
    v_rcp_f32 v242, v242
    v_mfma_f32_16x16x32_bf16 v[116:119], v[156:159], a[104:107], v[116:119]
    ds_read_b128 a[132:135], v5 offset:33792
    v_mul_f32 v238, v46, v228
    v_mfma_f32_16x16x32_bf16 v[120:123], v[156:159], a[108:111], v[120:123]
    buffer_load_dwordx4 v[156:159], v2, s[8:11], s26 offen offset:2048 sc1
    v_mfma_f32_16x16x32_bf16 v[124:127], v[160:163], a[96:99], v[124:127]
    ds_read_b128 a[136:139], v5 offset:34816
    v_rcp_f32 v243, v243
    v_mfma_f32_16x16x32_bf16 v[128:131], v[160:163], a[100:103], v[128:131]
    v_mul_f32 v239, v47, v228
    v_exp_f32 v236, v236
    v_mfma_f32_16x16x32_bf16 v[132:135], v[160:163], a[104:107], v[132:135]
    ds_read_b128 a[140:143], v5 offset:35840
    v_mul_f32 v240, v104, v240
    v_mfma_f32_16x16x32_bf16 v[136:139], v[160:163], a[108:111], v[136:139]
    buffer_load_dwordx4 v[160:163], v2, s[8:11], s26 offen offset:3072 sc1
    v_mfma_f32_16x16x32_bf16 v[140:143], v[164:167], a[96:99], v[140:143]
    v_mul_f32 v241, v105, v241
    v_exp_f32 v237, v237
    v_mfma_f32_16x16x32_bf16 v[144:147], v[164:167], a[100:103], v[144:147]
    v_mul_f32 v242, v106, v242
    v_mul_f32 v243, v107, v243
    v_mfma_f32_16x16x32_bf16 v[148:151], v[164:167], a[104:107], v[148:151]
    v_exp_f32 v238, v238
    v_cvt_pk_bf16_f32 v90, v240, v241
    v_mfma_f32_16x16x32_bf16 v[152:155], v[164:167], a[108:111], v[152:155]
    v_cvt_pk_bf16_f32 v91, v242, v243
    s_add_u32 s26, s26, 4096
    buffer_load_dwordx4 v[164:167], v2, s[8:11], s26 offen offset:0 sc1
    s_waitcnt vmcnt(16) lgkmcnt(5)
    v_mfma_f32_16x16x32_bf16 v[108:111], v[168:171], a[112:115], v[108:111]
    ds_read_b128 a[144:147], v6 offset:0
    v_mfma_f32_16x16x32_bf16 v[112:115], v[168:171], a[116:119], v[112:115]
    v_exp_f32 v239, v239
    v_mfma_f32_16x16x32_bf16 v[116:119], v[168:171], a[120:123], v[116:119]
    ds_read_b128 a[148:151], v6 offset:1024
    ds_write_b128 v8, v[88:91] offset:52224
    v_mfma_f32_16x16x32_bf16 v[120:123], v[168:171], a[124:127], v[120:123]
    v_fma_f32 v236, v236, v229, v229
    buffer_load_dwordx4 v[168:171], v2, s[8:11], s26 offen offset:1024 sc1
    v_mfma_f32_16x16x32_bf16 v[124:127], v[172:175], a[112:115], v[124:127]
    ds_read_b128 a[152:155], v6 offset:2048
    v_fma_f32 v237, v237, v229, v229
    v_mfma_f32_16x16x32_bf16 v[128:131], v[172:175], a[116:119], v[128:131]
    v_rcp_f32 v236, v236
    v_mul_f32 v240, v48, v230
    v_mfma_f32_16x16x32_bf16 v[132:135], v[172:175], a[120:123], v[132:135]
    ds_read_b128 a[156:159], v6 offset:3072
    v_fma_f32 v238, v238, v229, v229
    v_mfma_f32_16x16x32_bf16 v[136:139], v[172:175], a[124:127], v[136:139]
    buffer_load_dwordx4 v[172:175], v2, s[8:11], s26 offen offset:2048 sc1
    v_mfma_f32_16x16x32_bf16 v[140:143], v[176:179], a[112:115], v[140:143]
    v_rcp_f32 v237, v237
    v_mul_f32 v241, v49, v230
    v_mfma_f32_16x16x32_bf16 v[144:147], v[176:179], a[116:119], v[144:147]
    s_add_u32 m0, s97, 15360
    s_mov_b32 s98, 311296
    buffer_load_dwordx4 v2, s[8:11], s98 offen sc1 lds
    v_mfma_f32_16x16x32_bf16 v[148:151], v[176:179], a[120:123], v[148:151]
    v_fma_f32 v239, v239, v229, v229
    v_rcp_f32 v238, v238
    v_mfma_f32_16x16x32_bf16 v[152:155], v[176:179], a[124:127], v[152:155]
    buffer_load_dwordx4 v[176:179], v2, s[8:11], s26 offen offset:3072 sc1
    s_waitcnt vmcnt(17) lgkmcnt(5)
    v_mfma_f32_16x16x32_bf16 v[108:111], v[180:183], a[128:131], v[108:111]
    ds_read_b128 a[160:163], v6 offset:4096
    v_mul_f32 v242, v50, v230
    v_mfma_f32_16x16x32_bf16 v[112:115], v[180:183], a[132:135], v[112:115]
    v_rcp_f32 v239, v239
    v_mfma_f32_16x16x32_bf16 v[116:119], v[180:183], a[136:139], v[116:119]
    ds_read_b128 a[164:167], v6 offset:5120
    v_mul_f32 v243, v51, v230
    v_mfma_f32_16x16x32_bf16 v[120:123], v[180:183], a[140:143], v[120:123]
    s_add_u32 s26, s26, 4096
    buffer_load_dwordx4 v[180:183], v2, s[8:11], s26 offen offset:0 sc1
    v_mfma_f32_16x16x32_bf16 v[124:127], v[184:187], a[128:131], v[124:127]
    ds_read_b128 a[168:171], v6 offset:6144
    v_exp_f32 v240, v240
    v_mfma_f32_16x16x32_bf16 v[128:131], v[184:187], a[132:135], v[128:131]
    v_mul_f32 v236, v44, v236
    v_mul_f32 v237, v45, v237
    v_mfma_f32_16x16x32_bf16 v[132:135], v[184:187], a[136:139], v[132:135]
    ds_read_b128 a[172:175], v6 offset:7168
    v_exp_f32 v241, v241
    v_mfma_f32_16x16x32_bf16 v[136:139], v[184:187], a[140:143], v[136:139]
    buffer_load_dwordx4 v[184:187], v2, s[8:11], s26 offen offset:1024 sc1
    v_mfma_f32_16x16x32_bf16 v[140:143], v[188:191], a[128:131], v[140:143]
    v_mul_f32 v238, v46, v238
    v_mul_f32 v239, v47, v239
    v_mfma_f32_16x16x32_bf16 v[144:147], v[188:191], a[132:135], v[144:147]
    v_exp_f32 v242, v242
    v_cvt_pk_bf16_f32 v44, v236, v237
    v_mfma_f32_16x16x32_bf16 v[148:151], v[188:191], a[136:139], v[148:151]
    v_cvt_pk_bf16_f32 v45, v238, v239
    v_exp_f32 v243, v243
    v_mfma_f32_16x16x32_bf16 v[152:155], v[188:191], a[140:143], v[152:155]
    buffer_load_dwordx4 v[188:191], v2, s[8:11], s26 offen offset:2048 sc1
    s_waitcnt vmcnt(17) lgkmcnt(4)
    s_waitcnt lgkmcnt(0)
    s_barrier
    v_mfma_f32_16x16x32_bf16 v[108:111], v[192:195], a[144:147], v[108:111]
    ds_read_b128 a[176:179], v6 offset:8192
    v_mfma_f32_16x16x32_bf16 v[112:115], v[192:195], a[148:151], v[112:115]
    ds_write_b64 v9, v[44:45] offset:0
    v_mfma_f32_16x16x32_bf16 v[116:119], v[192:195], a[152:155], v[116:119]
    ds_read_b128 a[180:183], v6 offset:9216
    v_fma_f32 v240, v240, v231, v231
    v_mfma_f32_16x16x32_bf16 v[120:123], v[192:195], a[156:159], v[120:123]
    v_fma_f32 v241, v241, v231, v231
    buffer_load_dwordx4 v[192:195], v2, s[8:11], s26 offen offset:3072 sc1
    v_mfma_f32_16x16x32_bf16 v[124:127], v[196:199], a[144:147], v[124:127]
    ds_read_b128 a[184:187], v6 offset:10240
    v_rcp_f32 v240, v240
    v_mfma_f32_16x16x32_bf16 v[128:131], v[196:199], a[148:151], v[128:131]
    v_mul_f32 v236, v52, v232
    v_fma_f32 v242, v242, v231, v231
    v_mfma_f32_16x16x32_bf16 v[132:135], v[196:199], a[152:155], v[132:135]
    ds_read_b128 a[188:191], v6 offset:11264
    v_rcp_f32 v241, v241
    v_mfma_f32_16x16x32_bf16 v[136:139], v[196:199], a[156:159], v[136:139]
    s_add_u32 s26, s26, 4096
    buffer_load_dwordx4 v[196:199], v2, s[8:11], s26 offen offset:0 sc1
    v_mfma_f32_16x16x32_bf16 v[140:143], v[200:203], a[144:147], v[140:143]
    v_mul_f32 v237, v53, v232
    v_fma_f32 v243, v243, v231, v231
    v_mfma_f32_16x16x32_bf16 v[144:147], v[200:203], a[148:151], v[144:147]
    v_rcp_f32 v242, v242
    v_mfma_f32_16x16x32_bf16 v[148:151], v[200:203], a[152:155], v[148:151]
    v_mul_f32 v238, v54, v232
    v_rcp_f32 v243, v243
    v_mfma_f32_16x16x32_bf16 v[152:155], v[200:203], a[156:159], v[152:155]
    buffer_load_dwordx4 v[200:203], v2, s[8:11], s26 offen offset:1024 sc1
    s_waitcnt vmcnt(16)
    v_mfma_f32_16x16x32_bf16 v[108:111], v[204:207], a[160:163], v[108:111]
    ds_read_b128 a[192:195], v6 offset:12288
    v_mul_f32 v239, v55, v232
    v_mfma_f32_16x16x32_bf16 v[112:115], v[204:207], a[164:167], v[112:115]
    v_exp_f32 v236, v236
    v_mfma_f32_16x16x32_bf16 v[116:119], v[204:207], a[168:171], v[116:119]
    ds_read_b128 a[196:199], v6 offset:13312
    v_mul_f32 v240, v48, v240
    v_mul_f32 v241, v49, v241
    v_mfma_f32_16x16x32_bf16 v[120:123], v[204:207], a[172:175], v[120:123]
    buffer_load_dwordx4 v[204:207], v2, s[8:11], s26 offen offset:2048 sc1
    v_mfma_f32_16x16x32_bf16 v[124:127], v[208:211], a[160:163], v[124:127]
    ds_read_b128 a[200:203], v6 offset:14336
    v_exp_f32 v237, v237
    v_mfma_f32_16x16x32_bf16 v[128:131], v[208:211], a[164:167], v[128:131]
    v_mul_f32 v242, v50, v242
    v_mul_f32 v243, v51, v243
    v_mfma_f32_16x16x32_bf16 v[132:135], v[208:211], a[168:171], v[132:135]
    ds_read_b128 a[204:207], v6 offset:15360
    v_exp_f32 v238, v238
    v_mfma_f32_16x16x32_bf16 v[136:139], v[208:211], a[172:175], v[136:139]
    v_cvt_pk_bf16_f32 v48, v240, v241
    buffer_load_dwordx4 v[208:211], v2, s[8:11], s26 offen offset:3072 sc1
    v_mfma_f32_16x16x32_bf16 v[140:143], v[212:215], a[160:163], v[140:143]
    v_cvt_pk_bf16_f32 v49, v242, v243
    v_exp_f32 v239, v239
    v_mfma_f32_16x16x32_bf16 v[144:147], v[212:215], a[164:167], v[144:147]
    ds_write_b64 v9, v[48:49] offset:1024
    v_fma_f32 v236, v236, v233, v233
    v_mfma_f32_16x16x32_bf16 v[148:151], v[212:215], a[168:171], v[148:151]
    v_fma_f32 v237, v237, v233, v233
    v_mfma_f32_16x16x32_bf16 v[152:155], v[212:215], a[172:175], v[152:155]
    v_rcp_f32 v236, v236
    s_add_u32 s26, s26, 4096
    buffer_load_dwordx4 v[212:215], v2, s[8:11], s26 offen offset:0 sc1
    s_waitcnt vmcnt(16) lgkmcnt(5)
    v_mfma_f32_16x16x32_bf16 v[108:111], v[216:219], a[176:179], v[108:111]
    ds_read_b128 a[208:211], v6 offset:16384
    v_mfma_f32_16x16x32_bf16 v[112:115], v[216:219], a[180:183], v[112:115]
    s_add_u32 m0, s97, 16384
    s_mov_b32 s98, 316416
    buffer_load_dwordx4 v2, s[8:11], s98 offen sc1 lds
    v_mfma_f32_16x16x32_bf16 v[116:119], v[216:219], a[184:187], v[116:119]
    ds_read_b128 a[212:215], v6 offset:17408
    v_mfma_f32_16x16x32_bf16 v[120:123], v[216:219], a[188:191], v[120:123]
    v_mul_f32 v240, v56, v234
    buffer_load_dwordx4 v[216:219], v2, s[8:11], s26 offen offset:1024 sc1
    v_mfma_f32_16x16x32_bf16 v[124:127], v[220:223], a[176:179], v[124:127]
    ds_read_b128 a[216:219], v6 offset:18432
    v_fma_f32 v238, v238, v233, v233
    v_mfma_f32_16x16x32_bf16 v[128:131], v[220:223], a[180:183], v[128:131]
    v_rcp_f32 v237, v237
    v_mul_f32 v241, v57, v234
    v_mfma_f32_16x16x32_bf16 v[132:135], v[220:223], a[184:187], v[132:135]
    ds_read_b128 a[220:223], v6 offset:19456
    v_fma_f32 v239, v239, v233, v233
    v_mfma_f32_16x16x32_bf16 v[136:139], v[220:223], a[188:191], v[136:139]
    buffer_load_dwordx4 v[220:223], v2, s[8:11], s26 offen offset:2048 sc1
    v_mfma_f32_16x16x32_bf16 v[140:143], v[224:227], a[176:179], v[140:143]
    v_rcp_f32 v238, v238
    v_mul_f32 v242, v58, v234
    v_mfma_f32_16x16x32_bf16 v[144:147], v[224:227], a[180:183], v[144:147]
    v_rcp_f32 v239, v239
    v_mul_f32 v243, v59, v234
    v_mfma_f32_16x16x32_bf16 v[148:151], v[224:227], a[184:187], v[148:151]
    v_exp_f32 v240, v240
    v_mfma_f32_16x16x32_bf16 v[152:155], v[224:227], a[188:191], v[152:155]
    v_mul_f32 v236, v52, v236
    buffer_load_dwordx4 v[224:227], v2, s[8:11], s26 offen offset:3072 sc1
    s_waitcnt vmcnt(17) lgkmcnt(5)
    v_mfma_f32_16x16x32_bf16 v[108:111], v[156:159], a[192:195], v[108:111]
    ds_read_b128 a[224:227], v6 offset:20480
    v_mul_f32 v237, v53, v237
    v_mfma_f32_16x16x32_bf16 v[112:115], v[156:159], a[196:199], v[112:115]
    v_exp_f32 v241, v241
    v_mfma_f32_16x16x32_bf16 v[116:119], v[156:159], a[200:203], v[116:119]
    ds_read_b128 a[228:231], v6 offset:21504
    v_mul_f32 v238, v54, v238
    v_mfma_f32_16x16x32_bf16 v[120:123], v[156:159], a[204:207], v[120:123]
    v_mul_f32 v239, v55, v239
    s_add_u32 s26, s26, 4096
    buffer_load_dwordx4 v[156:159], v2, s[8:11], s26 offen offset:0 sc1
    v_mfma_f32_16x16x32_bf16 v[124:127], v[160:163], a[192:195], v[124:127]
    ds_read_b128 a[232:235], v6 offset:22528
    v_mfma_f32_16x16x32_bf16 v[128:131], v[160:163], a[196:199], v[128:131]
    v_exp_f32 v242, v242
    v_cvt_pk_bf16_f32 v52, v236, v237
    v_mfma_f32_16x16x32_bf16 v[132:135], v[160:163], a[200:203], v[132:135]
    ds_read_b128 a[236:239], v6 offset:23552
    v_cvt_pk_bf16_f32 v53, v238, v239
    v_mfma_f32_16x16x32_bf16 v[136:139], v[160:163], a[204:207], v[136:139]
    v_exp_f32 v243, v243
    buffer_load_dwordx4 v[160:163], v2, s[8:11], s26 offen offset:1024 sc1
    v_mfma_f32_16x16x32_bf16 v[140:143], v[164:167], a[192:195], v[140:143]
    ds_write_b64 v9, v[52:53] offset:2048
    v_fma_f32 v240, v240, v235, v235
    v_mfma_f32_16x16x32_bf16 v[144:147], v[164:167], a[196:199], v[144:147]
    v_fma_f32 v241, v241, v235, v235
    v_rcp_f32 v240, v240
    v_mfma_f32_16x16x32_bf16 v[148:151], v[164:167], a[200:203], v[148:151]
    v_fma_f32 v242, v242, v235, v235
    v_mfma_f32_16x16x32_bf16 v[152:155], v[164:167], a[204:207], v[152:155]
    v_rcp_f32 v241, v241
    v_fma_f32 v243, v243, v235, v235
    v_rcp_f32 v242, v242
    v_rcp_f32 v243, v243
    v_mul_f32 v240, v56, v240
    v_mul_f32 v241, v57, v241
    v_mul_f32 v242, v58, v242
    v_mul_f32 v243, v59, v243
    v_cvt_pk_bf16_f32 v56, v240, v241
    v_cvt_pk_bf16_f32 v57, v242, v243
    ds_write_b64 v9, v[56:57] offset:3072
    buffer_load_dwordx4 v[164:167], v2, s[8:11], s26 offen offset:2048 sc1
    s_waitcnt vmcnt(16) lgkmcnt(6)
    v_mfma_f32_16x16x32_bf16 v[108:111], v[168:171], a[208:211], v[108:111]
    ds_read_b128 a[240:243], v6 offset:24576
    v_mfma_f32_16x16x32_bf16 v[112:115], v[168:171], a[212:215], v[112:115]
    v_mfma_f32_16x16x32_bf16 v[116:119], v[168:171], a[216:219], v[116:119]
    ds_read_b128 a[244:247], v6 offset:25600
    v_mfma_f32_16x16x32_bf16 v[120:123], v[168:171], a[220:223], v[120:123]
    buffer_load_dwordx4 v[168:171], v2, s[8:11], s26 offen offset:3072 sc1
    v_mfma_f32_16x16x32_bf16 v[124:127], v[172:175], a[208:211], v[124:127]
    ds_read_b128 a[248:251], v6 offset:26624
    s_lshl_b32 s21, s6, 11
    s_sub_u32 s32, s3, 1
    v_mfma_f32_16x16x32_bf16 v[128:131], v[172:175], a[212:215], v[128:131]
    s_and_b32 s32, s32, 7
    s_lshl_b32 s32, s32, 13
    v_mfma_f32_16x16x32_bf16 v[132:135], v[172:175], a[216:219], v[132:135]
    ds_read_b128 a[252:255], v6 offset:27648
    s_add_u32 s32, s32, s21
    s_sub_u32 s33, s3, 2
    v_mfma_f32_16x16x32_bf16 v[136:139], v[172:175], a[220:223], v[136:139]
    s_and_b32 s33, s33, 7
    s_lshl_b32 s33, s33, 13
    s_add_u32 s26, s26, 4096
    buffer_load_dwordx4 v[172:175], v2, s[8:11], s26 offen offset:0 sc1
    v_mfma_f32_16x16x32_bf16 v[140:143], v[176:179], a[208:211], v[140:143]
    s_add_u32 s33, s33, s21
    s_add_u32 s33, s33, 65536
    v_mfma_f32_16x16x32_bf16 v[144:147], v[176:179], a[212:215], v[144:147]
    s_sub_u32 s34, s3, 3
    s_and_b32 s34, s34, 7
    v_mfma_f32_16x16x32_bf16 v[148:151], v[176:179], a[216:219], v[148:151]
    s_lshl_b32 s34, s34, 13
    s_add_u32 s34, s34, s21
    v_mfma_f32_16x16x32_bf16 v[152:155], v[176:179], a[220:223], v[152:155]
    s_sub_u32 s35, s3, 4
    s_and_b32 s35, s35, 7
    buffer_load_dwordx4 v[176:179], v2, s[8:11], s26 offen offset:1024 sc1
    s_waitcnt vmcnt(16) lgkmcnt(6)
    s_waitcnt lgkmcnt(0)
    s_barrier
    v_mfma_f32_16x16x32_bf16 v[108:111], v[180:183], a[224:227], v[108:111]
    ds_read_b128 v[12:15], v6 offset:28672
    s_lshl_b32 s35, s35, 13
    s_add_u32 s35, s35, s21
    v_mfma_f32_16x16x32_bf16 v[112:115], v[180:183], a[228:231], v[112:115]
    s_add_u32 s35, s35, 65536
    s_sub_u32 s36, s3, 5
    v_mfma_f32_16x16x32_bf16 v[116:119], v[180:183], a[232:235], v[116:119]
    ds_read_b128 v[16:19], v6 offset:29696
    s_and_b32 s36, s36, 7
    s_lshl_b32 s36, s36, 13
    v_mfma_f32_16x16x32_bf16 v[120:123], v[180:183], a[236:239], v[120:123]
    s_add_u32 s36, s36, s21
    s_sub_u32 s37, s3, 6
    buffer_load_dwordx4 v[180:183], v2, s[8:11], s26 offen offset:2048 sc1
    v_mfma_f32_16x16x32_bf16 v[124:127], v[184:187], a[224:227], v[124:127]
    ds_read_b128 v[20:23], v6 offset:30720
    s_and_b32 s37, s37, 7
    s_lshl_b32 s37, s37, 13
    v_mfma_f32_16x16x32_bf16 v[128:131], v[184:187], a[228:231], v[128:131]
    s_add_u32 m0, s97, 17408
    s_mov_b32 s98, 318464
    buffer_load_dwordx4 v2, s[8:11], s98 offen sc1 lds
    s_add_u32 s37, s37, s21
    s_add_u32 s37, s37, 65536
    v_mfma_f32_16x16x32_bf16 v[132:135], v[184:187], a[232:235], v[132:135]
    ds_read_b128 v[24:27], v6 offset:31744
    s_lshl_b32 s38, s3, 13
    s_add_u32 s38, s38, s21
    v_mfma_f32_16x16x32_bf16 v[136:139], v[184:187], a[236:239], v[136:139]
    s_add_u32 s39, s38, 65536
    s_add_u32 s40, s38, 131072
    buffer_load_dwordx4 v[184:187], v2, s[8:11], s26 offen offset:3072 sc1
    v_mfma_f32_16x16x32_bf16 v[140:143], v[188:191], a[224:227], v[140:143]
    s_add_u32 s21, s21, 131072
    s_lshl_b32 s41, s3, 8
    v_mfma_f32_16x16x32_bf16 v[144:147], v[188:191], a[228:231], v[144:147]
    s_add_u32 s41, s41, s21
    s_sub_u32 s25, s3, 1
    v_mfma_f32_16x16x32_bf16 v[148:151], v[188:191], a[232:235], v[148:151]
    s_and_b32 s25, s25, 7
    s_lshl_b32 s42, s25, 8
    v_mfma_f32_16x16x32_bf16 v[152:155], v[188:191], a[236:239], v[152:155]
    s_add_u32 s42, s42, s21
    s_lshl_b32 s25, s25, 2
    s_add_u32 s26, s26, 4096
    buffer_load_dwordx4 v[188:191], v2, s[8:11], s26 offen offset:0 sc1
    s_waitcnt vmcnt(17)
    v_mfma_f32_16x16x32_bf16 v[108:111], v[192:195], a[240:243], v[108:111]
    ds_read_b128 v[28:31], v6 offset:32768
    s_add_u32 s25, s25, s6
    s_lshl_b32 s25, 1, s25
    v_mfma_f32_16x16x32_bf16 v[112:115], v[192:195], a[244:247], v[112:115]
    s_sub_u32 s23, s3, 2
    s_and_b32 s23, s23, 7
    v_mfma_f32_16x16x32_bf16 v[116:119], v[192:195], a[248:251], v[116:119]
    ds_read_b128 v[32:35], v6 offset:33792
    s_lshl_b32 s23, s23, 2
    s_add_u32 s23, s23, s6
    v_mfma_f32_16x16x32_bf16 v[120:123], v[192:195], a[252:255], v[120:123]
    s_lshl_b32 s23, 1, s23
    s_sub_u32 s24, s3, 3
    buffer_load_dwordx4 v[192:195], v2, s[8:11], s26 offen offset:1024 sc1
    v_mfma_f32_16x16x32_bf16 v[124:127], v[196:199], a[240:243], v[124:127]
    ds_read_b128 v[36:39], v6 offset:34816
    s_and_b32 s24, s24, 7
    s_lshl_b32 s24, s24, 2
    v_mfma_f32_16x16x32_bf16 v[128:131], v[196:199], a[244:247], v[128:131]
    s_add_u32 s24, s24, s6
    s_lshl_b32 s24, 1, s24
    v_mfma_f32_16x16x32_bf16 v[132:135], v[196:199], a[248:251], v[132:135]
    ds_read_b128 v[40:43], v6 offset:35840
    s_or_b32 s24, s24, s23
    s_lshl_b32 s22, 0x11111111, s6
    v_mfma_f32_16x16x32_bf16 v[136:139], v[196:199], a[252:255], v[136:139]
    s_add_u32 s43, s51, 4096
    s_add_u32 s55, s52, 4096
    buffer_load_dwordx4 v[196:199], v2, s[8:11], s26 offen offset:2048 sc1
    v_mfma_f32_16x16x32_bf16 v[140:143], v[200:203], a[240:243], v[140:143]
    s_cmp_eq_u32 s45, 1
    s_cselect_b32 s27, 0, -1
    v_mfma_f32_16x16x32_bf16 v[144:147], v[200:203], a[244:247], v[144:147]
    v_mfma_f32_16x16x32_bf16 v[148:151], v[200:203], a[248:251], v[148:151]
    v_mfma_f32_16x16x32_bf16 v[152:155], v[200:203], a[252:255], v[152:155]
    buffer_load_dwordx4 v[200:203], v2, s[8:11], s26 offen offset:3072 sc1
    s_waitcnt vmcnt(17) lgkmcnt(4)
    v_mfma_f32_16x16x32_bf16 v[108:111], v[204:207], v[12:15], v[108:111]
    v_mfma_f32_16x16x32_bf16 v[112:115], v[204:207], v[16:19], v[112:115]
    v_mfma_f32_16x16x32_bf16 v[116:119], v[204:207], v[20:23], v[116:119]
    v_mfma_f32_16x16x32_bf16 v[120:123], v[204:207], v[24:27], v[120:123]
    s_add_u32 s26, s26, 4096
    buffer_load_dwordx4 v[204:207], v2, s[8:11], s26 offen offset:0 sc1
    v_mfma_f32_16x16x32_bf16 v[124:127], v[208:211], v[12:15], v[124:127]
    v_mfma_f32_16x16x32_bf16 v[128:131], v[208:211], v[16:19], v[128:131]
    v_mfma_f32_16x16x32_bf16 v[132:135], v[208:211], v[20:23], v[132:135]
    v_mfma_f32_16x16x32_bf16 v[136:139], v[208:211], v[24:27], v[136:139]
    buffer_load_dwordx4 v[208:211], v2, s[8:11], s26 offen offset:1024 sc1
    v_mfma_f32_16x16x32_bf16 v[140:143], v[212:215], v[12:15], v[140:143]
    v_mfma_f32_16x16x32_bf16 v[144:147], v[212:215], v[16:19], v[144:147]
    v_mfma_f32_16x16x32_bf16 v[148:151], v[212:215], v[20:23], v[148:151]
    v_mfma_f32_16x16x32_bf16 v[152:155], v[212:215], v[24:27], v[152:155]
    buffer_load_dwordx4 v[212:215], v2, s[8:11], s26 offen offset:2048 sc1
    s_waitcnt vmcnt(16) lgkmcnt(0)
    v_mfma_f32_16x16x32_bf16 v[108:111], v[216:219], v[28:31], v[108:111]
    v_mfma_f32_16x16x32_bf16 v[112:115], v[216:219], v[32:35], v[112:115]
    v_mfma_f32_16x16x32_bf16 v[116:119], v[216:219], v[36:39], v[116:119]
    v_mfma_f32_16x16x32_bf16 v[120:123], v[216:219], v[40:43], v[120:123]
    buffer_load_dwordx4 v[216:219], v2, s[8:11], s26 offen offset:3072 sc1
    v_mfma_f32_16x16x32_bf16 v[124:127], v[220:223], v[28:31], v[124:127]
    v_mfma_f32_16x16x32_bf16 v[128:131], v[220:223], v[32:35], v[128:131]
    v_mfma_f32_16x16x32_bf16 v[132:135], v[220:223], v[36:39], v[132:135]
    v_mfma_f32_16x16x32_bf16 v[136:139], v[220:223], v[40:43], v[136:139]
    s_add_u32 s26, s26, 4096
    buffer_load_dwordx4 v[220:223], v2, s[8:11], s26 offen offset:0 sc1
    v_mfma_f32_16x16x32_bf16 v[140:143], v[224:227], v[28:31], v[140:143]
    v_mfma_f32_16x16x32_bf16 v[144:147], v[224:227], v[32:35], v[144:147]
    v_mfma_f32_16x16x32_bf16 v[148:151], v[224:227], v[36:39], v[148:151]
    v_mfma_f32_16x16x32_bf16 v[152:155], v[224:227], v[40:43], v[152:155]
    buffer_load_dwordx4 v[224:227], v2, s[8:11], s26 offen offset:1024 sc1
    s_waitcnt vmcnt(15)
    v_mfma_f32_16x16x32_bf16 v[76:79], v[156:159], a[0:3], 0
    v_mfma_f32_16x16x32_bf16 v[80:83], v[156:159], a[4:7], 0
    v_mfma_f32_16x16x32_bf16 v[84:87], v[156:159], a[8:11], 0
    v_mfma_f32_16x16x32_bf16 v[88:91], v[156:159], a[12:15], 0
    buffer_load_dwordx4 v[156:159], v2, s[8:11], s26 offen offset:2048 sc1
    v_mfma_f32_16x16x32_bf16 v[92:95], v[160:163], a[0:3], 0
    v_cvt_pk_bf16_f32 v124, v124, v125
    v_cvt_pk_bf16_f32 v125, v126, v127
    v_mfma_f32_16x16x32_bf16 v[96:99], v[160:163], a[4:7], 0
    v_cvt_pk_bf16_f32 v126, v128, v129
    v_cvt_pk_bf16_f32 v127, v130, v131
    v_mfma_f32_16x16x32_bf16 v[100:103], v[160:163], a[8:11], 0
    buffer_store_dwordx4 v[124:127], v2, s[16:19], s32 offen offset:0
    v_cvt_pk_bf16_f32 v132, v132, v133
    v_mfma_f32_16x16x32_bf16 v[104:107], v[160:163], a[12:15], 0
    v_cvt_pk_bf16_f32 v133, v134, v135
    v_cvt_pk_bf16_f32 v134, v136, v137
    ds_read_b128 v[160:163], v0 offset:0
    v_mfma_f32_16x16x32_bf16 v[76:79], v[164:167], a[16:19], v[76:79]
    v_cvt_pk_bf16_f32 v135, v138, v139
    buffer_store_dwordx4 v[132:135], v2, s[16:19], s32 offen offset:1024
    v_mfma_f32_16x16x32_bf16 v[80:83], v[164:167], a[20:23], v[80:83]
    v_cvt_pk_bf16_f32 v140, v140, v141
    v_cvt_pk_bf16_f32 v141, v142, v143
    v_mfma_f32_16x16x32_bf16 v[84:87], v[164:167], a[24:27], v[84:87]
    v_cvt_pk_bf16_f32 v142, v144, v145
    v_cvt_pk_bf16_f32 v143, v146, v147
    v_mfma_f32_16x16x32_bf16 v[88:91], v[164:167], a[28:31], v[88:91]
    buffer_store_dwordx4 v[140:143], v2, s[16:19], s33 offen offset:0
    v_cvt_pk_bf16_f32 v148, v148, v149
    s_add_u32 s26, s26, 4096
    buffer_load_dwordx4 v[164:167], v2, s[8:11], s26 offen offset:0 sc1
    v_mfma_f32_16x16x32_bf16 v[92:95], v[168:171], a[16:19], v[92:95]
    v_cvt_pk_bf16_f32 v149, v150, v151
    v_cvt_pk_bf16_f32 v150, v152, v153
    v_mfma_f32_16x16x32_bf16 v[96:99], v[168:171], a[20:23], v[96:99]
    v_cvt_pk_bf16_f32 v151, v154, v155
    buffer_store_dwordx4 v[148:151], v2, s[16:19], s33 offen offset:1024
    v_mfma_f32_16x16x32_bf16 v[100:103], v[168:171], a[24:27], v[100:103]
    v_cvt_pk_bf16_f32 v108, v108, v109
    v_cvt_pk_bf16_f32 v109, v110, v111
    v_mfma_f32_16x16x32_bf16 v[104:107], v[168:171], a[28:31], v[104:107]
    v_cvt_pk_bf16_f32 v110, v112, v113
    v_cvt_pk_bf16_f32 v111, v114, v115
    ds_read_b128 v[168:171], v0 offset:1024
    s_waitcnt vmcnt(16)
    v_mfma_f32_16x16x32_bf16 v[76:79], v[172:175], a[32:35], v[76:79]
    buffer_store_dwordx4 v[108:111], v2, s[16:19], s40 offen offset:0
    v_cvt_pk_bf16_f32 v116, v116, v117
    v_mfma_f32_16x16x32_bf16 v[80:83], v[172:175], a[36:39], v[80:83]
    v_cvt_pk_bf16_f32 v117, v118, v119
    v_cvt_pk_bf16_f32 v118, v120, v121
    v_mfma_f32_16x16x32_bf16 v[84:87], v[172:175], a[40:43], v[84:87]
    v_cvt_pk_bf16_f32 v119, v122, v123
    buffer_store_dwordx4 v[116:119], v2, s[16:19], s40 offen offset:1024
    v_mfma_f32_16x16x32_bf16 v[88:91], v[172:175], a[44:47], v[88:91]
    buffer_load_dwordx4 v[172:175], v2, s[8:11], s26 offen offset:2048 sc1
    v_mfma_f32_16x16x32_bf16 v[92:95], v[176:179], a[32:35], v[92:95]
    v_mfma_f32_16x16x32_bf16 v[96:99], v[176:179], a[36:39], v[96:99]
    v_mfma_f32_16x16x32_bf16 v[100:103], v[176:179], a[40:43], v[100:103]
    v_mfma_f32_16x16x32_bf16 v[104:107], v[176:179], a[44:47], v[104:107]
    ds_read_b128 v[176:179], v0 offset:2048
    v_mfma_f32_16x16x32_bf16 v[76:79], v[180:183], a[48:51], v[76:79]
    v_mfma_f32_16x16x32_bf16 v[80:83], v[180:183], a[52:55], v[80:83]
    v_mfma_f32_16x16x32_bf16 v[84:87], v[180:183], a[56:59], v[84:87]
    v_mfma_f32_16x16x32_bf16 v[88:91], v[180:183], a[60:63], v[88:91]
    s_add_u32 s26, s26, 4096
    buffer_load_dwordx4 v[180:183], v2, s[8:11], s26 offen offset:0 sc1
    v_mfma_f32_16x16x32_bf16 v[92:95], v[184:187], a[48:51], v[92:95]
    v_mfma_f32_16x16x32_bf16 v[96:99], v[184:187], a[52:55], v[96:99]
    v_mfma_f32_16x16x32_bf16 v[100:103], v[184:187], a[56:59], v[100:103]
    v_mfma_f32_16x16x32_bf16 v[104:107], v[184:187], a[60:63], v[104:107]
    ds_read_b128 v[184:187], v0 offset:3072
    s_waitcnt vmcnt(16)
    v_mfma_f32_16x16x32_bf16 v[76:79], v[188:191], a[64:67], v[76:79]
    v_and_b32 v10, 15, v1
    v_lshrrev_b32 v249, 4, v1
    v_mfma_f32_16x16x32_bf16 v[80:83], v[188:191], a[68:71], v[80:83]
    v_lshlrev_b32 v249, 2, v249
    v_sub_u32 v10, v10, v249
    v_mfma_f32_16x16x32_bf16 v[84:87], v[188:191], a[72:75], v[84:87]
    v_mov_b32 v4, 0
    v_mov_b32 v5, 0
    v_mfma_f32_16x16x32_bf16 v[88:91], v[188:191], a[76:79], v[88:91]
    v_mov_b32 v6, 0
    v_mov_b32 v7, 0
    buffer_load_dwordx4 v[188:191], v2, s[8:11], s26 offen offset:2048 sc1
    v_mfma_f32_16x16x32_bf16 v[92:95], v[192:195], a[64:67], v[92:95]
    v_mov_b32 v8, 0
    v_mov_b32 v9, 0
    v_mfma_f32_16x16x32_bf16 v[96:99], v[192:195], a[68:71], v[96:99]
    v_mov_b32 v249, 16256
    v_cmp_eq_u32 vcc, 0, v10
    v_mfma_f32_16x16x32_bf16 v[100:103], v[192:195], a[72:75], v[100:103]
    s_nop 0
    s_nop 0
    v_mfma_f32_16x16x32_bf16 v[104:107], v[192:195], a[76:79], v[104:107]
    v_cndmask_b32 v6, v6, v249, vcc
    v_mov_b32 v249, 1065353216
    buffer_load_dwordx4 v[192:195], v2, s[8:11], s26 offen offset:3072 sc1
    v_mfma_f32_16x16x32_bf16 v[76:79], v[196:199], a[80:83], v[76:79]
    v_cmp_eq_u32 vcc, 1, v10
    s_nop 0
    v_mfma_f32_16x16x32_bf16 v[80:83], v[196:199], a[84:87], v[80:83]
    s_nop 0
    v_cndmask_b32 v6, v6, v249, vcc
    v_mfma_f32_16x16x32_bf16 v[84:87], v[196:199], a[88:91], v[84:87]
    v_mov_b32 v249, 16256
    v_cmp_eq_u32 vcc, 2, v10
    v_mfma_f32_16x16x32_bf16 v[88:91], v[196:199], a[92:95], v[88:91]
    s_nop 0
    s_nop 0
    s_add_u32 s26, s26, 4096
    buffer_load_dwordx4 v[196:199], v2, s[8:11], s26 offen offset:0 sc1
    v_mfma_f32_16x16x32_bf16 v[92:95], v[200:203], a[80:83], v[92:95]
    v_cndmask_b32 v7, v7, v249, vcc
    v_mov_b32 v249, 1065353216
    v_mfma_f32_16x16x32_bf16 v[96:99], v[200:203], a[84:87], v[96:99]
    v_cmp_eq_u32 vcc, 3, v10
    s_nop 0
    v_mfma_f32_16x16x32_bf16 v[100:103], v[200:203], a[88:91], v[100:103]
    s_nop 0
    v_cndmask_b32 v7, v7, v249, vcc
    v_mfma_f32_16x16x32_bf16 v[104:107], v[200:203], a[92:95], v[104:107]
    s_bitcmp0_b32 s6, 0
    s_cselect_b64 vcc, -1, 0
    v_cndmask_b32 v250, v4, v6, vcc
    buffer_load_dwordx4 v[200:203], v2, s[8:11], s26 offen offset:1024 sc1
    s_waitcnt vmcnt(16)
    v_mfma_f32_16x16x32_bf16 v[76:79], v[204:207], a[96:99], v[76:79]
    v_cndmask_b32 v251, v5, v7, vcc
    v_cndmask_b32 v252, v6, v8, vcc
    v_mfma_f32_16x16x32_bf16 v[80:83], v[204:207], a[100:103], v[80:83]
    v_cndmask_b32 v253, v7, v9, vcc
    v_mfma_f32_16x16x32_bf16 v[84:87], v[204:207], a[104:107], v[84:87]
    v_mfma_f32_16x16x32_bf16 v[88:91], v[204:207], a[108:111], v[88:91]
    buffer_load_dwordx4 v[204:207], v2, s[8:11], s26 offen offset:2048 sc1
    v_mfma_f32_16x16x32_bf16 v[92:95], v[208:211], a[96:99], v[92:95]
    v_mfma_f32_16x16x32_bf16 v[96:99], v[208:211], a[100:103], v[96:99]
    v_mfma_f32_16x16x32_bf16 v[100:103], v[208:211], a[104:107], v[100:103]
    v_mfma_f32_16x16x32_bf16 v[104:107], v[208:211], a[108:111], v[104:107]
    buffer_load_dwordx4 v[208:211], v2, s[8:11], s26 offen offset:3072 sc1
    v_mfma_f32_16x16x32_bf16 v[76:79], v[212:215], a[112:115], v[76:79]
    v_mfma_f32_16x16x32_bf16 v[80:83], v[212:215], a[116:119], v[80:83]
    v_mfma_f32_16x16x32_bf16 v[84:87], v[212:215], a[120:123], v[84:87]
    v_mfma_f32_16x16x32_bf16 v[88:91], v[212:215], a[124:127], v[88:91]
    s_add_u32 s26, s26, 4096
    buffer_load_dwordx4 v[212:215], v2, s[8:11], s26 offen offset:0 sc1
    v_mfma_f32_16x16x32_bf16 v[92:95], v[216:219], a[112:115], v[92:95]
    v_mov_b32 v254, 1
    s_waitcnt vmcnt(9)
    s_mov_b64 exec, 1
    s_cmp_lg_u32 s45, 1
    s_cbranch_scc1 L_fsig1
    buffer_store_dword v254, off, s[56:59], s55
L_fsigb1:
    s_mov_b64 exec, -1
    v_mfma_f32_16x16x32_bf16 v[96:99], v[216:219], a[116:119], v[96:99]
    v_mfma_f32_16x16x32_bf16 v[100:103], v[216:219], a[120:123], v[100:103]
    v_mfma_f32_16x16x32_bf16 v[104:107], v[216:219], a[124:127], v[104:107]
    buffer_load_dwordx4 v[216:219], v2, s[8:11], s26 offen offset:1024 sc1
    v_mfma_f32_16x16x32_bf16 v[76:79], v[220:223], a[128:131], v[76:79]
    v_mfma_f32_16x16x32_bf16 v[80:83], v[220:223], a[132:135], v[80:83]
    v_mfma_f32_16x16x32_bf16 v[84:87], v[220:223], a[136:139], v[84:87]
    v_mfma_f32_16x16x32_bf16 v[88:91], v[220:223], a[140:143], v[88:91]
    buffer_load_dwordx4 v[220:223], v2, s[8:11], s26 offen offset:2048 sc1
    v_mfma_f32_16x16x32_bf16 v[92:95], v[224:227], a[128:131], v[92:95]
    v_mfma_f32_16x16x32_bf16 v[96:99], v[224:227], a[132:135], v[96:99]
    v_mfma_f32_16x16x32_bf16 v[100:103], v[224:227], a[136:139], v[100:103]
    v_mfma_f32_16x16x32_bf16 v[104:107], v[224:227], a[140:143], v[104:107]
    buffer_load_dwordx4 v[224:227], v2, s[8:11], s26 offen offset:3072 sc1
    v_mfma_f32_16x16x32_bf16 v[76:79], v[156:159], a[144:147], v[76:79]
    v_mfma_f32_16x16x32_bf16 v[80:83], v[156:159], a[148:151], v[80:83]
    v_mfma_f32_16x16x32_bf16 v[84:87], v[156:159], a[152:155], v[84:87]
    v_mfma_f32_16x16x32_bf16 v[88:91], v[156:159], a[156:159], v[88:91]
    s_add_u32 s26, s26, 4096
    buffer_load_dwordx4 v[156:159], v2, s[8:11], s26 offen offset:0 sc1
    s_waitcnt lgkmcnt(3)
    v_mfma_f32_16x16x32_bf16 v[92:95], v[160:163], a[144:147], v[92:95]
    buffer_load_dword v11, v3, s[56:59], s43 offen sc1
    v_mfma_f32_16x16x32_bf16 v[96:99], v[160:163], a[148:151], v[96:99]
    v_mfma_f32_16x16x32_bf16 v[100:103], v[160:163], a[152:155], v[100:103]
    v_mfma_f32_16x16x32_bf16 v[104:107], v[160:163], a[156:159], v[104:107]
    buffer_load_dwordx4 v[160:163], v2, s[8:11], s26 offen offset:1024 sc1
    v_mfma_f32_16x16x32_bf16 v[76:79], v[164:167], a[160:163], v[76:79]
    v_mfma_f32_16x16x32_bf16 v[80:83], v[164:167], a[164:167], v[80:83]
    v_mfma_f32_16x16x32_bf16 v[84:87], v[164:167], a[168:171], v[84:87]
    v_mfma_f32_16x16x32_bf16 v[88:91], v[164:167], a[172:175], v[88:91]
    buffer_load_dwordx4 v[164:167], v2, s[8:11], s26 offen offset:2048 sc1
    s_waitcnt lgkmcnt(2)
    v_mfma_f32_16x16x32_bf16 v[92:95], v[168:171], a[160:163], v[92:95]
    v_mfma_f32_16x16x32_bf16 v[96:99], v[168:171], a[164:167], v[96:99]
    v_mfma_f32_16x16x32_bf16 v[100:103], v[168:171], a[168:171], v[100:103]
    v_mfma_f32_16x16x32_bf16 v[104:107], v[168:171], a[172:175], v[104:107]
    buffer_load_dwordx4 v[168:171], v2, s[8:11], s26 offen offset:3072 sc1
    s_waitcnt vmcnt(16)
    v_mfma_f32_16x16x32_bf16 v[76:79], v[172:175], a[176:179], v[76:79]
    v_mfma_f32_16x16x32_bf16 v[80:83], v[172:175], a[180:183], v[80:83]
    v_mfma_f32_16x16x32_bf16 v[84:87], v[172:175], a[184:187], v[84:87]
    v_mfma_f32_16x16x32_bf16 v[88:91], v[172:175], a[188:191], v[88:91]
    s_add_u32 s26, s26, 4096
    buffer_load_dwordx4 v[172:175], v2, s[8:11], s26 offen offset:0 sc1
    s_waitcnt lgkmcnt(1)
    v_mfma_f32_16x16x32_bf16 v[92:95], v[176:179], a[176:179], v[92:95]
    v_mfma_f32_16x16x32_bf16 v[96:99], v[176:179], a[180:183], v[96:99]
    v_mfma_f32_16x16x32_bf16 v[100:103], v[176:179], a[184:187], v[100:103]
    v_mfma_f32_16x16x32_bf16 v[104:107], v[176:179], a[188:191], v[104:107]
    buffer_load_dwordx4 v[176:179], v2, s[8:11], s26 offen offset:1024 sc1
    v_mfma_f32_16x16x32_bf16 v[76:79], v[180:183], a[192:195], v[76:79]
    v_mfma_f32_16x16x32_bf16 v[80:83], v[180:183], a[196:199], v[80:83]
    v_mfma_f32_16x16x32_bf16 v[84:87], v[180:183], a[200:203], v[84:87]
    v_mfma_f32_16x16x32_bf16 v[88:91], v[180:183], a[204:207], v[88:91]
    buffer_load_dwordx4 v[180:183], v2, s[8:11], s26 offen offset:2048 sc1
    s_waitcnt lgkmcnt(0)
    v_mfma_f32_16x16x32_bf16 v[92:95], v[184:187], a[192:195], v[92:95]
    v_mfma_f32_16x16x32_bf16 v[96:99], v[184:187], a[196:199], v[96:99]
    v_mfma_f32_16x16x32_bf16 v[100:103], v[184:187], a[200:203], v[100:103]
    v_mfma_f32_16x16x32_bf16 v[104:107], v[184:187], a[204:207], v[104:107]
    buffer_load_dwordx4 v[184:187], v2, s[8:11], s26 offen offset:3072 sc1
    s_waitcnt vmcnt(16)
    v_mfma_f32_16x16x32_bf16 v[76:79], v[188:191], a[208:211], v[76:79]
    v_mfma_f32_16x16x32_bf16 v[80:83], v[188:191], a[212:215], v[80:83]
    v_mfma_f32_16x16x32_bf16 v[84:87], v[188:191], a[216:219], v[84:87]
    v_mfma_f32_16x16x32_bf16 v[88:91], v[188:191], a[220:223], v[88:91]
    s_add_u32 s26, s26, 4096
    buffer_load_dwordx4 v[188:191], v2, s[8:11], s26 offen offset:0 sc1
    v_mfma_f32_16x16x32_bf16 v[92:95], v[192:195], a[208:211], v[92:95]
    v_mfma_f32_16x16x32_bf16 v[96:99], v[192:195], a[212:215], v[96:99]
    v_mfma_f32_16x16x32_bf16 v[100:103], v[192:195], a[216:219], v[100:103]
    v_mfma_f32_16x16x32_bf16 v[104:107], v[192:195], a[220:223], v[104:107]
    buffer_load_dwordx4 v[192:195], v2, s[8:11], s26 offen offset:1024 sc1
    v_mfma_f32_16x16x32_bf16 v[76:79], v[196:199], a[224:227], v[76:79]
    s_waitcnt vmcnt(9)
    v_cmp_le_u32 vcc, 1, v11
    s_nop 0
    v_mfma_f32_16x16x32_bf16 v[80:83], v[196:199], a[228:231], v[80:83]
    s_and_b32 s20, vcc_lo, s22
    s_xor_b32 s20, s20, s27
    s_cmp_lg_u32 s20, s22
    s_cbranch_scc1 L_fchk1
L_fchkb1:
    buffer_load_dwordx4 v[228:231], v2, s[16:19], s34 offen offset:0 sc1
    v_mfma_f32_16x16x32_bf16 v[84:87], v[196:199], a[232:235], v[84:87]
    buffer_load_dwordx4 v[232:235], v2, s[16:19], s34 offen offset:1024 sc1
    buffer_load_dwordx4 v[236:239], v2, s[16:19], s35 offen offset:0 sc1
    v_mfma_f32_16x16x32_bf16 v[88:91], v[196:199], a[236:239], v[88:91]
    buffer_load_dwordx4 v[240:243], v2, s[16:19], s35 offen offset:1024 sc1
    s_mov_b32 s20, 0
    ds_read_b128 v[196:199], v0 offset:4096
    v_mfma_f32_16x16x32_bf16 v[92:95], v[200:203], a[224:227], v[92:95]
    buffer_load_dword v140, v244, s[16:19], s20 offen sc1
    s_mov_b32 s20, 8192
    v_mfma_f32_16x16x32_bf16 v[96:99], v[200:203], a[228:231], v[96:99]
    buffer_load_dword v141, v244, s[16:19], s20 offen sc1
    s_mov_b32 s20, 16384
    v_mfma_f32_16x16x32_bf16 v[100:103], v[200:203], a[232:235], v[100:103]
    buffer_load_dword v142, v244, s[16:19], s20 offen sc1
    s_mov_b32 s20, 24576
    v_mfma_f32_16x16x32_bf16 v[104:107], v[200:203], a[236:239], v[104:107]
    buffer_load_dword v143, v244, s[16:19], s20 offen sc1
    s_mov_b32 s20, 32768
    buffer_load_dwordx4 v[200:203], v2, s[8:11], s26 offen offset:3072 sc1
    v_mfma_f32_16x16x32_bf16 v[76:79], v[204:207], a[240:243], v[76:79]
    buffer_load_dword v144, v244, s[16:19], s20 offen sc1
    s_mov_b32 s20, 40960
    v_mfma_f32_16x16x32_bf16 v[80:83], v[204:207], a[244:247], v[80:83]
    buffer_load_dword v145, v244, s[16:19], s20 offen sc1
    s_mov_b32 s20, 49152
    v_mfma_f32_16x16x32_bf16 v[84:87], v[204:207], a[248:251], v[84:87]
    buffer_load_dword v146, v244, s[16:19], s20 offen sc1
    s_mov_b32 s20, 57344
    v_mfma_f32_16x16x32_bf16 v[88:91], v[204:207], a[252:255], v[88:91]
    buffer_load_dword v147, v244, s[16:19], s20 offen sc1
    buffer_load_dword v148, v247, s[12:15], 0 offen sc1
    s_add_u32 s26, s26, 4096
    ds_read_b128 v[204:207], v0 offset:5120
    v_mfma_f32_16x16x32_bf16 v[92:95], v[208:211], a[240:243], v[92:95]
    v_mfma_f32_16x16x32_bf16 v[96:99], v[208:211], a[244:247], v[96:99]
    v_mfma_f32_16x16x32_bf16 v[100:103], v[208:211], a[248:251], v[100:103]
    v_mfma_f32_16x16x32_bf16 v[104:107], v[208:211], a[252:255], v[104:107]
    buffer_load_dwordx4 v[208:211], v2, s[8:11], s26 offen offset:1024 sc1
    v_mfma_f32_16x16x32_bf16 v[76:79], v[212:215], v[12:15], v[76:79]
    v_mfma_f32_16x16x32_bf16 v[80:83], v[212:215], v[16:19], v[80:83]
    v_mfma_f32_16x16x32_bf16 v[84:87], v[212:215], v[20:23], v[84:87]
    v_mfma_f32_16x16x32_bf16 v[88:91], v[212:215], v[24:27], v[88:91]
    ds_read_b128 v[212:215], v0 offset:6144
    v_mfma_f32_16x16x32_bf16 v[92:95], v[216:219], v[12:15], v[92:95]
    v_mfma_f32_16x16x32_bf16 v[96:99], v[216:219], v[16:19], v[96:99]
    v_mfma_f32_16x16x32_bf16 v[100:103], v[216:219], v[20:23], v[100:103]
    v_mfma_f32_16x16x32_bf16 v[104:107], v[216:219], v[24:27], v[104:107]
    buffer_load_dwordx4 v[216:219], v2, s[8:11], s26 offen offset:3072 sc1
    v_mfma_f32_16x16x32_bf16 v[76:79], v[220:223], v[28:31], v[76:79]
    v_mfma_f32_16x16x32_bf16 v[80:83], v[220:223], v[32:35], v[80:83]
    v_mfma_f32_16x16x32_bf16 v[84:87], v[220:223], v[36:39], v[84:87]
    v_mfma_f32_16x16x32_bf16 v[88:91], v[220:223], v[40:43], v[88:91]
    s_add_u32 s26, s26, 4096
    ds_read_b128 v[220:223], v0 offset:7168
    v_mfma_f32_16x16x32_bf16 v[92:95], v[224:227], v[28:31], v[92:95]
    v_mfma_f32_16x16x32_bf16 v[96:99], v[224:227], v[32:35], v[96:99]
    v_mfma_f32_16x16x32_bf16 v[100:103], v[224:227], v[36:39], v[100:103]
    v_mfma_f32_16x16x32_bf16 v[104:107], v[224:227], v[40:43], v[104:107]
    buffer_load_dwordx4 v[224:227], v2, s[8:11], s26 offen offset:1024 sc1
    v_mfma_f32_16x16x32_bf16 v[44:47], v[156:159], a[0:3], 0
    v_mfma_f32_16x16x32_bf16 v[48:51], v[156:159], a[4:7], 0
    v_mfma_f32_16x16x32_bf16 v[52:55], v[156:159], a[8:11], 0
    v_mfma_f32_16x16x32_bf16 v[56:59], v[156:159], a[12:15], 0
    ds_read_b128 v[156:159], v0 offset:8192
    s_waitcnt vmcnt(22)
    v_mfma_f32_16x16x32_bf16 v[60:63], v[160:163], a[0:3], 0
    v_mfma_f32_16x16x32_bf16 v[64:67], v[160:163], a[4:7], 0
    v_mfma_f32_16x16x32_bf16 v[68:71], v[160:163], a[8:11], 0
    v_mfma_f32_16x16x32_bf16 v[72:75], v[160:163], a[12:15], 0
    buffer_load_dwordx4 v[160:163], v2, s[8:11], s26 offen offset:3072 sc1
    v_mfma_f32_16x16x32_bf16 v[44:47], v[164:167], a[16:19], v[44:47]
    s_waitcnt vmcnt(14)
    v_mfma_f32_16x16x32_bf16 v[76:79], v[6:9], v[228:231], v[76:79]
    v_mfma_f32_16x16x32_bf16 v[48:51], v[164:167], a[20:23], v[48:51]
    v_mfma_f32_16x16x32_bf16 v[80:83], v[4:7], v[228:231], v[80:83]
    v_mfma_f32_16x16x32_bf16 v[52:55], v[164:167], a[24:27], v[52:55]
    v_mfma_f32_16x16x32_bf16 v[84:87], v[6:9], v[232:235], v[84:87]
    v_mfma_f32_16x16x32_bf16 v[56:59], v[164:167], a[28:31], v[56:59]
    v_mfma_f32_16x16x32_bf16 v[88:91], v[4:7], v[232:235], v[88:91]
    s_add_u32 s26, s26, 4096
    buffer_load_dwordx4 v[164:167], v2, s[8:11], s26 offen offset:0 sc1
    v_mfma_f32_16x16x32_bf16 v[60:63], v[168:171], a[16:19], v[60:63]
    v_mfma_f32_16x16x32_bf16 v[92:95], v[6:9], v[236:239], v[92:95]
    v_mfma_f32_16x16x32_bf16 v[64:67], v[168:171], a[20:23], v[64:67]
    v_mfma_f32_16x16x32_bf16 v[96:99], v[4:7], v[236:239], v[96:99]
    v_mfma_f32_16x16x32_bf16 v[68:71], v[168:171], a[24:27], v[68:71]
    v_mfma_f32_16x16x32_bf16 v[100:103], v[6:9], v[240:243], v[100:103]
    v_mfma_f32_16x16x32_bf16 v[72:75], v[168:171], a[28:31], v[72:75]
    v_mfma_f32_16x16x32_bf16 v[104:107], v[4:7], v[240:243], v[104:107]
    ds_read_b128 v[168:171], v0 offset:9216
    v_mfma_f32_16x16x32_bf16 v[44:47], v[172:175], a[32:35], v[44:47]
    v_cvt_pk_bf16_f32 v76, v76, v77
    v_cvt_pk_bf16_f32 v77, v78, v79
    v_mfma_f32_16x16x32_bf16 v[48:51], v[172:175], a[36:39], v[48:51]
    v_cvt_pk_bf16_f32 v78, v80, v81
    v_cvt_pk_bf16_f32 v79, v82, v83
    v_mfma_f32_16x16x32_bf16 v[52:55], v[172:175], a[40:43], v[52:55]
    buffer_store_dwordx4 v[76:79], v2, s[16:19], s34 offen offset:0
    v_cvt_pk_bf16_f32 v84, v84, v85
    v_mfma_f32_16x16x32_bf16 v[56:59], v[172:175], a[44:47], v[56:59]
    v_cvt_pk_bf16_f32 v85, v86, v87
    v_cvt_pk_bf16_f32 v86, v88, v89
    buffer_load_dwordx4 v[172:175], v2, s[8:11], s26 offen offset:2048 sc1
    v_mfma_f32_16x16x32_bf16 v[60:63], v[176:179], a[32:35], v[60:63]
    v_cvt_pk_bf16_f32 v87, v90, v91
    buffer_store_dwordx4 v[84:87], v2, s[16:19], s34 offen offset:1024
    v_mfma_f32_16x16x32_bf16 v[64:67], v[176:179], a[36:39], v[64:67]
    v_cvt_pk_bf16_f32 v92, v92, v93
    v_cvt_pk_bf16_f32 v93, v94, v95
    v_mfma_f32_16x16x32_bf16 v[68:71], v[176:179], a[40:43], v[68:71]
    v_cvt_pk_bf16_f32 v94, v96, v97
    v_cvt_pk_bf16_f32 v95, v98, v99
    v_mfma_f32_16x16x32_bf16 v[72:75], v[176:179], a[44:47], v[72:75]
    buffer_store_dwordx4 v[92:95], v2, s[16:19], s35 offen offset:0
    v_cvt_pk_bf16_f32 v100, v100, v101
    ds_read_b128 v[176:179], v0 offset:10240
    v_mfma_f32_16x16x32_bf16 v[44:47], v[180:183], a[48:51], v[44:47]
    v_cvt_pk_bf16_f32 v101, v102, v103
    v_cvt_pk_bf16_f32 v102, v104, v105
    v_mfma_f32_16x16x32_bf16 v[48:51], v[180:183], a[52:55], v[48:51]
    v_cvt_pk_bf16_f32 v103, v106, v107
    buffer_store_dwordx4 v[100:103], v2, s[16:19], s35 offen offset:1024
    v_mfma_f32_16x16x32_bf16 v[52:55], v[180:183], a[56:59], v[52:55]
    v_mfma_f32_16x16x32_bf16 v[56:59], v[180:183], a[60:63], v[56:59]
    s_add_u32 s26, s26, 4096
    buffer_load_dwordx4 v[180:183], v2, s[8:11], s26 offen offset:0 sc1
    v_mfma_f32_16x16x32_bf16 v[60:63], v[184:187], a[48:51], v[60:63]
    v_mfma_f32_16x16x32_bf16 v[64:67], v[184:187], a[52:55], v[64:67]
    v_mfma_f32_16x16x32_bf16 v[68:71], v[184:187], a[56:59], v[68:71]
    v_mfma_f32_16x16x32_bf16 v[72:75], v[184:187], a[60:63], v[72:75]
    ds_read_b128 v[184:187], v0 offset:11264
    v_mfma_f32_16x16x32_bf16 v[44:47], v[188:191], a[64:67], v[44:47]
    s_waitcnt vmcnt(11)
    v_lshlrev_b32 v150, 16, v148
    v_mfma_f32_16x16x32_bf16 v[48:51], v[188:191], a[68:71], v[48:51]
    v_and_b32 v151, 0xffff0000, v148
    v_lshlrev_b32 v152, 16, v140
    v_mfma_f32_16x16x32_bf16 v[52:55], v[188:191], a[72:75], v[52:55]
    v_and_b32 v153, 0xffff0000, v140
    v_add_f32 v150, v150, v152
    v_mfma_f32_16x16x32_bf16 v[56:59], v[188:191], a[76:79], v[56:59]
    v_add_f32 v151, v151, v153
    v_lshlrev_b32 v152, 16, v141
    buffer_load_dwordx4 v[188:191], v2, s[8:11], s26 offen offset:2048 sc1
    v_mfma_f32_16x16x32_bf16 v[60:63], v[192:195], a[64:67], v[60:63]
    v_and_b32 v153, 0xffff0000, v141
    v_add_f32 v150, v150, v152
    v_mfma_f32_16x16x32_bf16 v[64:67], v[192:195], a[68:71], v[64:67]
    v_add_f32 v151, v151, v153
    v_lshlrev_b32 v152, 16, v142
    v_mfma_f32_16x16x32_bf16 v[68:71], v[192:195], a[72:75], v[68:71]
    v_and_b32 v153, 0xffff0000, v142
    v_add_f32 v150, v150, v152
    v_mfma_f32_16x16x32_bf16 v[72:75], v[192:195], a[76:79], v[72:75]
    v_add_f32 v151, v151, v153
    v_lshlrev_b32 v152, 16, v143
    buffer_load_dwordx4 v[192:195], v2, s[8:11], s26 offen offset:3072 sc1
    s_waitcnt lgkmcnt(7)
    v_mfma_f32_16x16x32_bf16 v[44:47], v[196:199], a[80:83], v[44:47]
    v_and_b32 v153, 0xffff0000, v143
    v_add_f32 v150, v150, v152
    v_mfma_f32_16x16x32_bf16 v[48:51], v[196:199], a[84:87], v[48:51]
    v_add_f32 v151, v151, v153
    v_lshlrev_b32 v152, 16, v144
    v_mfma_f32_16x16x32_bf16 v[52:55], v[196:199], a[88:91], v[52:55]
    v_and_b32 v153, 0xffff0000, v144
    v_add_f32 v150, v150, v152
    v_mfma_f32_16x16x32_bf16 v[56:59], v[196:199], a[92:95], v[56:59]
    v_add_f32 v151, v151, v153
    v_lshlrev_b32 v152, 16, v145
    s_add_u32 s26, s26, 4096
    buffer_load_dwordx4 v[196:199], v2, s[8:11], s26 offen offset:0 sc1
    v_mfma_f32_16x16x32_bf16 v[60:63], v[200:203], a[80:83], v[60:63]
    v_and_b32 v153, 0xffff0000, v145
    v_add_f32 v150, v150, v152
    v_mfma_f32_16x16x32_bf16 v[64:67], v[200:203], a[84:87], v[64:67]
    v_add_f32 v151, v151, v153
    v_lshlrev_b32 v152, 16, v146
    v_mfma_f32_16x16x32_bf16 v[68:71], v[200:203], a[88:91], v[68:71]
    v_and_b32 v153, 0xffff0000, v146
    v_add_f32 v150, v150, v152
    v_mfma_f32_16x16x32_bf16 v[72:75], v[200:203], a[92:95], v[72:75]
    v_add_f32 v151, v151, v153
    v_lshlrev_b32 v152, 16, v147
    buffer_load_dwordx4 v[200:203], v2, s[8:11], s26 offen offset:1024 sc1
    s_waitcnt lgkmcnt(6)
    v_mfma_f32_16x16x32_bf16 v[44:47], v[204:207], a[96:99], v[44:47]
    v_and_b32 v153, 0xffff0000, v147
    v_add_f32 v150, v150, v152
    v_mfma_f32_16x16x32_bf16 v[48:51], v[204:207], a[100:103], v[48:51]
    v_add_f32 v151, v151, v153
    v_cvt_pk_bf16_f32 v150, v150, v151
    v_mfma_f32_16x16x32_bf16 v[52:55], v[204:207], a[104:107], v[52:55]
    buffer_store_dword v150, v248, s[28:31], 0 offen
    v_mfma_f32_16x16x32_bf16 v[56:59], v[204:207], a[108:111], v[56:59]
    buffer_load_dwordx4 v[204:207], v2, s[8:11], s26 offen offset:2048 sc1
    s_waitcnt vmcnt(15)
    v_mfma_f32_16x16x32_bf16 v[60:63], v[208:211], a[96:99], v[60:63]
    v_mfma_f32_16x16x32_bf16 v[64:67], v[208:211], a[100:103], v[64:67]
    v_mfma_f32_16x16x32_bf16 v[68:71], v[208:211], a[104:107], v[68:71]
    v_mfma_f32_16x16x32_bf16 v[72:75], v[208:211], a[108:111], v[72:75]
    buffer_load_dwordx4 v[208:211], v2, s[8:11], s26 offen offset:3072 sc1
    s_waitcnt lgkmcnt(5)
    v_mfma_f32_16x16x32_bf16 v[44:47], v[212:215], a[112:115], v[44:47]
    v_mfma_f32_16x16x32_bf16 v[48:51], v[212:215], a[116:119], v[48:51]
    v_mfma_f32_16x16x32_bf16 v[52:55], v[212:215], a[120:123], v[52:55]
    v_mfma_f32_16x16x32_bf16 v[56:59], v[212:215], a[124:127], v[56:59]
    s_add_u32 s26, s26, 4096
    buffer_load_dwordx4 v[212:215], v2, s[8:11], s26 offen offset:0 sc1
    v_mfma_f32_16x16x32_bf16 v[60:63], v[216:219], a[112:115], v[60:63]
    v_mov_b32 v254, 2
    s_waitcnt vmcnt(9)
    s_mov_b64 exec, 1
    s_cmp_lg_u32 s45, 1
    s_cbranch_scc1 L_fsig2
    buffer_store_dword v254, off, s[56:59], s55
L_fsigb2:
    s_mov_b64 exec, -1
    v_mfma_f32_16x16x32_bf16 v[64:67], v[216:219], a[116:119], v[64:67]
    v_mfma_f32_16x16x32_bf16 v[68:71], v[216:219], a[120:123], v[68:71]
    v_mfma_f32_16x16x32_bf16 v[72:75], v[216:219], a[124:127], v[72:75]
    buffer_load_dwordx4 v[216:219], v2, s[8:11], s26 offen offset:1024 sc1
    s_waitcnt lgkmcnt(4)
    v_mfma_f32_16x16x32_bf16 v[44:47], v[220:223], a[128:131], v[44:47]
    v_mfma_f32_16x16x32_bf16 v[48:51], v[220:223], a[132:135], v[48:51]
    v_mfma_f32_16x16x32_bf16 v[52:55], v[220:223], a[136:139], v[52:55]
    v_mfma_f32_16x16x32_bf16 v[56:59], v[220:223], a[140:143], v[56:59]
    buffer_load_dwordx4 v[220:223], v2, s[8:11], s26 offen offset:2048 sc1
    v_mfma_f32_16x16x32_bf16 v[60:63], v[224:227], a[128:131], v[60:63]
    v_mfma_f32_16x16x32_bf16 v[64:67], v[224:227], a[132:135], v[64:67]
    v_mfma_f32_16x16x32_bf16 v[68:71], v[224:227], a[136:139], v[68:71]
    v_mfma_f32_16x16x32_bf16 v[72:75], v[224:227], a[140:143], v[72:75]
    buffer_load_dwordx4 v[224:227], v2, s[8:11], s26 offen offset:3072 sc1
    s_waitcnt lgkmcnt(3)
    v_mfma_f32_16x16x32_bf16 v[44:47], v[156:159], a[144:147], v[44:47]
    v_mfma_f32_16x16x32_bf16 v[48:51], v[156:159], a[148:151], v[48:51]
    v_mfma_f32_16x16x32_bf16 v[52:55], v[156:159], a[152:155], v[52:55]
    v_mfma_f32_16x16x32_bf16 v[56:59], v[156:159], a[156:159], v[56:59]
    s_add_u32 s26, s26, 4096
    buffer_load_dwordx4 v[156:159], v2, s[8:11], s26 offen offset:0 sc1
    v_mfma_f32_16x16x32_bf16 v[60:63], v[160:163], a[144:147], v[60:63]
    buffer_load_dword v11, v3, s[56:59], s43 offen sc1
    v_mfma_f32_16x16x32_bf16 v[64:67], v[160:163], a[148:151], v[64:67]
    v_mfma_f32_16x16x32_bf16 v[68:71], v[160:163], a[152:155], v[68:71]
    v_mfma_f32_16x16x32_bf16 v[72:75], v[160:163], a[156:159], v[72:75]
    buffer_load_dwordx4 v[160:163], v2, s[8:11], s26 offen offset:1024 sc1
    v_mfma_f32_16x16x32_bf16 v[44:47], v[164:167], a[160:163], v[44:47]
    v_mfma_f32_16x16x32_bf16 v[48:51], v[164:167], a[164:167], v[48:51]
    v_mfma_f32_16x16x32_bf16 v[52:55], v[164:167], a[168:171], v[52:55]
    v_mfma_f32_16x16x32_bf16 v[56:59], v[164:167], a[172:175], v[56:59]
    buffer_load_dwordx4 v[164:167], v2, s[8:11], s26 offen offset:2048 sc1
    s_waitcnt lgkmcnt(2)
    v_mfma_f32_16x16x32_bf16 v[60:63], v[168:171], a[160:163], v[60:63]
    v_mfma_f32_16x16x32_bf16 v[64:67], v[168:171], a[164:167], v[64:67]
    v_mfma_f32_16x16x32_bf16 v[68:71], v[168:171], a[168:171], v[68:71]
    v_mfma_f32_16x16x32_bf16 v[72:75], v[168:171], a[172:175], v[72:75]
    buffer_load_dwordx4 v[168:171], v2, s[8:11], s26 offen offset:3072 sc1
    v_mfma_f32_16x16x32_bf16 v[44:47], v[172:175], a[176:179], v[44:47]
    v_mfma_f32_16x16x32_bf16 v[48:51], v[172:175], a[180:183], v[48:51]
    v_mfma_f32_16x16x32_bf16 v[52:55], v[172:175], a[184:187], v[52:55]
    v_mfma_f32_16x16x32_bf16 v[56:59], v[172:175], a[188:191], v[56:59]
    s_add_u32 s26, s26, 4096
    buffer_load_dwordx4 v[172:175], v2, s[8:11], s26 offen offset:0 sc1
    s_waitcnt lgkmcnt(1)
    v_mfma_f32_16x16x32_bf16 v[60:63], v[176:179], a[176:179], v[60:63]
    v_mfma_f32_16x16x32_bf16 v[64:67], v[176:179], a[180:183], v[64:67]
    v_mfma_f32_16x16x32_bf16 v[68:71], v[176:179], a[184:187], v[68:71]
    v_mfma_f32_16x16x32_bf16 v[72:75], v[176:179], a[188:191], v[72:75]
    buffer_load_dwordx4 v[176:179], v2, s[8:11], s26 offen offset:1024 sc1
    s_waitcnt vmcnt(17)
    v_mfma_f32_16x16x32_bf16 v[44:47], v[180:183], a[192:195], v[44:47]
    v_mfma_f32_16x16x32_bf16 v[48:51], v[180:183], a[196:199], v[48:51]
    v_mfma_f32_16x16x32_bf16 v[52:55], v[180:183], a[200:203], v[52:55]
    v_mfma_f32_16x16x32_bf16 v[56:59], v[180:183], a[204:207], v[56:59]
    buffer_load_dwordx4 v[180:183], v2, s[8:11], s26 offen offset:2048 sc1
    s_waitcnt lgkmcnt(0)
    v_mfma_f32_16x16x32_bf16 v[60:63], v[184:187], a[192:195], v[60:63]
    v_mfma_f32_16x16x32_bf16 v[64:67], v[184:187], a[196:199], v[64:67]
    v_mfma_f32_16x16x32_bf16 v[68:71], v[184:187], a[200:203], v[68:71]
    v_mfma_f32_16x16x32_bf16 v[72:75], v[184:187], a[204:207], v[72:75]
    buffer_load_dwordx4 v[184:187], v2, s[8:11], s26 offen offset:3072 sc1
    v_mfma_f32_16x16x32_bf16 v[44:47], v[188:191], a[208:211], v[44:47]
    v_mfma_f32_16x16x32_bf16 v[48:51], v[188:191], a[212:215], v[48:51]
    v_mfma_f32_16x16x32_bf16 v[52:55], v[188:191], a[216:219], v[52:55]
    v_mfma_f32_16x16x32_bf16 v[56:59], v[188:191], a[220:223], v[56:59]
    s_add_u32 s26, s26, 4096
    buffer_load_dwordx4 v[188:191], v2, s[8:11], s26 offen offset:0 sc1
    v_mfma_f32_16x16x32_bf16 v[60:63], v[192:195], a[208:211], v[60:63]
    v_mfma_f32_16x16x32_bf16 v[64:67], v[192:195], a[212:215], v[64:67]
    v_mfma_f32_16x16x32_bf16 v[68:71], v[192:195], a[216:219], v[68:71]
    v_mfma_f32_16x16x32_bf16 v[72:75], v[192:195], a[220:223], v[72:75]
    buffer_load_dwordx4 v[192:195], v2, s[8:11], s26 offen offset:1024 sc1
    s_waitcnt vmcnt(16)
    v_mfma_f32_16x16x32_bf16 v[44:47], v[196:199], a[224:227], v[44:47]
    s_waitcnt vmcnt(9)
    v_cmp_le_u32 vcc, 2, v11
    s_nop 0
    v_mfma_f32_16x16x32_bf16 v[48:51], v[196:199], a[228:231], v[48:51]
    s_and_b32 s20, vcc_lo, s23
    s_xor_b32 s20, s20, s27
    s_cmp_lg_u32 s20, s23
    s_cbranch_scc1 L_fchk2
L_fchkb2:
    buffer_load_dwordx4 v[228:231], v2, s[16:19], s36 offen offset:0 sc1
    v_mfma_f32_16x16x32_bf16 v[52:55], v[196:199], a[232:235], v[52:55]
    buffer_load_dwordx4 v[232:235], v2, s[16:19], s36 offen offset:1024 sc1
    buffer_load_dwordx4 v[236:239], v2, s[16:19], s37 offen offset:0 sc1
    v_mfma_f32_16x16x32_bf16 v[56:59], v[196:199], a[236:239], v[56:59]
    buffer_load_dwordx4 v[240:243], v2, s[16:19], s37 offen offset:1024 sc1
    ds_read_b128 v[196:199], v0 offset:12288
    v_mfma_f32_16x16x32_bf16 v[60:63], v[200:203], a[224:227], v[60:63]
    v_mfma_f32_16x16x32_bf16 v[64:67], v[200:203], a[228:231], v[64:67]
    v_mfma_f32_16x16x32_bf16 v[68:71], v[200:203], a[232:235], v[68:71]
    v_mfma_f32_16x16x32_bf16 v[72:75], v[200:203], a[236:239], v[72:75]
    buffer_load_dwordx4 v[200:203], v2, s[8:11], s26 offen offset:3072 sc1
    v_mfma_f32_16x16x32_bf16 v[44:47], v[204:207], a[240:243], v[44:47]
    v_mfma_f32_16x16x32_bf16 v[48:51], v[204:207], a[244:247], v[48:51]
    v_mfma_f32_16x16x32_bf16 v[52:55], v[204:207], a[248:251], v[52:55]
    v_mfma_f32_16x16x32_bf16 v[56:59], v[204:207], a[252:255], v[56:59]
    s_add_u32 s26, s26, 4096
    ds_read_b128 v[204:207], v0 offset:13312
    v_mfma_f32_16x16x32_bf16 v[60:63], v[208:211], a[240:243], v[60:63]
    buffer_load_dwordx4 v[76:79], v2, s[12:15], s50 offen sc1
    s_add_u32 s50, s50, 18432
    v_mfma_f32_16x16x32_bf16 v[64:67], v[208:211], a[244:247], v[64:67]
    buffer_load_dwordx4 v[80:83], v2, s[12:15], s50 offen sc1
    s_add_u32 s50, s50, 18432
    v_mfma_f32_16x16x32_bf16 v[68:71], v[208:211], a[248:251], v[68:71]
    buffer_load_dwordx4 v[84:87], v2, s[12:15], s50 offen sc1
    s_add_u32 s50, s50, 18432
    v_mfma_f32_16x16x32_bf16 v[72:75], v[208:211], a[252:255], v[72:75]
    buffer_load_dwordx4 v[88:91], v2, s[12:15], s50 offen sc1
    s_add_u32 s50, s50, 18432
    buffer_load_dwordx4 v[208:211], v2, s[8:11], s26 offen offset:1024 sc1
    v_mfma_f32_16x16x32_bf16 v[44:47], v[212:215], v[12:15], v[44:47]
    v_mfma_f32_16x16x32_bf16 v[48:51], v[212:215], v[16:19], v[48:51]
    v_mfma_f32_16x16x32_bf16 v[52:55], v[212:215], v[20:23], v[52:55]
    v_mfma_f32_16x16x32_bf16 v[56:59], v[212:215], v[24:27], v[56:59]
    ds_read_b128 v[212:215], v0 offset:14336
    v_mfma_f32_16x16x32_bf16 v[60:63], v[216:219], v[12:15], v[60:63]
    v_mfma_f32_16x16x32_bf16 v[64:67], v[216:219], v[16:19], v[64:67]
    v_mfma_f32_16x16x32_bf16 v[68:71], v[216:219], v[20:23], v[68:71]
    v_mfma_f32_16x16x32_bf16 v[72:75], v[216:219], v[24:27], v[72:75]
    buffer_load_dwordx4 v[216:219], v2, s[8:11], s26 offen offset:3072 sc1
    v_mfma_f32_16x16x32_bf16 v[44:47], v[220:223], v[28:31], v[44:47]
    v_mfma_f32_16x16x32_bf16 v[48:51], v[220:223], v[32:35], v[48:51]
    v_mfma_f32_16x16x32_bf16 v[52:55], v[220:223], v[36:39], v[52:55]
    v_mfma_f32_16x16x32_bf16 v[56:59], v[220:223], v[40:43], v[56:59]
    s_add_u32 s26, s26, 4096
    ds_read_b128 v[220:223], v0 offset:15360
    v_mfma_f32_16x16x32_bf16 v[60:63], v[224:227], v[28:31], v[60:63]
    v_mfma_f32_16x16x32_bf16 v[64:67], v[224:227], v[32:35], v[64:67]
    v_mfma_f32_16x16x32_bf16 v[68:71], v[224:227], v[36:39], v[68:71]
    v_mfma_f32_16x16x32_bf16 v[72:75], v[224:227], v[40:43], v[72:75]
    buffer_load_dwordx4 v[224:227], v2, s[8:11], s26 offen offset:1024 sc1
    v_mfma_f32_16x16x32_bf16 v[108:111], v[156:159], a[0:3], 0
    v_mfma_f32_16x16x32_bf16 v[112:115], v[156:159], a[4:7], 0
    v_mfma_f32_16x16x32_bf16 v[116:119], v[156:159], a[8:11], 0
    v_mfma_f32_16x16x32_bf16 v[120:123], v[156:159], a[12:15], 0
    buffer_load_dwordx4 v[156:159], v2, s[8:11], s26 offen offset:2048 sc1
    s_waitcnt vmcnt(18)
    v_mfma_f32_16x16x32_bf16 v[108:111], v[160:163], a[16:19], v[108:111]
    v_mfma_f32_16x16x32_bf16 v[112:115], v[160:163], a[20:23], v[112:115]
    v_mfma_f32_16x16x32_bf16 v[116:119], v[160:163], a[24:27], v[116:119]
    v_mfma_f32_16x16x32_bf16 v[120:123], v[160:163], a[28:31], v[120:123]
    buffer_load_dwordx4 v[160:163], v2, s[8:11], s26 offen offset:3072 sc1
    v_mfma_f32_16x16x32_bf16 v[108:111], v[164:167], a[32:35], v[108:111]
    s_waitcnt vmcnt(10)
    v_mfma_f32_16x16x32_bf16 v[44:47], v[6:9], v[228:231], v[44:47]
    v_mfma_f32_16x16x32_bf16 v[112:115], v[164:167], a[36:39], v[112:115]
    v_mfma_f32_16x16x32_bf16 v[48:51], v[4:7], v[228:231], v[48:51]
    v_mfma_f32_16x16x32_bf16 v[116:119], v[164:167], a[40:43], v[116:119]
    v_mfma_f32_16x16x32_bf16 v[52:55], v[6:9], v[232:235], v[52:55]
    v_mfma_f32_16x16x32_bf16 v[120:123], v[164:167], a[44:47], v[120:123]
    v_mfma_f32_16x16x32_bf16 v[56:59], v[4:7], v[232:235], v[56:59]
    s_add_u32 s26, s26, 4096
    buffer_load_dwordx4 v[164:167], v2, s[8:11], s26 offen offset:0 sc1
    v_mfma_f32_16x16x32_bf16 v[108:111], v[168:171], a[48:51], v[108:111]
    v_mfma_f32_16x16x32_bf16 v[60:63], v[6:9], v[236:239], v[60:63]
    v_mfma_f32_16x16x32_bf16 v[112:115], v[168:171], a[52:55], v[112:115]
    v_mfma_f32_16x16x32_bf16 v[64:67], v[4:7], v[236:239], v[64:67]
    v_mfma_f32_16x16x32_bf16 v[116:119], v[168:171], a[56:59], v[116:119]
    v_mfma_f32_16x16x32_bf16 v[68:71], v[6:9], v[240:243], v[68:71]
    v_mfma_f32_16x16x32_bf16 v[120:123], v[168:171], a[60:63], v[120:123]
    v_mfma_f32_16x16x32_bf16 v[72:75], v[4:7], v[240:243], v[72:75]
    ds_read_b128 v[168:171], v0 offset:16384
    v_mfma_f32_16x16x32_bf16 v[108:111], v[172:175], a[64:67], v[108:111]
    v_cvt_pk_bf16_f32 v44, v44, v45
    v_cvt_pk_bf16_f32 v45, v46, v47
    v_mfma_f32_16x16x32_bf16 v[112:115], v[172:175], a[68:71], v[112:115]
    v_cvt_pk_bf16_f32 v46, v48, v49
    v_cvt_pk_bf16_f32 v47, v50, v51
    v_mfma_f32_16x16x32_bf16 v[116:119], v[172:175], a[72:75], v[116:119]
    buffer_store_dwordx4 v[44:47], v2, s[16:19], s36 offen offset:0
    v_cvt_pk_bf16_f32 v52, v52, v53
    v_mfma_f32_16x16x32_bf16 v[120:123], v[172:175], a[76:79], v[120:123]
    v_cvt_pk_bf16_f32 v53, v54, v55
    v_cvt_pk_bf16_f32 v54, v56, v57
    buffer_load_dwordx4 v[172:175], v2, s[8:11], s26 offen offset:2048 sc1
    v_mfma_f32_16x16x32_bf16 v[108:111], v[176:179], a[80:83], v[108:111]
    v_cvt_pk_bf16_f32 v55, v58, v59
    buffer_store_dwordx4 v[52:55], v2, s[16:19], s36 offen offset:1024
    v_mfma_f32_16x16x32_bf16 v[112:115], v[176:179], a[84:87], v[112:115]
    v_cvt_pk_bf16_f32 v60, v60, v61
    v_cvt_pk_bf16_f32 v61, v62, v63
    v_mfma_f32_16x16x32_bf16 v[116:119], v[176:179], a[88:91], v[116:119]
    v_cvt_pk_bf16_f32 v62, v64, v65
    v_cvt_pk_bf16_f32 v63, v66, v67
    v_mfma_f32_16x16x32_bf16 v[120:123], v[176:179], a[92:95], v[120:123]
    buffer_store_dwordx4 v[60:63], v2, s[16:19], s37 offen offset:0
    v_cvt_pk_bf16_f32 v68, v68, v69
    ds_read_b128 v[176:179], v0 offset:17408
    v_mfma_f32_16x16x32_bf16 v[108:111], v[180:183], a[96:99], v[108:111]
    v_cvt_pk_bf16_f32 v69, v70, v71
    v_cvt_pk_bf16_f32 v70, v72, v73
    v_mfma_f32_16x16x32_bf16 v[112:115], v[180:183], a[100:103], v[112:115]
    v_cvt_pk_bf16_f32 v71, v74, v75
    buffer_store_dwordx4 v[68:71], v2, s[16:19], s37 offen offset:1024
    v_mfma_f32_16x16x32_bf16 v[116:119], v[180:183], a[104:107], v[116:119]
    v_mfma_f32_16x16x32_bf16 v[120:123], v[180:183], a[108:111], v[120:123]
    s_add_u32 s26, s26, 4096
    buffer_load_dwordx4 v[180:183], v2, s[8:11], s26 offen offset:0 sc1
    v_mfma_f32_16x16x32_bf16 v[108:111], v[184:187], a[112:115], v[108:111]
    v_mfma_f32_16x16x32_bf16 v[112:115], v[184:187], a[116:119], v[112:115]
    v_mfma_f32_16x16x32_bf16 v[116:119], v[184:187], a[120:123], v[116:119]
    v_mfma_f32_16x16x32_bf16 v[120:123], v[184:187], a[124:127], v[120:123]
    buffer_load_dwordx4 v[184:187], v2, s[8:11], s26 offen offset:1024 sc1
    v_mfma_f32_16x16x32_bf16 v[108:111], v[188:191], a[128:131], v[108:111]
    v_mfma_f32_16x16x32_bf16 v[112:115], v[188:191], a[132:135], v[112:115]
    v_mfma_f32_16x16x32_bf16 v[116:119], v[188:191], a[136:139], v[116:119]
    v_mfma_f32_16x16x32_bf16 v[120:123], v[188:191], a[140:143], v[120:123]
    buffer_load_dwordx4 v[188:191], v2, s[8:11], s26 offen offset:2048 sc1
    v_mfma_f32_16x16x32_bf16 v[108:111], v[192:195], a[144:147], v[108:111]
    v_mfma_f32_16x16x32_bf16 v[112:115], v[192:195], a[148:151], v[112:115]
    v_mfma_f32_16x16x32_bf16 v[116:119], v[192:195], a[152:155], v[116:119]
    v_mfma_f32_16x16x32_bf16 v[120:123], v[192:195], a[156:159], v[120:123]
    buffer_load_dwordx4 v[192:195], v2, s[8:11], s26 offen offset:3072 sc1
    s_waitcnt lgkmcnt(5)
    v_mfma_f32_16x16x32_bf16 v[108:111], v[196:199], a[160:163], v[108:111]
    v_mfma_f32_16x16x32_bf16 v[112:115], v[196:199], a[164:167], v[112:115]
    v_mfma_f32_16x16x32_bf16 v[116:119], v[196:199], a[168:171], v[116:119]
    v_mfma_f32_16x16x32_bf16 v[120:123], v[196:199], a[172:175], v[120:123]
    s_add_u32 s26, s26, 4096
    buffer_load_dwordx4 v[196:199], v2, s[8:11], s26 offen offset:0 sc1
    s_waitcnt vmcnt(15)
    v_mfma_f32_16x16x32_bf16 v[108:111], v[200:203], a[176:179], v[108:111]
    v_mfma_f32_16x16x32_bf16 v[112:115], v[200:203], a[180:183], v[112:115]
    v_mfma_f32_16x16x32_bf16 v[116:119], v[200:203], a[184:187], v[116:119]
    v_mfma_f32_16x16x32_bf16 v[120:123], v[200:203], a[188:191], v[120:123]
    buffer_load_dwordx4 v[200:203], v2, s[8:11], s26 offen offset:1024 sc1
    s_waitcnt lgkmcnt(4)
    v_mfma_f32_16x16x32_bf16 v[108:111], v[204:207], a[192:195], v[108:111]
    v_mfma_f32_16x16x32_bf16 v[112:115], v[204:207], a[196:199], v[112:115]
    v_mfma_f32_16x16x32_bf16 v[116:119], v[204:207], a[200:203], v[116:119]
    v_mfma_f32_16x16x32_bf16 v[120:123], v[204:207], a[204:207], v[120:123]
    buffer_load_dwordx4 v[204:207], v2, s[8:11], s26 offen offset:2048 sc1
    v_mfma_f32_16x16x32_bf16 v[108:111], v[208:211], a[208:211], v[108:111]
    v_mfma_f32_16x16x32_bf16 v[112:115], v[208:211], a[212:215], v[112:115]
    v_mfma_f32_16x16x32_bf16 v[116:119], v[208:211], a[216:219], v[116:119]
    v_mfma_f32_16x16x32_bf16 v[120:123], v[208:211], a[220:223], v[120:123]
    buffer_load_dwordx4 v[208:211], v2, s[8:11], s26 offen offset:3072 sc1
    s_waitcnt lgkmcnt(3)
    v_mfma_f32_16x16x32_bf16 v[108:111], v[212:215], a[224:227], v[108:111]
    v_mfma_f32_16x16x32_bf16 v[112:115], v[212:215], a[228:231], v[112:115]
    v_mfma_f32_16x16x32_bf16 v[116:119], v[212:215], a[232:235], v[116:119]
    v_mfma_f32_16x16x32_bf16 v[120:123], v[212:215], a[236:239], v[120:123]
    s_add_u32 s26, s26, 4096
    buffer_load_dwordx4 v[212:215], v2, s[8:11], s26 offen offset:0 sc1
    s_waitcnt vmcnt(16)
    v_mfma_f32_16x16x32_bf16 v[108:111], v[216:219], a[240:243], v[108:111]
    v_mov_b32 v254, 3
    s_waitcnt vmcnt(9)
    s_mov_b64 exec, 1
    s_cmp_lg_u32 s45, 1
    s_cbranch_scc1 L_fsig3
    buffer_store_dword v254, off, s[56:59], s55
L_fsigb3:
    s_mov_b64 exec, -1
    v_mfma_f32_16x16x32_bf16 v[112:115], v[216:219], a[244:247], v[112:115]
    v_mfma_f32_16x16x32_bf16 v[116:119], v[216:219], a[248:251], v[116:119]
    v_mfma_f32_16x16x32_bf16 v[120:123], v[216:219], a[252:255], v[120:123]
    buffer_load_dwordx4 v[216:219], v2, s[8:11], s26 offen offset:1024 sc1
    s_waitcnt lgkmcnt(2)
    v_mfma_f32_16x16x32_bf16 v[108:111], v[220:223], v[12:15], v[108:111]
    v_mfma_f32_16x16x32_bf16 v[112:115], v[220:223], v[16:19], v[112:115]
    v_mfma_f32_16x16x32_bf16 v[116:119], v[220:223], v[20:23], v[116:119]
    v_mfma_f32_16x16x32_bf16 v[120:123], v[220:223], v[24:27], v[120:123]
    buffer_load_dwordx4 v[220:223], v2, s[8:11], s26 offen offset:2048 sc1
    v_mfma_f32_16x16x32_bf16 v[108:111], v[224:227], v[28:31], v[108:111]
    v_mfma_f32_16x16x32_bf16 v[112:115], v[224:227], v[32:35], v[112:115]
    v_mfma_f32_16x16x32_bf16 v[116:119], v[224:227], v[36:39], v[116:119]
    v_mfma_f32_16x16x32_bf16 v[120:123], v[224:227], v[40:43], v[120:123]
    buffer_load_dwordx4 v[224:227], v2, s[8:11], s26 offen offset:3072 sc1
    v_mfma_f32_16x16x32_bf16 v[124:127], v[156:159], a[0:3], 0
    v_mfma_f32_16x16x32_bf16 v[128:131], v[156:159], a[4:7], 0
    v_mfma_f32_16x16x32_bf16 v[132:135], v[156:159], a[8:11], 0
    v_mfma_f32_16x16x32_bf16 v[136:139], v[156:159], a[12:15], 0
    v_mfma_f32_16x16x32_bf16 v[124:127], v[160:163], a[16:19], v[124:127]
    v_cvt_pk_bf16_f32 v108, v108, v109
    v_cvt_pk_bf16_f32 v109, v110, v111
    v_mfma_f32_16x16x32_bf16 v[128:131], v[160:163], a[20:23], v[128:131]
    v_cvt_pk_bf16_f32 v110, v112, v113
    v_cvt_pk_bf16_f32 v111, v114, v115
    v_mfma_f32_16x16x32_bf16 v[132:135], v[160:163], a[24:27], v[132:135]
    buffer_store_dwordx4 v[108:111], v245, s[16:19], s41 offen
    v_cvt_pk_bf16_f32 v116, v116, v117
    v_mfma_f32_16x16x32_bf16 v[136:139], v[160:163], a[28:31], v[136:139]
    v_cvt_pk_bf16_f32 v117, v118, v119
    v_cvt_pk_bf16_f32 v118, v120, v121
    v_mfma_f32_16x16x32_bf16 v[124:127], v[164:167], a[32:35], v[124:127]
    v_cvt_pk_bf16_f32 v119, v122, v123
    s_add_u32 s41, s41, 32768
    v_mfma_f32_16x16x32_bf16 v[128:131], v[164:167], a[36:39], v[128:131]
    buffer_store_dwordx4 v[116:119], v245, s[16:19], s41 offen
    v_mfma_f32_16x16x32_bf16 v[132:135], v[164:167], a[40:43], v[132:135]
    v_mfma_f32_16x16x32_bf16 v[136:139], v[164:167], a[44:47], v[136:139]
    s_waitcnt lgkmcnt(1)
    v_mfma_f32_16x16x32_bf16 v[124:127], v[168:171], a[48:51], v[124:127]
    buffer_load_dword v11, v3, s[56:59], s43 offen sc1
    v_mfma_f32_16x16x32_bf16 v[128:131], v[168:171], a[52:55], v[128:131]
    v_mfma_f32_16x16x32_bf16 v[132:135], v[168:171], a[56:59], v[132:135]
    v_mfma_f32_16x16x32_bf16 v[136:139], v[168:171], a[60:63], v[136:139]
    v_mfma_f32_16x16x32_bf16 v[124:127], v[172:175], a[64:67], v[124:127]
    v_mfma_f32_16x16x32_bf16 v[128:131], v[172:175], a[68:71], v[128:131]
    v_mfma_f32_16x16x32_bf16 v[132:135], v[172:175], a[72:75], v[132:135]
    v_mfma_f32_16x16x32_bf16 v[136:139], v[172:175], a[76:79], v[136:139]
    s_waitcnt lgkmcnt(0)
    v_mfma_f32_16x16x32_bf16 v[124:127], v[176:179], a[80:83], v[124:127]
    v_mfma_f32_16x16x32_bf16 v[128:131], v[176:179], a[84:87], v[128:131]
    v_mfma_f32_16x16x32_bf16 v[132:135], v[176:179], a[88:91], v[132:135]
    v_mfma_f32_16x16x32_bf16 v[136:139], v[176:179], a[92:95], v[136:139]
    s_waitcnt vmcnt(12)
    v_mfma_f32_16x16x32_bf16 v[124:127], v[180:183], a[96:99], v[124:127]
    v_mfma_f32_16x16x32_bf16 v[128:131], v[180:183], a[100:103], v[128:131]
    v_mfma_f32_16x16x32_bf16 v[132:135], v[180:183], a[104:107], v[132:135]
    v_mfma_f32_16x16x32_bf16 v[136:139], v[180:183], a[108:111], v[136:139]
    v_mfma_f32_16x16x32_bf16 v[124:127], v[184:187], a[112:115], v[124:127]
    v_mfma_f32_16x16x32_bf16 v[128:131], v[184:187], a[116:119], v[128:131]
    v_mfma_f32_16x16x32_bf16 v[132:135], v[184:187], a[120:123], v[132:135]
    v_mfma_f32_16x16x32_bf16 v[136:139], v[184:187], a[124:127], v[136:139]
    v_mfma_f32_16x16x32_bf16 v[124:127], v[188:191], a[128:131], v[124:127]
    v_mov_b32 v254, 4
    s_waitcnt vmcnt(1)
    s_mov_b64 exec, 1
    s_cmp_lg_u32 s45, 1
    s_cbranch_scc1 L_fsig4
    buffer_store_dword v254, off, s[56:59], s55
L_fsigb4:
    s_mov_b64 exec, -1
    v_mfma_f32_16x16x32_bf16 v[128:131], v[188:191], a[132:135], v[128:131]
    v_mfma_f32_16x16x32_bf16 v[132:135], v[188:191], a[136:139], v[132:135]
    v_mfma_f32_16x16x32_bf16 v[136:139], v[188:191], a[140:143], v[136:139]
    v_mfma_f32_16x16x32_bf16 v[124:127], v[192:195], a[144:147], v[124:127]
    s_waitcnt vmcnt(1)
    v_cmp_le_u32 vcc, 3, v11
    s_nop 0
    v_mfma_f32_16x16x32_bf16 v[128:131], v[192:195], a[148:151], v[128:131]
    s_and_b32 s20, vcc_lo, s24
    s_xor_b32 s20, s20, s27
    s_cmp_lg_u32 s20, s24
    s_cbranch_scc1 L_fchk3
L_fchkb3:
    buffer_load_dwordx4 v[228:231], v2, s[16:19], s38 offen offset:0 sc1
    v_mfma_f32_16x16x32_bf16 v[132:135], v[192:195], a[152:155], v[132:135]
    buffer_load_dwordx4 v[232:235], v2, s[16:19], s38 offen offset:1024 sc1
    buffer_load_dwordx4 v[236:239], v2, s[16:19], s39 offen offset:0 sc1
    v_mfma_f32_16x16x32_bf16 v[136:139], v[192:195], a[156:159], v[136:139]
    buffer_load_dwordx4 v[240:243], v2, s[16:19], s39 offen offset:1024 sc1
    v_mfma_f32_16x16x32_bf16 v[124:127], v[196:199], a[160:163], v[124:127]
    v_mfma_f32_16x16x32_bf16 v[128:131], v[196:199], a[164:167], v[128:131]
    v_mfma_f32_16x16x32_bf16 v[132:135], v[196:199], a[168:171], v[132:135]
    v_mfma_f32_16x16x32_bf16 v[136:139], v[196:199], a[172:175], v[136:139]
    v_mfma_f32_16x16x32_bf16 v[124:127], v[200:203], a[176:179], v[124:127]
    v_mfma_f32_16x16x32_bf16 v[128:131], v[200:203], a[180:183], v[128:131]
    v_mfma_f32_16x16x32_bf16 v[132:135], v[200:203], a[184:187], v[132:135]
    v_mfma_f32_16x16x32_bf16 v[136:139], v[200:203], a[188:191], v[136:139]
    v_mfma_f32_16x16x32_bf16 v[124:127], v[204:207], a[192:195], v[124:127]
    v_mfma_f32_16x16x32_bf16 v[128:131], v[204:207], a[196:199], v[128:131]
    v_mfma_f32_16x16x32_bf16 v[132:135], v[204:207], a[200:203], v[132:135]
    v_mfma_f32_16x16x32_bf16 v[136:139], v[204:207], a[204:207], v[136:139]
    v_mfma_f32_16x16x32_bf16 v[124:127], v[208:211], a[208:211], v[124:127]
    buffer_load_dword v11, v3, s[56:59], s43 offen sc1
    v_mfma_f32_16x16x32_bf16 v[128:131], v[208:211], a[212:215], v[128:131]
    v_mfma_f32_16x16x32_bf16 v[132:135], v[208:211], a[216:219], v[132:135]
    v_mfma_f32_16x16x32_bf16 v[136:139], v[208:211], a[220:223], v[136:139]
    v_mfma_f32_16x16x32_bf16 v[124:127], v[212:215], a[224:227], v[124:127]
    v_mfma_f32_16x16x32_bf16 v[128:131], v[212:215], a[228:231], v[128:131]
    v_mfma_f32_16x16x32_bf16 v[132:135], v[212:215], a[232:235], v[132:135]
    v_mfma_f32_16x16x32_bf16 v[136:139], v[212:215], a[236:239], v[136:139]
    v_mfma_f32_16x16x32_bf16 v[124:127], v[216:219], a[240:243], v[124:127]
    v_mfma_f32_16x16x32_bf16 v[128:131], v[216:219], a[244:247], v[128:131]
    v_mfma_f32_16x16x32_bf16 v[132:135], v[216:219], a[248:251], v[132:135]
    v_mfma_f32_16x16x32_bf16 v[136:139], v[216:219], a[252:255], v[136:139]
    v_mfma_f32_16x16x32_bf16 v[124:127], v[220:223], v[12:15], v[124:127]
    v_mfma_f32_16x16x32_bf16 v[128:131], v[220:223], v[16:19], v[128:131]
    v_mfma_f32_16x16x32_bf16 v[132:135], v[220:223], v[20:23], v[132:135]
    v_mfma_f32_16x16x32_bf16 v[136:139], v[220:223], v[24:27], v[136:139]
    v_mfma_f32_16x16x32_bf16 v[124:127], v[224:227], v[28:31], v[124:127]
    v_mfma_f32_16x16x32_bf16 v[128:131], v[224:227], v[32:35], v[128:131]
    v_mfma_f32_16x16x32_bf16 v[132:135], v[224:227], v[36:39], v[132:135]
    v_mfma_f32_16x16x32_bf16 v[136:139], v[224:227], v[40:43], v[136:139]
    s_waitcnt vmcnt(0)
    v_cmp_le_u32 vcc, 4, v11
    s_nop 0
    s_and_b32 s20, vcc_lo, s25
    s_xor_b32 s20, s20, s27
    s_cmp_lg_u32 s20, s25
    s_cbranch_scc1 L_fchk4
L_fchkb4:
    buffer_load_dwordx4 v[92:95], v245, s[16:19], s42 offen sc1
    s_add_u32 s42, s42, 32768
    buffer_load_dwordx4 v[96:99], v245, s[16:19], s42 offen sc1
    v_mfma_f32_16x16x32_bf16 v[124:127], v[250:253], v[76:79], v[124:127]
    v_mfma_f32_16x16x32_bf16 v[128:131], v[250:253], v[80:83], v[128:131]
    v_mfma_f32_16x16x32_bf16 v[132:135], v[250:253], v[84:87], v[132:135]
    v_mfma_f32_16x16x32_bf16 v[136:139], v[250:253], v[88:91], v[136:139]
    v_mfma_f32_16x16x32_bf16 v[124:127], v[6:9], v[228:231], v[124:127]
    v_mfma_f32_16x16x32_bf16 v[128:131], v[4:7], v[228:231], v[128:131]
    v_mfma_f32_16x16x32_bf16 v[132:135], v[6:9], v[232:235], v[132:135]
    v_mfma_f32_16x16x32_bf16 v[136:139], v[4:7], v[232:235], v[136:139]
    v_mfma_f32_16x16x32_bf16 v[124:127], v[6:9], v[236:239], v[124:127]
    v_mfma_f32_16x16x32_bf16 v[128:131], v[4:7], v[236:239], v[128:131]
    v_mfma_f32_16x16x32_bf16 v[132:135], v[6:9], v[240:243], v[132:135]
    v_mfma_f32_16x16x32_bf16 v[136:139], v[4:7], v[240:243], v[136:139]
    v_and_b32 v3, 15, v1
    v_mov_b32 v11, 0x100000
    v_cmp_eq_u32 vcc, 0, v3
    v_mov_b32 v10, 57600
    s_nop 0
    v_cndmask_b32 v11, v11, v10, vcc
    v_cmp_eq_u32 vcc, 1, v3
    v_mov_b32 v10, 57616
    s_nop 0
    v_cndmask_b32 v11, v11, v10, vcc
    v_cmp_eq_u32 vcc, 4, v3
    v_mov_b32 v10, 55296
    s_nop 0
    v_cndmask_b32 v11, v11, v10, vcc
    v_cmp_eq_u32 vcc, 5, v3
    v_mov_b32 v10, 55312
    s_nop 0
    v_cndmask_b32 v11, v11, v10, vcc
    v_cmp_eq_u32 vcc, 3, v3
    v_mov_b32 v10, 59904
    s_nop 0
    v_cndmask_b32 v11, v11, v10, vcc
    v_cmp_eq_u32 vcc, 7, v3
    v_mov_b32 v10, 59920
    s_nop 0
    v_cndmask_b32 v11, v11, v10, vcc
    v_lshrrev_b32 v3, 4, v1
    v_lshl_add_u32 v11, v3, 5, v11
    s_waitcnt vmcnt(0)
    v_mfma_f32_16x16x32_bf16 v[124:127], v[6:9], v[92:95], v[124:127]
    v_mfma_f32_16x16x32_bf16 v[128:131], v[4:7], v[92:95], v[128:131]
    v_mfma_f32_16x16x32_bf16 v[132:135], v[6:9], v[96:99], v[132:135]
    v_mfma_f32_16x16x32_bf16 v[136:139], v[4:7], v[96:99], v[136:139]
    s_mov_b32 s20, 0
    s_nop 3
    v_cvt_pk_bf16_f32 v124, v124, v125
    v_cvt_pk_bf16_f32 v125, v126, v127
    buffer_store_dwordx2 v[124:125], v246, s[28:31], s20 offen
    s_mov_b32 s20, 18432
    v_cvt_pk_bf16_f32 v128, v128, v129
    v_cvt_pk_bf16_f32 v129, v130, v131
    buffer_store_dwordx2 v[128:129], v246, s[28:31], s20 offen
    s_mov_b32 s20, 36864
    v_cvt_pk_bf16_f32 v132, v132, v133
    v_cvt_pk_bf16_f32 v133, v134, v135
    buffer_store_dwordx2 v[132:133], v246, s[28:31], s20 offen
    s_mov_b32 s20, 55296
    v_cvt_pk_bf16_f32 v136, v136, v137
    v_cvt_pk_bf16_f32 v137, v138, v139
    buffer_store_dwordx2 v[136:137], v246, s[28:31], s20 offen
    s_cmp_eq_u32 s44, 1
    s_cbranch_scc1 L_interleave_layers__linear_attn_block__dense_activation_silu__prompt_kernel_fin
    s_lshl_b32 s21, s3, 2
    s_add_u32 s21, s21, s6
    s_mul_i32 s21, s21, 73728
    s_add_u32 s21, s21, 10616832
    s_add_u32 s8, s4, s21
    s_addc_u32 s9, s5, 0
    s_and_b32 s9, s9, 0xffff
    s_mov_b32 s10, 73728
    s_mov_b32 s11, 0x20000
    s_mov_b32 s26, 0
    buffer_load_dwordx4 v[156:159], v2, s[8:11], s26 offen offset:0 sc1
    buffer_load_dwordx4 v[160:163], v2, s[8:11], s26 offen offset:1024 sc1
    buffer_load_dwordx4 v[164:167], v2, s[8:11], s26 offen offset:2048 sc1
    buffer_load_dwordx4 v[168:171], v2, s[8:11], s26 offen offset:3072 sc1
    s_add_u32 s20, s52, 8192
    v_mov_b32 v3, 1
    s_waitcnt vmcnt(4)
    s_mov_b64 exec, 1
    s_cmp_eq_u32 s45, 1
    s_cbranch_scc1 L_sigf10
    buffer_wbl2 sc1
    s_waitcnt vmcnt(0)
    buffer_store_dword v3, off, s[56:59], s20 sc1
    s_branch L_sigd10
L_sigf10:
    buffer_store_dword v3, off, s[56:59], s20
L_sigd10:
    s_mov_b64 exec, -1
    s_add_u32 s26, s26, 4096
    buffer_load_dwordx4 v[172:175], v2, s[8:11], s26 offen offset:0 sc1
    buffer_load_dwordx4 v[176:179], v2, s[8:11], s26 offen offset:1024 sc1
    buffer_load_dwordx4 v[180:183], v2, s[8:11], s26 offen offset:2048 sc1
    buffer_load_dwordx4 v[184:187], v2, s[8:11], s26 offen offset:3072 sc1
    s_add_u32 s26, s26, 4096
    buffer_load_dwordx4 v[188:191], v2, s[8:11], s26 offen offset:0 sc1
    buffer_load_dwordx4 v[192:195], v2, s[8:11], s26 offen offset:1024 sc1
    buffer_load_dwordx4 v[196:199], v2, s[8:11], s26 offen offset:2048 sc1
    buffer_load_dwordx4 v[200:203], v2, s[8:11], s26 offen offset:3072 sc1
    s_add_u32 s26, s26, 4096
    buffer_load_dwordx4 v[204:207], v2, s[8:11], s26 offen offset:0 sc1
    buffer_load_dwordx4 v[208:211], v2, s[8:11], s26 offen offset:1024 sc1
    buffer_load_dwordx4 v[212:215], v2, s[8:11], s26 offen offset:2048 sc1
    buffer_load_dwordx4 v[216:219], v2, s[8:11], s26 offen offset:3072 sc1
    s_add_u32 s26, s26, 4096
    buffer_load_dwordx4 v[220:223], v2, s[8:11], s26 offen offset:0 sc1
    buffer_load_dwordx4 v[224:227], v2, s[8:11], s26 offen offset:1024 sc1
    s_mul_i32 s21, s7, 73728
    s_add_u32 s22, s21, 13893632
    s_add_u32 s96, s4, s22
    s_addc_u32 s97, s5, 0
    s_and_b32 s97, s97, 0xffff
    s_mov_b32 s98, 73728
    s_mov_b32 s99, 0x20000
    s_mul_i32 s90, s6, 18432
    v_mov_b32 v249, v2
    v_add_u32 v250, 1024, v2
    s_mov_b32 s44, 1
    s_add_u32 s51, s51, 16384
    s_add_u32 s52, s52, 16384
    s_branch L_layer
L_fsig1:
    buffer_wbl2 sc1
    s_waitcnt vmcnt(0)
    buffer_store_dword v254, off, s[56:59], s55 sc1
    s_branch L_fsigb1
L_fchk1:
    s_mov_b32 s21, 131072
L_fchks1:
    buffer_load_dword v11, v3, s[56:59], s43 offen sc1
    s_waitcnt vmcnt(0)
    v_cmp_le_u32 vcc, 1, v11
    s_sub_u32 s21, s21, 1
    s_nop 0
    s_and_b32 s20, vcc_lo, s22
    s_cmp_eq_u32 s20, s22
    s_cbranch_scc1 L_fchkd1
    s_cmp_lg_u32 s21, 0
    s_cbranch_scc1 L_fchks1
L_fchkd1:
    s_cmp_eq_u32 s45, 1
    s_cbranch_scc1 L_fchkb1
    buffer_inv sc1
    s_waitcnt vmcnt(0)
    s_branch L_fchkb1
L_fsig2:
    buffer_wbl2 sc1
    s_waitcnt vmcnt(0)
    buffer_store_dword v254, off, s[56:59], s55 sc1
    s_branch L_fsigb2
L_fchk2:
    s_mov_b32 s21, 131072
L_fchks2:
    buffer_load_dword v11, v3, s[56:59], s43 offen sc1
    s_waitcnt vmcnt(0)
    v_cmp_le_u32 vcc, 2, v11
    s_sub_u32 s21, s21, 1
    s_nop 0
    s_and_b32 s20, vcc_lo, s23
    s_cmp_eq_u32 s20, s23
    s_cbranch_scc1 L_fchkd2
    s_cmp_lg_u32 s21, 0
    s_cbranch_scc1 L_fchks2
L_fchkd2:
    s_cmp_eq_u32 s45, 1
    s_cbranch_scc1 L_fchkb2
    buffer_inv sc1
    s_waitcnt vmcnt(0)
    s_branch L_fchkb2
L_fsig3:
    buffer_wbl2 sc1
    s_waitcnt vmcnt(0)
    buffer_store_dword v254, off, s[56:59], s55 sc1
    s_branch L_fsigb3
L_fsig4:
    buffer_wbl2 sc1
    s_waitcnt vmcnt(0)
    buffer_store_dword v254, off, s[56:59], s55 sc1
    s_branch L_fsigb4
L_fchk3:
    s_mov_b32 s21, 131072
L_fchks3:
    buffer_load_dword v11, v3, s[56:59], s43 offen sc1
    s_waitcnt vmcnt(0)
    v_cmp_le_u32 vcc, 3, v11
    s_sub_u32 s21, s21, 1
    s_nop 0
    s_and_b32 s20, vcc_lo, s24
    s_cmp_eq_u32 s20, s24
    s_cbranch_scc1 L_fchkd3
    s_cmp_lg_u32 s21, 0
    s_cbranch_scc1 L_fchks3
L_fchkd3:
    s_cmp_eq_u32 s45, 1
    s_cbranch_scc1 L_fchkb3
    buffer_inv sc1
    s_waitcnt vmcnt(0)
    s_branch L_fchkb3
L_fchk4:
    s_mov_b32 s21, 131072
L_fchks4:
    buffer_load_dword v11, v3, s[56:59], s43 offen sc1
    s_waitcnt vmcnt(0)
    v_cmp_le_u32 vcc, 4, v11
    s_sub_u32 s21, s21, 1
    s_nop 0
    s_and_b32 s20, vcc_lo, s25
    s_cmp_eq_u32 s20, s25
    s_cbranch_scc1 L_fchkd4
    s_cmp_lg_u32 s21, 0
    s_cbranch_scc1 L_fchks4
L_fchkd4:
    s_cmp_eq_u32 s45, 1
    s_cbranch_scc1 L_fchkb4
    buffer_inv sc1
    s_waitcnt vmcnt(0)
    s_branch L_fchkb4
L_interleave_layers__linear_attn_block__dense_activation_silu__prompt_kernel_fin:
L_interleave_layers__linear_attn_block__dense_activation_silu__prompt_kernel_end:
    s_endpgm
.p2align 4
.type L_k0_tab,@object
L_k0_tab:
.long 10653696, 1024, 0, 10672128
.long 10727424, 1024, 0, 10745856
.long 10801152, 1024, 0, 10819584
.long 10874880, 1024, 0, 10893312
.long 11538432, 1024, 432, 11556864
.long 11612160, 1024, 432, 11630592
.long 11685888, 1024, 432, 11704320
.long 11759616, 1024, 432, 11778048
.long 12423168, 1024, 864, 12441600
.long 12496896, 1024, 864, 12515328
.long 12570624, 1024, 864, 12589056
.long 12644352, 1024, 864, 12662784
.long 10911744, 2048, 1296, 10969344
.long 10985472, 2048, 1296, 11043072
.long 11059200, 2048, 1296, 11116800
.long 11132928, 2048, 1296, 11190528
.long 11796480, 2048, 1728, 11854080
.long 11870208, 2048, 1728, 11927808
.long 11943936, 2048, 1728, 12001536
.long 12017664, 2048, 1728, 12075264
.long 12681216, 2048, 2160, 12738816
.long 12754944, 2048, 2160, 12812544
.long 12828672, 2048, 2160, 12886272
.long 12902400, 2048, 2160, 12960000
.long 11207680, 2048, 2592, 11266560
.long 11281408, 2048, 2592, 11340288
.long 11355136, 2048, 2592, 11414016
.long 11428864, 2048, 2592, 11487744
.long 12092416, 2048, 3024, 12151296
.long 12166144, 2048, 3024, 12225024
.long 12239872, 2048, 3024, 12298752
.long 12313600, 2048, 3024, 12372480
.long 10948608, 1024, 144, 10967040
.long 11022336, 1024, 144, 11040768
.long 11096064, 1024, 144, 11114496
.long 11169792, 1024, 144, 11188224
.long 11833344, 1024, 576, 11851776
.long 11907072, 1024, 576, 11925504
.long 11980800, 1024, 576, 11999232
.long 12054528, 1024, 576, 12072960
.long 12718080, 1024, 1008, 12736512
.long 12791808, 1024, 1008, 12810240
.long 12865536, 1024, 1008, 12883968
.long 12939264, 1024, 1008, 12957696
.long 11206656, 2048, 1440, 11264256
.long 11280384, 2048, 1440, 11337984
.long 11354112, 2048, 1440, 11411712
.long 11427840, 2048, 1440, 11485440
.long 12091392, 2048, 1872, 12148992
.long 12165120, 2048, 1872, 12222720
.long 12238848, 2048, 1872, 12296448
.long 12312576, 2048, 1872, 12370176
.long 10617856, 2048, 2304, 10676736
.long 10691584, 2048, 2304, 10750464
.long 10765312, 2048, 2304, 10824192
.long 10839040, 2048, 2304, 10897920
.long 11502592, 2048, 2736, 11561472
.long 11576320, 2048, 2736, 11635200
.long 11650048, 2048, 2736, 11708928
.long 11723776, 2048, 2736, 11782656
.long 12387328, 2048, 3168, 12446208
.long 12461056, 2048, 3168, 12519936
.long 12534784, 2048, 3168, 12593664
.long 12608512, 2048, 3168, 12667392
.long 11243520, 1024, 288, 11261952
.long 11317248, 1024, 288, 11335680
.long 11390976, 1024, 288, 11409408
.long 11464704, 1024, 288, 11483136
.long 12128256, 1024, 720, 12146688
.long 12201984, 1024, 720, 12220416
.long 12275712, 1024, 720, 12294144
.long 12349440, 1024, 720, 12367872
.long 10616832, 2048, 1152, 10674432
.long 10690560, 2048, 1152, 10748160
.long 10764288, 2048, 1152, 10821888
.long 10838016, 2048, 1152, 10895616
.long 11501568, 2048, 1584, 11559168
.long 11575296, 2048, 1584, 11632896
.long 11649024, 2048, 1584, 11706624
.long 11722752, 2048, 1584, 11780352
.long 12386304, 2048, 2016, 12443904
.long 12460032, 2048, 2016, 12517632
.long 12533760, 2048, 2016, 12591360
.long 12607488, 2048, 2016, 12665088
.long 10912768, 2048, 2448, 10971648
.long 10986496, 2048, 2448, 11045376
.long 11060224, 2048, 2448, 11119104
.long 11133952, 2048, 2448, 11192832
.long 11797504, 2048, 2880, 11856384
.long 11871232, 2048, 2880, 11930112
.long 11944960, 2048, 2880, 12003840
.long 12018688, 2048, 2880, 12077568
.long 12682240, 2048, 3312, 12741120
.long 12755968, 2048, 3312, 12814848
.long 12829696, 2048, 3312, 12888576
.long 12903424, 2048, 3312, 12962304
.long 0, 2048, 0, 9216
.long 1024, 2048, 0, 9216
.long 36864, 2048, 0, 9216
.long 37888, 2048, 0, 9216
.long 1327104, 2048, 1152, 9216
.long 1328128, 2048, 1152, 9216
.long 1363968, 2048, 1152, 9216
.long 1364992, 2048, 1152, 9216
.long 2654208, 2048, 2304, 9216
.long 2655232, 2048, 2304, 9216
.long 2691072, 2048, 2304, 9216
.long 2692096, 2048, 2304, 9216
.long 3981312, 2048, 3456, 9216
.long 3982336, 2048, 3456, 9216
.long 4018176, 2048, 3456, 9216
.long 4019200, 2048, 3456, 9216
.long 5308416, 2048, 4608, 9216
.long 5309440, 2048, 4608, 9216
.long 5345280, 2048, 4608, 9216
.long 5346304, 2048, 4608, 9216
.long 6635520, 2048, 5760, 9216
.long 6636544, 2048, 5760, 9216
.long 6672384, 2048, 5760, 9216
.long 6673408, 2048, 5760, 9216
.long 7962624, 2048, 6912, 9216
.long 7963648, 2048, 6912, 9216
.long 7999488, 2048, 6912, 9216
.long 8000512, 2048, 6912, 9216
.long 9289728, 2048, 8064, 9216
.long 9290752, 2048, 8064, 9216
.long 9326592, 2048, 8064, 9216
.long 9327616, 2048, 8064, 9216
.long 73728, 2048, 128, 9216
.long 74752, 2048, 128, 9216
.long 110592, 2048, 128, 9216
.long 111616, 2048, 128, 9216
.long 1400832, 2048, 1280, 9216
.long 1401856, 2048, 1280, 9216
.long 1437696, 2048, 1280, 9216
.long 1438720, 2048, 1280, 9216
.long 2727936, 2048, 2432, 9216
.long 2728960, 2048, 2432, 9216
.long 2764800, 2048, 2432, 9216
.long 2765824, 2048, 2432, 9216
.long 4055040, 2048, 3584, 9216
.long 4056064, 2048, 3584, 9216
.long 4091904, 2048, 3584, 9216
.long 4092928, 2048, 3584, 9216
.long 5382144, 2048, 4736, 9216
.long 5383168, 2048, 4736, 9216
.long 5419008, 2048, 4736, 9216
.long 5420032, 2048, 4736, 9216
.long 6709248, 2048, 5888, 9216
.long 6710272, 2048, 5888, 9216
.long 6746112, 2048, 5888, 9216
.long 6747136, 2048, 5888, 9216
.long 8036352, 2048, 7040, 9216
.long 8037376, 2048, 7040, 9216
.long 8073216, 2048, 7040, 9216
.long 8074240, 2048, 7040, 9216
.long 9363456, 2048, 8192, 9216
.long 9364480, 2048, 8192, 9216
.long 9400320, 2048, 8192, 9216
.long 9401344, 2048, 8192, 9216
.long 147456, 1024, 256, 9216
.long 331776, 2048, 256, 9216
.long 332800, 2048, 256, 9216
.long 368640, 2048, 256, 9216
.long 1474560, 1024, 1408, 9216
.long 1658880, 2048, 1408, 9216
.long 1659904, 2048, 1408, 9216
.long 1695744, 2048, 1408, 9216
.long 2801664, 1024, 2560, 9216
.long 2985984, 2048, 2560, 9216
.long 2987008, 2048, 2560, 9216
.long 3022848, 2048, 2560, 9216
.long 4128768, 1024, 3712, 9216
.long 4313088, 2048, 3712, 9216
.long 4314112, 2048, 3712, 9216
.long 4349952, 2048, 3712, 9216
.long 5455872, 1024, 4864, 9216
.long 5640192, 2048, 4864, 9216
.long 5641216, 2048, 4864, 9216
.long 5677056, 2048, 4864, 9216
.long 6782976, 1024, 6016, 9216
.long 6967296, 2048, 6016, 9216
.long 6968320, 2048, 6016, 9216
.long 7004160, 2048, 6016, 9216
.long 8110080, 1024, 7168, 9216
.long 8294400, 2048, 7168, 9216
.long 8295424, 2048, 7168, 9216
.long 8331264, 2048, 7168, 9216
.long 9437184, 1024, 8320, 9216
.long 9621504, 2048, 8320, 9216
.long 9622528, 2048, 8320, 9216
.long 9658368, 2048, 8320, 9216
.long 369664, 2048, 384, 9216
.long 405504, 2048, 384, 9216
.long 406528, 2048, 384, 9216
.long 442368, 2048, 384, 9216
.long 1696768, 2048, 1536, 9216
.long 1732608, 2048, 1536, 9216
.long 1733632, 2048, 1536, 9216
.long 1769472, 2048, 1536, 9216
.long 3023872, 2048, 2688, 9216
.long 3059712, 2048, 2688, 9216
.long 3060736, 2048, 2688, 9216
.long 3096576, 2048, 2688, 9216
.long 4350976, 2048, 3840, 9216
.long 4386816, 2048, 3840, 9216
.long 4387840, 2048, 3840, 9216
.long 4423680, 2048, 3840, 9216
.long 5678080, 2048, 4992, 9216
.long 5713920, 2048, 4992, 9216
.long 5714944, 2048, 4992, 9216
.long 5750784, 2048, 4992, 9216
.long 7005184, 2048, 6144, 9216
.long 7041024, 2048, 6144, 9216
.long 7042048, 2048, 6144, 9216
.long 7077888, 2048, 6144, 9216
.long 8332288, 2048, 7296, 9216
.long 8368128, 2048, 7296, 9216
.long 8369152, 2048, 7296, 9216
.long 8404992, 2048, 7296, 9216
.long 9659392, 2048, 8448, 9216
.long 9695232, 2048, 8448, 9216
.long 9696256, 2048, 8448, 9216
.long 9732096, 2048, 8448, 9216
.long 443392, 2048, 512, 9216
.long 479232, 1024, 512, 9216
.long 663552, 2048, 512, 9216
.long 664576, 2048, 512, 9216
.long 1770496, 2048, 1664, 9216
.long 1806336, 1024, 1664, 9216
.long 1990656, 2048, 1664, 9216
.long 1991680, 2048, 1664, 9216
.long 3097600, 2048, 2816, 9216
.long 3133440, 1024, 2816, 9216
.long 3317760, 2048, 2816, 9216
.long 3318784, 2048, 2816, 9216
.long 4424704, 2048, 3968, 9216
.long 4460544, 1024, 3968, 9216
.long 4644864, 2048, 3968, 9216
.long 4645888, 2048, 3968, 9216
.long 5751808, 2048, 5120, 9216
.long 5787648, 1024, 5120, 9216
.long 5971968, 2048, 5120, 9216
.long 5972992, 2048, 5120, 9216
.long 7078912, 2048, 6272, 9216
.long 7114752, 1024, 6272, 9216
.long 7299072, 2048, 6272, 9216
.long 7300096, 2048, 6272, 9216
.long 8406016, 2048, 7424, 9216
.long 8441856, 1024, 7424, 9216
.long 8626176, 2048, 7424, 9216
.long 8627200, 2048, 7424, 9216
.long 9733120, 2048, 8576, 9216
.long 9768960, 1024, 8576, 9216
.long 9953280, 2048, 8576, 9216
.long 9954304, 2048, 8576, 9216
.long 700416, 2048, 640, 9216
.long 701440, 2048, 640, 9216
.long 737280, 2048, 640, 9216
.long 738304, 2048, 640, 9216
.long 2027520, 2048, 1792, 9216
.long 2028544, 2048, 1792, 9216
.long 2064384, 2048, 1792, 9216
.long 2065408, 2048, 1792, 9216
.long 3354624, 2048, 2944, 9216
.long 3355648, 2048, 2944, 9216
.long 3391488, 2048, 2944, 9216
.long 3392512, 2048, 2944, 9216
.long 4681728, 2048, 4096, 9216
.long 4682752, 2048, 4096, 9216
.long 4718592, 2048, 4096, 9216
.long 4719616, 2048, 4096, 9216
.long 6008832, 2048, 5248, 9216
.long 6009856, 2048, 5248, 9216
.long 6045696, 2048, 5248, 9216
.long 6046720, 2048, 5248, 9216
.long 7335936, 2048, 6400, 9216
.long 7336960, 2048, 6400, 9216
.long 7372800, 2048, 6400, 9216
.long 7373824, 2048, 6400, 9216
.long 8663040, 2048, 7552, 9216
.long 8664064, 2048, 7552, 9216
.long 8699904, 2048, 7552, 9216
.long 8700928, 2048, 7552, 9216
.long 9990144, 2048, 8704, 9216
.long 9991168, 2048, 8704, 9216
.long 10027008, 2048, 8704, 9216
.long 10028032, 2048, 8704, 9216
.long 774144, 2048, 768, 9216
.long 775168, 2048, 768, 9216
.long 811008, 1024, 768, 9216
.long 995328, 2048, 768, 9216
.long 2101248, 2048, 1920, 9216
.long 2102272, 2048, 1920, 9216
.long 2138112, 1024, 1920, 9216
.long 2322432, 2048, 1920, 9216
.long 3428352, 2048, 3072, 9216
.long 3429376, 2048, 3072, 9216
.long 3465216, 1024, 3072, 9216
.long 3649536, 2048, 3072, 9216
.long 4755456, 2048, 4224, 9216
.long 4756480, 2048, 4224, 9216
.long 4792320, 1024, 4224, 9216
.long 4976640, 2048, 4224, 9216
.long 6082560, 2048, 5376, 9216
.long 6083584, 2048, 5376, 9216
.long 6119424, 1024, 5376, 9216
.long 6303744, 2048, 5376, 9216
.long 7409664, 2048, 6528, 9216
.long 7410688, 2048, 6528, 9216
.long 7446528, 1024, 6528, 9216
.long 7630848, 2048, 6528, 9216
.long 8736768, 2048, 7680, 9216
.long 8737792, 2048, 7680, 9216
.long 8773632, 1024, 7680, 9216
.long 8957952, 2048, 7680, 9216
.long 10063872, 2048, 8832, 9216
.long 10064896, 2048, 8832, 9216
.long 10100736, 1024, 8832, 9216
.long 10285056, 2048, 8832, 9216
.long 996352, 2048, 896, 9216
.long 1032192, 2048, 896, 9216
.long 1033216, 2048, 896, 9216
.long 1069056, 2048, 896, 9216
.long 2323456, 2048, 2048, 9216
.long 2359296, 2048, 2048, 9216
.long 2360320, 2048, 2048, 9216
.long 2396160, 2048, 2048, 9216
.long 3650560, 2048, 3200, 9216
.long 3686400, 2048, 3200, 9216
.long 3687424, 2048, 3200, 9216
.long 3723264, 2048, 3200, 9216
.long 4977664, 2048, 4352, 9216
.long 5013504, 2048, 4352, 9216
.long 5014528, 2048, 4352, 9216
.long 5050368, 2048, 4352, 9216
.long 6304768, 2048, 5504, 9216
.long 6340608, 2048, 5504, 9216
.long 6341632, 2048, 5504, 9216
.long 6377472, 2048, 5504, 9216
.long 7631872, 2048, 6656, 9216
.long 7667712, 2048, 6656, 9216
.long 7668736, 2048, 6656, 9216
.long 7704576, 2048, 6656, 9216
.long 8958976, 2048, 7808, 9216
.long 8994816, 2048, 7808, 9216
.long 8995840, 2048, 7808, 9216
.long 9031680, 2048, 7808, 9216
.long 10286080, 2048, 8960, 9216
.long 10321920, 2048, 8960, 9216
.long 10322944, 2048, 8960, 9216
.long 10358784, 2048, 8960, 9216
.long 1070080, 2048, 1024, 9216
.long 1105920, 2048, 1024, 9216
.long 1106944, 2048, 1024, 9216
.long 1142784, 1024, 1024, 9216
.long 2397184, 2048, 2176, 9216
.long 2433024, 2048, 2176, 9216
.long 2434048, 2048, 2176, 9216
.long 2469888, 1024, 2176, 9216
.long 3724288, 2048, 3328, 9216
.long 3760128, 2048, 3328, 9216
.long 3761152, 2048, 3328, 9216
.long 3796992, 1024, 3328, 9216
.long 5051392, 2048, 4480, 9216
.long 5087232, 2048, 4480, 9216
.long 5088256, 2048, 4480, 9216
.long 5124096, 1024, 4480, 9216
.long 6378496, 2048, 5632, 9216
.long 6414336, 2048, 5632, 9216
.long 6415360, 2048, 5632, 9216
.long 6451200, 1024, 5632, 9216
.long 7705600, 2048, 6784, 9216
.long 7741440, 2048, 6784, 9216
.long 7742464, 2048, 6784, 9216
.long 7778304, 1024, 6784, 9216
.long 9032704, 2048, 7936, 9216
.long 9068544, 2048, 7936, 9216
.long 9069568, 2048, 7936, 9216
.long 9105408, 1024, 7936, 9216
.long 10359808, 2048, 9088, 9216
.long 10395648, 2048, 9088, 9216
.long 10396672, 2048, 9088, 9216
.long 10432512, 1024, 9088, 9216
.long 313344, 1024, 0, 1152
.long 645120, 1024, 0, 1152
.long 976896, 1024, 0, 1152
.long 1308672, 1024, 0, 1152
.long 1494016, 3072, 663552, 1152
.long 1825792, 3072, 663552, 1152
.long 2157568, 3072, 663552, 1152
.long 2489344, 3072, 663552, 1152
.long 2822144, 3072, 1327104, 1152
.long 3153920, 3072, 1327104, 1152
.long 3485696, 3072, 1327104, 1152
.long 3817472, 3072, 1327104, 1152
.long 4202496, 2048, 1990656, 1152
.long 4534272, 2048, 1990656, 1152
.long 4866048, 2048, 1990656, 1152
.long 5197824, 2048, 1990656, 1152
.long 5530624, 2048, 2654208, 1152
.long 5862400, 2048, 2654208, 1152
.long 6194176, 2048, 2654208, 1152
.long 6525952, 2048, 2654208, 1152
.long 6893568, 2048, 3317760, 1152
.long 7225344, 2048, 3317760, 1152
.long 7557120, 2048, 3317760, 1152
.long 7888896, 2048, 3317760, 1152
.long 8221696, 2048, 3981312, 1152
.long 8553472, 2048, 3981312, 1152
.long 8885248, 2048, 3981312, 1152
.long 9217024, 2048, 3981312, 1152
.long 9584640, 1024, 4644864, 1152
.long 9916416, 1024, 4644864, 1152
.long 10248192, 1024, 4644864, 1152
.long 10579968, 1024, 4644864, 1152
.long 294912, 1024, 128, 1152
.long 626688, 1024, 128, 1152
.long 958464, 1024, 128, 1152
.long 1290240, 1024, 128, 1152
.long 1640448, 1024, 663680, 1152
.long 1972224, 1024, 663680, 1152
.long 2304000, 1024, 663680, 1152
.long 2635776, 1024, 663680, 1152
.long 2821120, 3072, 1327232, 1152
.long 3152896, 3072, 1327232, 1152
.long 3484672, 3072, 1327232, 1152
.long 3816448, 3072, 1327232, 1152
.long 4149248, 3072, 1990784, 1152
.long 4481024, 3072, 1990784, 1152
.long 4812800, 3072, 1990784, 1152
.long 5144576, 3072, 1990784, 1152
.long 5529600, 2048, 2654336, 1152
.long 5861376, 2048, 2654336, 1152
.long 6193152, 2048, 2654336, 1152
.long 6524928, 2048, 2654336, 1152
.long 6857728, 2048, 3317888, 1152
.long 7189504, 2048, 3317888, 1152
.long 7521280, 2048, 3317888, 1152
.long 7853056, 2048, 3317888, 1152
.long 8220672, 2048, 3981440, 1152
.long 8552448, 2048, 3981440, 1152
.long 8884224, 2048, 3981440, 1152
.long 9216000, 2048, 3981440, 1152
.long 9548800, 2048, 4644992, 1152
.long 9880576, 2048, 4644992, 1152
.long 10212352, 2048, 4644992, 1152
.long 10544128, 2048, 4644992, 1152
.long 259072, 2048, 256, 1152
.long 590848, 2048, 256, 1152
.long 922624, 2048, 256, 1152
.long 1254400, 2048, 256, 1152
.long 1622016, 1024, 663808, 1152
.long 1953792, 1024, 663808, 1152
.long 2285568, 1024, 663808, 1152
.long 2617344, 1024, 663808, 1152
.long 2967552, 1024, 1327360, 1152
.long 3299328, 1024, 1327360, 1152
.long 3631104, 1024, 1327360, 1152
.long 3962880, 1024, 1327360, 1152
.long 4148224, 3072, 1990912, 1152
.long 4480000, 3072, 1990912, 1152
.long 4811776, 3072, 1990912, 1152
.long 5143552, 3072, 1990912, 1152
.long 5476352, 3072, 2654464, 1152
.long 5808128, 3072, 2654464, 1152
.long 6139904, 3072, 2654464, 1152
.long 6471680, 3072, 2654464, 1152
.long 6856704, 2048, 3318016, 1152
.long 7188480, 2048, 3318016, 1152
.long 7520256, 2048, 3318016, 1152
.long 7852032, 2048, 3318016, 1152
.long 8184832, 2048, 3981568, 1152
.long 8516608, 2048, 3981568, 1152
.long 8848384, 2048, 3981568, 1152
.long 9180160, 2048, 3981568, 1152
.long 9547776, 2048, 4645120, 1152
.long 9879552, 2048, 4645120, 1152
.long 10211328, 2048, 4645120, 1152
.long 10543104, 2048, 4645120, 1152
.long 258048, 2048, 384, 1152
.long 589824, 2048, 384, 1152
.long 921600, 2048, 384, 1152
.long 1253376, 2048, 384, 1152
.long 1586176, 2048, 663936, 1152
.long 1917952, 2048, 663936, 1152
.long 2249728, 2048, 663936, 1152
.long 2581504, 2048, 663936, 1152
.long 2949120, 1024, 1327488, 1152
.long 3280896, 1024, 1327488, 1152
.long 3612672, 1024, 1327488, 1152
.long 3944448, 1024, 1327488, 1152
.long 4294656, 1024, 1991040, 1152
.long 4626432, 1024, 1991040, 1152
.long 4958208, 1024, 1991040, 1152
.long 5289984, 1024, 1991040, 1152
.long 5475328, 3072, 2654592, 1152
.long 5807104, 3072, 2654592, 1152
.long 6138880, 3072, 2654592, 1152
.long 6470656, 3072, 2654592, 1152
.long 6803456, 3072, 3318144, 1152
.long 7135232, 3072, 3318144, 1152
.long 7467008, 3072, 3318144, 1152
.long 7798784, 3072, 3318144, 1152
.long 8183808, 2048, 3981696, 1152
.long 8515584, 2048, 3981696, 1152
.long 8847360, 2048, 3981696, 1152
.long 9179136, 2048, 3981696, 1152
.long 9511936, 2048, 4645248, 1152
.long 9843712, 2048, 4645248, 1152
.long 10175488, 2048, 4645248, 1152
.long 10507264, 2048, 4645248, 1152
.long 222208, 2048, 512, 1152
.long 553984, 2048, 512, 1152
.long 885760, 2048, 512, 1152
.long 1217536, 2048, 512, 1152
.long 1585152, 2048, 664064, 1152
.long 1916928, 2048, 664064, 1152
.long 2248704, 2048, 664064, 1152
.long 2580480, 2048, 664064, 1152
.long 2913280, 2048, 1327616, 1152
.long 3245056, 2048, 1327616, 1152
.long 3576832, 2048, 1327616, 1152
.long 3908608, 2048, 1327616, 1152
.long 4276224, 1024, 1991168, 1152
.long 4608000, 1024, 1991168, 1152
.long 4939776, 1024, 1991168, 1152
.long 5271552, 1024, 1991168, 1152
.long 5621760, 1024, 2654720, 1152
.long 5953536, 1024, 2654720, 1152
.long 6285312, 1024, 2654720, 1152
.long 6617088, 1024, 2654720, 1152
.long 6802432, 3072, 3318272, 1152
.long 7134208, 3072, 3318272, 1152
.long 7465984, 3072, 3318272, 1152
.long 7797760, 3072, 3318272, 1152
.long 8130560, 3072, 3981824, 1152
.long 8462336, 3072, 3981824, 1152
.long 8794112, 3072, 3981824, 1152
.long 9125888, 3072, 3981824, 1152
.long 9510912, 2048, 4645376, 1152
.long 9842688, 2048, 4645376, 1152
.long 10174464, 2048, 4645376, 1152
.long 10506240, 2048, 4645376, 1152
.long 221184, 2048, 640, 1152
.long 552960, 2048, 640, 1152
.long 884736, 2048, 640, 1152
.long 1216512, 2048, 640, 1152
.long 1549312, 2048, 664192, 1152
.long 1881088, 2048, 664192, 1152
.long 2212864, 2048, 664192, 1152
.long 2544640, 2048, 664192, 1152
.long 2912256, 2048, 1327744, 1152
.long 3244032, 2048, 1327744, 1152
.long 3575808, 2048, 1327744, 1152
.long 3907584, 2048, 1327744, 1152
.long 4240384, 2048, 1991296, 1152
.long 4572160, 2048, 1991296, 1152
.long 4903936, 2048, 1991296, 1152
.long 5235712, 2048, 1991296, 1152
.long 5603328, 1024, 2654848, 1152
.long 5935104, 1024, 2654848, 1152
.long 6266880, 1024, 2654848, 1152
.long 6598656, 1024, 2654848, 1152
.long 6948864, 1024, 3318400, 1152
.long 7280640, 1024, 3318400, 1152
.long 7612416, 1024, 3318400, 1152
.long 7944192, 1024, 3318400, 1152
.long 8129536, 3072, 3981952, 1152
.long 8461312, 3072, 3981952, 1152
.long 8793088, 3072, 3981952, 1152
.long 9124864, 3072, 3981952, 1152
.long 9457664, 3072, 4645504, 1152
.long 9789440, 3072, 4645504, 1152
.long 10121216, 3072, 4645504, 1152
.long 10452992, 3072, 4645504, 1152
.long 167936, 3072, 768, 1152
.long 499712, 3072, 768, 1152
.long 831488, 3072, 768, 1152
.long 1163264, 3072, 768, 1152
.long 1548288, 2048, 664320, 1152
.long 1880064, 2048, 664320, 1152
.long 2211840, 2048, 664320, 1152
.long 2543616, 2048, 664320, 1152
.long 2876416, 2048, 1327872, 1152
.long 3208192, 2048, 1327872, 1152
.long 3539968, 2048, 1327872, 1152
.long 3871744, 2048, 1327872, 1152
.long 4239360, 2048, 1991424, 1152
.long 4571136, 2048, 1991424, 1152
.long 4902912, 2048, 1991424, 1152
.long 5234688, 2048, 1991424, 1152
.long 5567488, 2048, 2654976, 1152
.long 5899264, 2048, 2654976, 1152
.long 6231040, 2048, 2654976, 1152
.long 6562816, 2048, 2654976, 1152
.long 6930432, 1024, 3318528, 1152
.long 7262208, 1024, 3318528, 1152
.long 7593984, 1024, 3318528, 1152
.long 7925760, 1024, 3318528, 1152
.long 8275968, 1024, 3982080, 1152
.long 8607744, 1024, 3982080, 1152
.long 8939520, 1024, 3982080, 1152
.long 9271296, 1024, 3982080, 1152
.long 9456640, 3072, 4645632, 1152
.long 9788416, 3072, 4645632, 1152
.long 10120192, 3072, 4645632, 1152
.long 10451968, 3072, 4645632, 1152
.long 166912, 3072, 896, 1152
.long 498688, 3072, 896, 1152
.long 830464, 3072, 896, 1152
.long 1162240, 3072, 896, 1152
.long 1495040, 3072, 664448, 1152
.long 1826816, 3072, 664448, 1152
.long 2158592, 3072, 664448, 1152
.long 2490368, 3072, 664448, 1152
.long 2875392, 2048, 1328000, 1152
.long 3207168, 2048, 1328000, 1152
.long 3538944, 2048, 1328000, 1152
.long 3870720, 2048, 1328000, 1152
.long 4203520, 2048, 1991552, 1152
.long 4535296, 2048, 1991552, 1152
.long 4867072, 2048, 1991552, 1152
.long 5198848, 2048, 1991552, 1152
.long 5566464, 2048, 2655104, 1152
.long 5898240, 2048, 2655104, 1152
.long 6230016, 2048, 2655104, 1152
.long 6561792, 2048, 2655104, 1152
.long 6894592, 2048, 3318656, 1152
.long 7226368, 2048, 3318656, 1152
.long 7558144, 2048, 3318656, 1152
.long 7889920, 2048, 3318656, 1152
.long 8257536, 1024, 3982208, 1152
.long 8589312, 1024, 3982208, 1152
.long 8921088, 1024, 3982208, 1152
.long 9252864, 1024, 3982208, 1152
.long 9603072, 1024, 4645760, 1152
.long 9934848, 1024, 4645760, 1152
.long 10266624, 1024, 4645760, 1152
.long 10598400, 1024, 4645760, 1152
.long 165888, 3072, 1024, 1152
.long 497664, 3072, 1024, 1152
.long 829440, 3072, 1024, 1152
.long 1161216, 3072, 1024, 1152
.long 1492992, 3072, 664576, 1152
.long 1824768, 3072, 664576, 1152
.long 2156544, 3072, 664576, 1152
.long 2488320, 3072, 664576, 1152
.long 2820096, 3072, 1328128, 1152
.long 3151872, 3072, 1328128, 1152
.long 3483648, 3072, 1328128, 1152
.long 3815424, 3072, 1328128, 1152
.long 4147200, 3072, 1991680, 1152
.long 4478976, 3072, 1991680, 1152
.long 4810752, 3072, 1991680, 1152
.long 5142528, 3072, 1991680, 1152
.long 5474304, 3072, 2655232, 1152
.long 5806080, 3072, 2655232, 1152
.long 6137856, 3072, 2655232, 1152
.long 6469632, 3072, 2655232, 1152
.long 6801408, 3072, 3318784, 1152
.long 7133184, 3072, 3318784, 1152
.long 7464960, 3072, 3318784, 1152
.long 7796736, 3072, 3318784, 1152
.long 8128512, 3072, 3982336, 1152
.long 8460288, 3072, 3982336, 1152
.long 8792064, 3072, 3982336, 1152
.long 9123840, 3072, 3982336, 1152
.long 9455616, 3072, 4645888, 1152
.long 9787392, 3072, 4645888, 1152
.long 10119168, 3072, 4645888, 1152
.long 10450944, 3072, 4645888, 1152
.long 12976128, 2048, 0, 1152
.long 12977152, 2048, 0, 1152
.long 13012992, 2048, 0, 1152
.long 13014016, 2048, 0, 1152
.long 13049856, 2048, 128, 1152
.long 13050880, 2048, 128, 1152
.long 13086720, 2048, 128, 1152
.long 13087744, 2048, 128, 1152
.long 13123584, 1024, 256, 1152
.long 13289472, 1024, 256, 1152
.long 13142016, 2048, 256, 1152
.long 13143040, 2048, 256, 1152
.long 13178880, 2048, 384, 1152
.long 13179904, 2048, 384, 1152
.long 13215744, 2048, 384, 1152
.long 13216768, 2048, 384, 1152
.long 13252608, 2048, 512, 1152
.long 13253632, 2048, 512, 1152
.long 13307904, 2048, 512, 1152
.long 13308928, 2048, 512, 1152
.long 13344768, 2048, 640, 1152
.long 13345792, 2048, 640, 1152
.long 13381632, 2048, 640, 1152
.long 13382656, 2048, 640, 1152
.long 13418496, 2048, 768, 1152
.long 13419520, 2048, 768, 1152
.long 13455360, 1024, 768, 1152
.long 13621248, 1024, 768, 1152
.long 13473792, 2048, 896, 1152
.long 13474816, 2048, 896, 1152
.long 13510656, 2048, 896, 1152
.long 13511680, 2048, 896, 1152
.long 13547520, 2048, 1024, 1152
.long 13548544, 2048, 1024, 1152
.long 13584384, 2048, 1024, 1152
.long 13585408, 2048, 1024, 1152
.size L_k0_tab, .-L_k0_tab
.section .rodata,"a"
.p2align 6
.amdhsa_kernel interleave_layers__linear_attn_block__dense_activation_silu__prompt_kernel
  .amdhsa_next_free_vgpr 512
  .amdhsa_next_free_sgpr 102
  .amdhsa_accum_offset 256
  .amdhsa_group_segment_fixed_size 0
  .amdhsa_kernarg_size 72
  .amdhsa_user_sgpr_count 2
  .amdhsa_user_sgpr_kernarg_segment_ptr 1
  .amdhsa_system_sgpr_workgroup_id_x 1
  .amdhsa_float_denorm_mode_32 3
.end_amdhsa_kernel
```
